```python
import torch

def _softmax(x, axis=-1):
    return torch.softmax(x, dim=axis)
def _gelu(x):
    return torch.nn.functional.gelu(x, approximate="tanh")
def _silu(x):
    return torch.nn.functional.silu(x)
def _sigmoid(x):
    return torch.sigmoid(x)
def _layernorm(x, axis=-1, eps=1e-5):
    m = x.mean(dim=axis, keepdim=True)
    v = x.var(dim=axis, keepdim=True, unbiased=False)
    return (x - m) / torch.sqrt(v + eps)
def _scatter_add(tgt, idx, src, axis=0):
    return tgt.clone().index_add_(axis, idx, src)
def _segment_sum(src, seg, n):
    out = torch.zeros((n,) + src.shape[1:], dtype=src.dtype)
    return out.index_add_(0, seg, src)
def _pad(x, pw):
    flat = tuple(v for pair in reversed(pw) for v in pair)
    return torch.nn.functional.pad(x, flat)

kernel_name = 'standalone__mha_softmax__near_ridge'

def setup_inputs():

    _w = (lambda a: (lambda t: t.to(torch.bfloat16) if t.is_floating_point() else t)(torch.as_tensor(a)))
    B, H, Sq, Sk, D = 16, 32, 512, 512, 192
    return {
        "q": _w((lambda *s: torch.randn(*s, dtype=torch.bfloat16) * 0.8)(B, H, Sq, D)),
        "k": _w((lambda *s: torch.randn(*s, dtype=torch.bfloat16) * 0.8)(B, H, Sk, D)),
        "v": _w((lambda *s: torch.randn(*s, dtype=torch.bfloat16) * 0.05)(B, H, Sk, D)),
    }

def reference(q, k, v):
    scale = q.shape[-1] ** -0.5
    scores = torch.einsum("bhqd,bhkd->bhqk", q, k) * scale
    p = _softmax(scores, axis=-1)
    return torch.einsum("bhqk,bhkd->bhqd", p, v)
```

```asm
; @launch grid=(256,1,1) block=(256,1,1) lds=156288
.amdgcn_target "amdgcn-amd-amdhsa--gfx950"
.text
.globl standalone__mha_softmax__near_ridge_kernel
.p2align 8
.type standalone__mha_softmax__near_ridge_kernel,@function
standalone__mha_softmax__near_ridge_kernel:
    s_cmp_ge_u32 s2, 256
    s_cbranch_scc1 L_end
    s_load_dwordx8 s[40:47], s[0:1], 0
    s_getpc_b64 s[58:59]
L_pc:
    v_lshrrev_b32 v1, 6, v0
    v_and_b32 v2, 63, v0
    v_readfirstlane_b32 s34, v1
    s_mov_b32 s20, 0x3dd53b95
    s_mov_b32 s21, 0xbdd53b95
    s_mov_b32 s22, 0x5f800000
    s_mov_b32 s24, 4
    s_mov_b32 s32, 0
    s_lshr_b32 s3, s2, 4
    s_lshl_b32 s3, s3, 3
    s_and_b32 s35, s2, 7
    s_add_u32 s3, s3, s35
    s_mul_i32 s39, s3, 196608
    s_add_u32 s57, s39, 196608
    s_lshr_b32 s3, s2, 4
    s_mul_i32 s3, s3, 0
    s_add_u32 s25, s39, 61440
    s_add_u32 s26, s39, 49152
    s_mul_i32 s27, s34, 3072
    s_mul_i32 s31, s34, 3104
    s_and_b32 s35, s34, 1
    s_mul_i32 s35, s35, 24
    s_sub_u32 s31, s31, s35
    s_add_u32 s31, s31, 61440
    s_add_u32 s28, s31, 37248
    s_add_u32 s29, s31, 49664
    s_mov_b32 s30, s29
    s_mov_b32 s37, 12416
    s_lshr_b32 s35, s2, 3
    s_and_b32 s35, s35, 1
    s_mul_i32 s23, s35, 98304
    s_lshr_b32 s35, s2, 3
    s_lshl_b32 s35, s35, 11
    v_lshlrev_b32 v247, 3, v0
    v_add_u32 v247, s35, v247
    v_min_u32 v247, L_cend-L_pc-4, v247
    s_mul_i32 s35, s34, 24576
    s_add_u32 s23, s23, s35
    s_add_u32 s36, s39, s23
    s_lshl_b32 s38, s34, 13
    s_add_u32 s38, s38, 123520
    v_lshrrev_b32 v6, 3, v2
    v_mul_u32_u24 v7, 384, v6
    v_xor_b32 v8, v6, v2
    v_and_b32 v8, 7, v8
    v_lshl_add_u32 v244, v8, 4, v7
    v_xor_b32 v245, 16, v244
    v_and_b32 v8, 1, v1
    v_lshlrev_b32 v8, 4, v8
    v_xor_b32 v8, v8, v244
    v_add_u32 v241, s27, v8
    v_and_b32 v3, 7, v2
    v_lshlrev_b32 v9, 4, v3
    v_lshl_add_u32 v9, v7, 2, v9
    v_mul_u32_u24 v8, 384, v1
    v_add_u32 v242, v8, v9
    v_lshlrev_b32 v7, 4, v2
    v_add_u32 v246, s38, v7
    v_lshrrev_b32 v4, 4, v2
    v_and_b32 v8, 1, v6
    v_lshlrev_b32 v7, 11, v8
    v_sub_u32 v9, s38, v7
    v_mul_u32_u24 v5, 3072, v8
    v_lshl_add_u32 v5, v3, 7, v5
    v_xor_b32 v6, v3, v8
    v_lshlrev_b32 v7, 1, v4
    v_xor_b32 v6, v6, v7
    v_lshl_add_u32 v236, v6, 4, v5
    v_xor_b32 v237, 16, v236
    v_add_u32 v238, v236, v9
    v_add_u32 v239, v237, v9
    v_bfe_u32 v7, v2, 2, 2
    v_mul_u32_u24 v8, 3104, v7
    v_lshl_add_u32 v8, v4, 7, v8
    v_and_b32 v9, 3, v2
    v_lshl_add_u32 v8, v9, 4, v8
    v_and_b32 v7, 1, v7
    v_mul_u32_u24 v7, 24, v7
    v_sub_u32 v8, v8, v7
    v_add_u32 v240, 111104, v8
    v_mul_u32_u24 v232, 64, v2
    v_mov_b32 v252, 0
    v_mov_b32 v253, 0
    v_mov_b32 v254, 0
    v_mov_b32 v255, 0
    v_mov_b32 v8, 0x3f803f80
    v_cmp_eq_u32 vcc, 0, v9
    v_cndmask_b32 v7, 0, v8, vcc
    v_accvgpr_write_b32 a224, v7
    v_accvgpr_write_b32 a225, v7
    v_accvgpr_write_b32 a226, v7
    v_accvgpr_write_b32 a227, v7
    v_cmp_eq_u32 vcc, 1, v9
    v_cndmask_b32 v7, 0, v8, vcc
    v_accvgpr_write_b32 a228, v7
    v_accvgpr_write_b32 a229, v7
    v_accvgpr_write_b32 a230, v7
    v_accvgpr_write_b32 a231, v7
    v_bfe_u32 v6, v2, 1, 3
    v_mul_u32_u24 v6, 768, v6
    v_bfe_u32 v7, v2, 4, 1
    v_lshl_add_u32 v6, v7, 4, v6
    v_lshrrev_b32 v7, 5, v2
    v_lshl_add_u32 v6, v7, 5, v6
    v_bfe_u32 v7, v2, 0, 1
    v_lshl_add_u32 v243, v7, 6, v6
    s_bfe_u32 s33, s2, 0x4
    s_mov_b32 s12, 0x55555555
    s_mov_b32 s13, 0x55555555
    s_mov_b32 s14, 0xaaaaaaaa
    s_mov_b32 s15, 0xaaaaaaaa
    s_waitcnt lgkmcnt(0)
    s_mov_b32 s8, s42
    s_and_b32 s9, s43, 0xffff
    s_mov_b32 s10, 100663296
    s_mov_b32 s11, 0x00020000
    s_mov_b32 s4, s40
    s_and_b32 s5, s41, 0xffff
    s_mov_b32 s6, 100663296
    s_mov_b32 s7, 0x00020000
    s_mov_b32 s48, s44
    s_and_b32 s49, s45, 0xffff
    s_mov_b32 s50, 100663296
    s_mov_b32 s51, 0x00020000
    s_mov_b32 s16, s46
    s_and_b32 s17, s47, 0xffff
    s_mov_b32 s18, 100663296
    s_mov_b32 s19, 0x00020000
    s_xor_b32 s40, s33, 0
    s_mul_i32 s40, s40, 6144
    s_add_u32 s40, s40, s36
    s_mov_b32 s44, 0x80000000
    s_xor_b32 s41, s33, 1
    s_mul_i32 s41, s41, 6144
    s_add_u32 s41, s41, s36
    s_mov_b32 s45, 0x80000000
    s_xor_b32 s42, s33, 2
    s_mul_i32 s42, s42, 6144
    s_add_u32 s42, s42, s36
    s_mov_b32 s46, 0x80000000
    s_xor_b32 s43, s33, 3
    s_mul_i32 s43, s43, 6144
    s_add_u32 s43, s43, s36
    s_mov_b32 s47, 0x80000000
    s_add_u32 s34, s39, 0
    s_add_u32 m0, s27, 49152
    s_nop 0
    buffer_load_dwordx4 v241, s[8:11], s34 offen nt lds
    s_add_u32 m0, s27, 50048
    s_nop 0
    buffer_load_dwordx4 v241, s[8:11], s34 offen offset:128 nt lds
    s_add_u32 m0, s27, 50944
    s_nop 0
    buffer_load_dwordx4 v241, s[8:11], s34 offen offset:256 nt lds
    buffer_load_dwordx4 v[0:3], v244, s[4:7], s40 offen nt
    buffer_load_dwordx4 v[4:7], v245, s[4:7], s40 offen offset:3072 nt
    buffer_load_dwordx4 v[8:11], v244, s[4:7], s41 offen nt
    buffer_load_dwordx4 v[12:15], v245, s[4:7], s41 offen offset:3072 nt
    buffer_load_dwordx4 v[16:19], v244, s[4:7], s40 offen offset:128 nt
    buffer_load_dwordx4 v[20:23], v245, s[4:7], s40 offen offset:3200 nt
    buffer_load_dwordx4 v[24:27], v244, s[4:7], s41 offen offset:128 nt
    buffer_load_dwordx4 v[28:31], v245, s[4:7], s41 offen offset:3200 nt
    buffer_load_dwordx4 v[32:35], v244, s[4:7], s40 offen offset:256 nt
    buffer_load_dwordx4 v[36:39], v245, s[4:7], s40 offen offset:3328 nt
    buffer_load_dwordx4 v[40:43], v244, s[4:7], s41 offen offset:256 nt
    buffer_load_dwordx4 v[44:47], v245, s[4:7], s41 offen offset:3328 nt
    s_add_u32 s34, s39, 12288
    s_add_u32 m0, s27, 12288
    s_nop 0
    buffer_load_dwordx4 v241, s[8:11], s34 offen nt lds
    s_add_u32 m0, s27, 13184
    s_nop 0
    buffer_load_dwordx4 v241, s[8:11], s34 offen offset:128 nt lds
    s_add_u32 m0, s27, 14080
    s_nop 0
    buffer_load_dwordx4 v241, s[8:11], s34 offen offset:256 nt lds
    s_waitcnt vmcnt(14)
    ds_write_b128 v246, v[0:3]
    s_waitcnt vmcnt(13)
    ds_write_b128 v246, v[4:7] offset:1024
    s_waitcnt vmcnt(12)
    ds_write_b128 v246, v[8:11] offset:2048
    s_waitcnt vmcnt(11)
    ds_write_b128 v246, v[12:15] offset:3072
    ds_read_b128 a[96:99], v238
    ds_read_b128 a[100:103], v239
    ds_read_b128 a[104:107], v238 offset:2048
    ds_read_b128 a[108:111], v239 offset:2048
    s_add_u32 s34, s39, 0
    s_add_u32 m0, s31, 0
    s_nop 0
    buffer_load_dwordx4 v242, s[48:51], s34 offen nt lds
    s_add_u32 m0, s31, 896
    s_nop 0
    buffer_load_dwordx4 v242, s[48:51], s34 offen offset:128 nt lds
    s_add_u32 m0, s31, 1792
    s_nop 0
    buffer_load_dwordx4 v242, s[48:51], s34 offen offset:256 nt lds
    s_waitcnt vmcnt(13)
    ds_write_b128 v246, v[16:19]
    s_waitcnt vmcnt(12)
    ds_write_b128 v246, v[20:23] offset:1024
    s_waitcnt vmcnt(11)
    ds_write_b128 v246, v[24:27] offset:2048
    s_waitcnt vmcnt(10)
    ds_write_b128 v246, v[28:31] offset:3072
    ds_read_b128 a[112:115], v238
    ds_read_b128 a[116:119], v239
    ds_read_b128 a[120:123], v238 offset:2048
    ds_read_b128 a[124:127], v239 offset:2048
    s_add_u32 s34, s39, 24576
    s_add_u32 m0, s27, 24576
    s_nop 0
    buffer_load_dwordx4 v241, s[8:11], s34 offen nt lds
    s_add_u32 m0, s27, 25472
    s_nop 0
    buffer_load_dwordx4 v241, s[8:11], s34 offen offset:128 nt lds
    s_add_u32 m0, s27, 26368
    s_nop 0
    buffer_load_dwordx4 v241, s[8:11], s34 offen offset:256 nt lds
    s_waitcnt vmcnt(12)
    ds_write_b128 v246, v[32:35]
    s_waitcnt vmcnt(11)
    ds_write_b128 v246, v[36:39] offset:1024
    s_waitcnt vmcnt(10)
    ds_write_b128 v246, v[40:43] offset:2048
    s_waitcnt vmcnt(9)
    ds_write_b128 v246, v[44:47] offset:3072
    ds_read_b128 a[128:131], v238
    ds_read_b128 a[132:135], v239
    ds_read_b128 a[136:139], v238 offset:2048
    ds_read_b128 a[140:143], v239 offset:2048
    s_add_u32 s34, s39, 12288
    s_add_u32 m0, s31, 12416
    s_nop 0
    buffer_load_dwordx4 v242, s[48:51], s34 offen nt lds
    s_add_u32 m0, s31, 13312
    s_nop 0
    buffer_load_dwordx4 v242, s[48:51], s34 offen offset:128 nt lds
    s_add_u32 m0, s31, 14208
    s_nop 0
    buffer_load_dwordx4 v242, s[48:51], s34 offen offset:256 nt lds
    s_barrier
    ds_read_b128 a[192:195], v236 offset:49152
    ds_read_b128 a[196:199], v237 offset:49152
    ds_read_b128 a[200:203], v236 offset:50176
    ds_read_b128 a[204:207], v237 offset:50176
    s_waitcnt lgkmcnt(3)
    v_mfma_f32_16x16x32_bf16 v[96:99], a[192:195], a[96:99], 0
    buffer_load_dwordx4 v[48:51], v244, s[4:7], s42 offen nt
    ds_read_b128 a[208:211], v236 offset:51200
    v_mfma_f32_16x16x32_bf16 v[104:107], a[192:195], a[104:107], 0
    s_waitcnt lgkmcnt(3)
    v_mfma_f32_16x16x32_bf16 v[96:99], a[196:199], a[100:103], v[96:99]
    ds_read_b128 a[212:215], v237 offset:51200
    v_mfma_f32_16x16x32_bf16 v[104:107], a[196:199], a[108:111], v[104:107]
    s_waitcnt lgkmcnt(3)
    v_mfma_f32_16x16x32_bf16 v[96:99], a[200:203], a[112:115], v[96:99]
    ds_read_b128 a[192:195], v236 offset:55296
    v_mfma_f32_16x16x32_bf16 v[104:107], a[200:203], a[120:123], v[104:107]
    s_waitcnt lgkmcnt(3)
    v_mfma_f32_16x16x32_bf16 v[96:99], a[204:207], a[116:119], v[96:99]
    ds_read_b128 a[196:199], v237 offset:55296
    v_mfma_f32_16x16x32_bf16 v[104:107], a[204:207], a[124:127], v[104:107]
    s_waitcnt lgkmcnt(3)
    v_mfma_f32_16x16x32_bf16 v[96:99], a[208:211], a[128:131], v[96:99]
    buffer_load_dwordx4 v[52:55], v245, s[4:7], s42 offen offset:3072 nt
    ds_read_b128 a[200:203], v236 offset:56320
    v_mfma_f32_16x16x32_bf16 v[104:107], a[208:211], a[136:139], v[104:107]
    s_waitcnt lgkmcnt(3)
    v_mfma_f32_16x16x32_bf16 v[96:99], a[212:215], a[132:135], v[96:99]
    ds_read_b128 a[204:207], v237 offset:56320
    v_mfma_f32_16x16x32_bf16 v[104:107], a[212:215], a[140:143], v[104:107]
    s_waitcnt lgkmcnt(3)
    v_mfma_f32_16x16x32_bf16 v[100:103], a[192:195], a[96:99], 0
    ds_read_b128 a[208:211], v236 offset:57344
    v_mfma_f32_16x16x32_bf16 v[108:111], a[192:195], a[104:107], 0
    s_waitcnt lgkmcnt(3)
    v_mfma_f32_16x16x32_bf16 v[100:103], a[196:199], a[100:103], v[100:103]
    ds_read_b128 a[212:215], v237 offset:57344
    v_mfma_f32_16x16x32_bf16 v[108:111], a[196:199], a[108:111], v[108:111]
    s_waitcnt lgkmcnt(3)
    v_mfma_f32_16x16x32_bf16 v[100:103], a[200:203], a[112:115], v[100:103]
    buffer_load_dwordx4 v[56:59], v244, s[4:7], s43 offen nt
    v_mfma_f32_16x16x32_bf16 v[108:111], a[200:203], a[120:123], v[108:111]
    s_waitcnt lgkmcnt(2)
    v_mfma_f32_16x16x32_bf16 v[100:103], a[204:207], a[116:119], v[100:103]
    v_mfma_f32_16x16x32_bf16 v[108:111], a[204:207], a[124:127], v[108:111]
    s_waitcnt lgkmcnt(1)
    v_mfma_f32_16x16x32_bf16 v[100:103], a[208:211], a[128:131], v[100:103]
    v_mfma_f32_16x16x32_bf16 v[108:111], a[208:211], a[136:139], v[108:111]
    s_waitcnt lgkmcnt(0)
    v_mfma_f32_16x16x32_bf16 v[100:103], a[212:215], a[132:135], v[100:103]
    v_mfma_f32_16x16x32_bf16 v[108:111], a[212:215], a[140:143], v[108:111]
    s_waitcnt vmcnt(9)
    s_barrier
    v_max3_f32 v248, v96, v97, v98
    v_max3_f32 v249, v104, v105, v106
    v_max_f32 v248, v248, v99
    v_max_f32 v249, v249, v107
    s_nop 1
    v_permlane32_swap_b32 v248, v249
    v_max_f32 v248, v248, v249
    v_mov_b32 v249, v248
    s_nop 1
    v_permlane16_swap_b32 v248, v249
    v_max_f32 v248, v248, v249
    v_mul_f32 v249, s21, v248
    v_mul_f32 v248, s21, v248
    s_nop 1
    v_permlane32_swap_b32 v248, v249
    v_fma_f32 v96, v96, s20, v248
    v_fma_f32 v97, v97, s20, v248
    v_fma_f32 v104, v104, s20, v249
    v_exp_f32 v96, v96
    v_fma_f32 v105, v105, s20, v249
    v_exp_f32 v97, v97
    v_exp_f32 v104, v104
    v_cvt_pk_bf16_f32 v96, v96, v97
    v_exp_f32 v105, v105
    s_nop 0
    v_cvt_pk_bf16_f32 v104, v104, v105
    ds_read_b128 a[192:195], v236 offset:12288
    v_fma_f32 v98, v98, s20, v248
    v_fma_f32 v99, v99, s20, v248
    ds_read_b128 a[196:199], v237 offset:12288
    v_fma_f32 v106, v106, s20, v249
    v_exp_f32 v98, v98
    v_fma_f32 v107, v107, s20, v249
    v_exp_f32 v99, v99
    ds_read_b128 a[200:203], v236 offset:13312
    v_exp_f32 v106, v106
    v_cvt_pk_bf16_f32 v97, v98, v99
    v_exp_f32 v107, v107
    ds_read_b128 a[204:207], v237 offset:13312
    v_cvt_pk_bf16_f32 v105, v106, v107
    v_fma_f32 v100, v100, s20, v248
    s_waitcnt lgkmcnt(3)
    v_mfma_f32_16x16x32_bf16 v[128:131], a[192:195], a[96:99], 0
    buffer_load_dwordx4 v[60:63], v245, s[4:7], s43 offen offset:3072 nt
    ds_read_b128 a[208:211], v236 offset:14336
    v_mfma_f32_16x16x32_bf16 v[136:139], a[192:195], a[104:107], 0
    v_fma_f32 v101, v101, s20, v248
    v_fma_f32 v102, v102, s20, v248
    s_waitcnt lgkmcnt(3)
    v_mfma_f32_16x16x32_bf16 v[128:131], a[196:199], a[100:103], v[128:131]
    ds_read_b128 a[212:215], v237 offset:14336
    v_exp_f32 v100, v100
    v_mfma_f32_16x16x32_bf16 v[136:139], a[196:199], a[108:111], v[136:139]
    v_fma_f32 v103, v103, s20, v248
    v_exp_f32 v101, v101
    v_fma_f32 v108, v108, s20, v249
    v_exp_f32 v102, v102
    s_waitcnt lgkmcnt(3)
    v_mfma_f32_16x16x32_bf16 v[128:131], a[200:203], a[112:115], v[128:131]
    ds_read_b128 a[192:195], v236 offset:18432
    v_fma_f32 v109, v109, s20, v249
    v_mfma_f32_16x16x32_bf16 v[136:139], a[200:203], a[120:123], v[136:139]
    v_cvt_pk_bf16_f32 v98, v100, v101
    v_exp_f32 v103, v103
    v_fma_f32 v110, v110, s20, v249
    s_waitcnt lgkmcnt(3)
    v_mfma_f32_16x16x32_bf16 v[128:131], a[204:207], a[116:119], v[128:131]
    ds_read_b128 a[196:199], v237 offset:18432
    v_exp_f32 v108, v108
    v_mfma_f32_16x16x32_bf16 v[136:139], a[204:207], a[124:127], v[136:139]
    v_fma_f32 v111, v111, s20, v249
    v_cvt_pk_bf16_f32 v99, v102, v103
    v_exp_f32 v109, v109
    v_exp_f32 v110, v110
    s_waitcnt lgkmcnt(3)
    v_mfma_f32_16x16x32_bf16 v[128:131], a[208:211], a[128:131], v[128:131]
    buffer_load_dwordx4 v[64:67], v244, s[4:7], s42 offen offset:128 nt
    ds_read_b128 a[200:203], v236 offset:19456
    v_mfma_f32_16x16x32_bf16 v[136:139], a[208:211], a[136:139], v[136:139]
    v_cvt_pk_bf16_f32 v106, v108, v109
    v_exp_f32 v111, v111
    s_waitcnt lgkmcnt(3)
    v_mfma_f32_16x16x32_bf16 v[128:131], a[212:215], a[132:135], v[128:131]
    ds_read_b128 a[204:207], v237 offset:19456
    v_mfma_f32_16x16x32_bf16 v[136:139], a[212:215], a[140:143], v[136:139]
    s_cmp_eq_u32 s29, s30
    s_cselect_b32 s35, -49664, s37
    v_cvt_pk_bf16_f32 v107, v110, v111
    s_add_u32 s28, s29, s35
    s_waitcnt lgkmcnt(3)
    v_mfma_f32_16x16x32_bf16 v[132:135], a[192:195], a[96:99], 0
    ds_read_b128 a[208:211], v236 offset:20480
    v_add_u32 v240, s35, v240
    v_mfma_f32_16x16x32_bf16 v[140:143], a[192:195], a[104:107], 0
    v_mfma_f32_16x16x32_bf16 a[232:235], a[224:227], v[96:99], 0
    s_waitcnt lgkmcnt(3)
    v_mfma_f32_16x16x32_bf16 v[132:135], a[196:199], a[100:103], v[132:135]
    ds_read_b128 a[212:215], v237 offset:20480
    v_mfma_f32_16x16x32_bf16 v[140:143], a[196:199], a[108:111], v[140:143]
    buffer_load_dwordx4 v[68:71], v245, s[4:7], s42 offen offset:3200 nt
    s_waitcnt lgkmcnt(3)
    v_mfma_f32_16x16x32_bf16 v[132:135], a[200:203], a[112:115], v[132:135]
    ds_read_b64_tr_b16 a[192:193], v240
    v_mfma_f32_16x16x32_bf16 a[232:235], a[228:231], v[104:107], a[232:235]
    v_mfma_f32_16x16x32_bf16 v[140:143], a[200:203], a[120:123], v[140:143]
    ds_read_b64_tr_b16 a[194:195], v240 offset:512
    s_waitcnt lgkmcnt(4)
    v_mfma_f32_16x16x32_bf16 v[132:135], a[204:207], a[116:119], v[132:135]
    ds_read_b64_tr_b16 a[196:197], v240 offset:8
    v_mfma_f32_16x16x32_bf16 v[140:143], a[204:207], a[124:127], v[140:143]
    ds_read_b64_tr_b16 a[198:199], v240 offset:520
    s_waitcnt lgkmcnt(5)
    v_mfma_f32_16x16x32_bf16 v[132:135], a[208:211], a[128:131], v[132:135]
    ds_read_b64_tr_b16 a[200:201], v240 offset:64
    v_fma_f32 v128, v128, s20, v248
    v_mfma_f32_16x16x32_bf16 v[140:143], a[208:211], a[136:139], v[140:143]
    ds_read_b64_tr_b16 a[202:203], v240 offset:576
    v_fma_f32 v129, v129, s20, v248
    v_fma_f32 v136, v136, s20, v249
    s_waitcnt lgkmcnt(6)
    v_mfma_f32_16x16x32_bf16 v[132:135], a[212:215], a[132:135], v[132:135]
    buffer_load_dwordx4 v[72:75], v244, s[4:7], s43 offen offset:128 nt
    ds_read_b64_tr_b16 a[204:205], v240 offset:72
    v_exp_f32 v128, v128
    v_mfma_f32_16x16x32_bf16 v[140:143], a[212:215], a[140:143], v[140:143]
    ds_read_b64_tr_b16 a[206:207], v240 offset:584
    v_fma_f32 v137, v137, s20, v249
    s_waitcnt vmcnt(7)
    s_barrier
    v_exp_f32 v129, v129
    s_waitcnt lgkmcnt(6)
    v_mfma_f32_16x16x32_bf16 a[0:3], a[192:195], v[96:99], 0
    ds_read_b64_tr_b16 a[208:209], v240 offset:1024
    v_mfma_f32_16x16x32_bf16 a[8:11], a[192:195], v[104:107], 0
    ds_read_b64_tr_b16 a[210:211], v240 offset:1536
    v_exp_f32 v136, v136
    s_waitcnt lgkmcnt(6)
    v_mfma_f32_16x16x32_bf16 a[4:7], a[196:199], v[96:99], 0
    ds_read_b64_tr_b16 a[212:213], v240 offset:1032
    v_mfma_f32_16x16x32_bf16 a[12:15], a[196:199], v[104:107], 0
    ds_read_b64_tr_b16 a[214:215], v240 offset:1544
    v_cvt_pk_bf16_f32 v128, v128, v129
    v_exp_f32 v137, v137
    s_waitcnt lgkmcnt(6)
    v_mfma_f32_16x16x32_bf16 a[16:19], a[200:203], v[96:99], 0
    ds_read_b64_tr_b16 a[192:193], v240 offset:1088
    v_mfma_f32_16x16x32_bf16 a[24:27], a[200:203], v[104:107], 0
    ds_read_b64_tr_b16 a[194:195], v240 offset:1600
    v_cvt_pk_bf16_f32 v136, v136, v137
    v_fma_f32 v130, v130, s20, v248
    s_waitcnt lgkmcnt(6)
    v_mfma_f32_16x16x32_bf16 a[20:23], a[204:207], v[96:99], 0
    buffer_load_dwordx4 v[76:79], v245, s[4:7], s43 offen offset:3200 nt
    ds_read_b64_tr_b16 a[196:197], v240 offset:1096
    v_fma_f32 v131, v131, s20, v248
    v_mfma_f32_16x16x32_bf16 a[28:31], a[204:207], v[104:107], 0
    ds_read_b64_tr_b16 a[198:199], v240 offset:1608
    v_fma_f32 v138, v138, s20, v249
    s_waitcnt lgkmcnt(6)
    v_mfma_f32_16x16x32_bf16 a[32:35], a[208:211], v[96:99], 0
    ds_read_b64_tr_b16 a[200:201], v240 offset:2048
    v_exp_f32 v130, v130
    v_mfma_f32_16x16x32_bf16 a[40:43], a[208:211], v[104:107], 0
    ds_read_b64_tr_b16 a[202:203], v240 offset:2560
    v_fma_f32 v139, v139, s20, v249
    s_waitcnt lgkmcnt(6)
    v_mfma_f32_16x16x32_bf16 a[36:39], a[212:215], v[96:99], 0
    ds_read_b64_tr_b16 a[204:205], v240 offset:2056
    v_exp_f32 v131, v131
    v_mfma_f32_16x16x32_bf16 a[44:47], a[212:215], v[104:107], 0
    ds_read_b64_tr_b16 a[206:207], v240 offset:2568
    v_exp_f32 v138, v138
    s_waitcnt lgkmcnt(6)
    v_mfma_f32_16x16x32_bf16 v[0:3], a[192:195], v[96:99], 0
    ds_read_b64_tr_b16 a[208:209], v240 offset:2112
    v_cvt_pk_bf16_f32 v129, v130, v131
    v_mfma_f32_16x16x32_bf16 v[8:11], a[192:195], v[104:107], 0
    ds_read_b64_tr_b16 a[210:211], v240 offset:2624
    v_exp_f32 v139, v139
    s_waitcnt lgkmcnt(6)
    v_mfma_f32_16x16x32_bf16 v[4:7], a[196:199], v[96:99], 0
    buffer_load_dwordx4 v[80:83], v244, s[4:7], s42 offen offset:256 nt
    ds_read_b64_tr_b16 a[212:213], v240 offset:2120
    v_mfma_f32_16x16x32_bf16 v[12:15], a[196:199], v[104:107], 0
    ds_read_b64_tr_b16 a[214:215], v240 offset:2632
    v_cvt_pk_bf16_f32 v137, v138, v139
    s_waitcnt lgkmcnt(6)
    v_mfma_f32_16x16x32_bf16 v[16:19], a[200:203], v[96:99], 0
    ds_read_b128 a[192:195], v236 offset:24576
    v_fma_f32 v132, v132, s20, v248
    v_mfma_f32_16x16x32_bf16 v[24:27], a[200:203], v[104:107], 0
    v_fma_f32 v133, v133, s20, v248
    s_waitcnt lgkmcnt(5)
    v_mfma_f32_16x16x32_bf16 v[20:23], a[204:207], v[96:99], 0
    ds_read_b128 a[196:199], v237 offset:24576
    v_mfma_f32_16x16x32_bf16 v[28:31], a[204:207], v[104:107], 0
    v_fma_f32 v134, v134, s20, v248
    v_exp_f32 v132, v132
    v_fma_f32 v135, v135, s20, v248
    v_exp_f32 v133, v133
    s_waitcnt lgkmcnt(4)
    v_mfma_f32_16x16x32_bf16 v[32:35], a[208:211], v[96:99], 0
    ds_read_b128 a[200:203], v236 offset:25600
    v_fma_f32 v140, v140, s20, v249
    v_mfma_f32_16x16x32_bf16 v[40:43], a[208:211], v[104:107], 0
    v_exp_f32 v134, v134
    v_fma_f32 v141, v141, s20, v249
    v_cvt_pk_bf16_f32 v130, v132, v133
    v_exp_f32 v135, v135
    s_waitcnt lgkmcnt(3)
    v_mfma_f32_16x16x32_bf16 v[36:39], a[212:215], v[96:99], 0
    buffer_load_dwordx4 v[84:87], v245, s[4:7], s42 offen offset:3328 nt
    ds_read_b128 a[204:207], v237 offset:25600
    v_fma_f32 v142, v142, s20, v249
    v_mfma_f32_16x16x32_bf16 v[44:47], a[212:215], v[104:107], 0
    v_exp_f32 v140, v140
    v_fma_f32 v143, v143, s20, v249
    v_cvt_pk_bf16_f32 v131, v134, v135
    v_exp_f32 v141, v141
    s_waitcnt lgkmcnt(3)
    v_mfma_f32_16x16x32_bf16 v[96:99], a[192:195], a[96:99], 0
    ds_read_b128 a[208:211], v236 offset:26624
    v_mfma_f32_16x16x32_bf16 v[104:107], a[192:195], a[104:107], 0
    v_exp_f32 v142, v142
    v_cvt_pk_bf16_f32 v138, v140, v141
    s_waitcnt lgkmcnt(3)
    v_mfma_f32_16x16x32_bf16 v[96:99], a[196:199], a[100:103], v[96:99]
    ds_read_b128 a[212:215], v237 offset:26624
    v_exp_f32 v143, v143
    v_mfma_f32_16x16x32_bf16 v[104:107], a[196:199], a[108:111], v[104:107]
    v_cvt_pk_bf16_f32 v139, v142, v143
    s_waitcnt lgkmcnt(3)
    v_mfma_f32_16x16x32_bf16 v[96:99], a[200:203], a[112:115], v[96:99]
    ds_read_b128 a[192:195], v236 offset:30720
    v_mfma_f32_16x16x32_bf16 a[232:235], a[224:227], v[128:131], a[232:235]
    v_mfma_f32_16x16x32_bf16 v[104:107], a[200:203], a[120:123], v[104:107]
    buffer_load_dwordx4 v[88:91], v244, s[4:7], s43 offen offset:256 nt
    s_waitcnt lgkmcnt(3)
    v_mfma_f32_16x16x32_bf16 v[96:99], a[204:207], a[116:119], v[96:99]
    ds_read_b128 a[196:199], v237 offset:30720
    v_mfma_f32_16x16x32_bf16 v[104:107], a[204:207], a[124:127], v[104:107]
    s_waitcnt lgkmcnt(3)
    v_mfma_f32_16x16x32_bf16 v[96:99], a[208:211], a[128:131], v[96:99]
    ds_read_b128 a[200:203], v236 offset:31744
    v_mfma_f32_16x16x32_bf16 a[232:235], a[228:231], v[136:139], a[232:235]
    v_mfma_f32_16x16x32_bf16 v[104:107], a[208:211], a[136:139], v[104:107]
    s_waitcnt lgkmcnt(3)
    v_mfma_f32_16x16x32_bf16 v[96:99], a[212:215], a[132:135], v[96:99]
    ds_read_b128 a[204:207], v237 offset:31744
    v_mfma_f32_16x16x32_bf16 v[104:107], a[212:215], a[140:143], v[104:107]
    s_cmp_eq_u32 s28, s30
    s_cselect_b32 s35, -49664, s37
    s_add_u32 s29, s28, s35
    s_waitcnt lgkmcnt(3)
    v_mfma_f32_16x16x32_bf16 v[100:103], a[192:195], a[96:99], 0
    buffer_load_dwordx4 v[92:95], v245, s[4:7], s43 offen offset:3328 nt
    s_add_u32 s40, s40, 25165824
    s_add_u32 s41, s41, 25165824
    s_add_u32 s42, s42, 25165824
    s_add_u32 s43, s43, 25165824
    ds_read_b128 a[208:211], v236 offset:32768
    v_add_u32 v240, s35, v240
    v_mfma_f32_16x16x32_bf16 v[108:111], a[192:195], a[104:107], 0
    v_fma_f32 v96, v96, s20, v248
    v_fma_f32 v97, v97, s20, v248
    s_waitcnt lgkmcnt(3)
    v_mfma_f32_16x16x32_bf16 v[100:103], a[196:199], a[100:103], v[100:103]
    ds_read_b128 a[212:215], v237 offset:32768
    v_fma_f32 v104, v104, s20, v249
    v_mfma_f32_16x16x32_bf16 v[108:111], a[196:199], a[108:111], v[108:111]
    v_exp_f32 v96, v96
    v_exp_f32 v97, v97
    v_fma_f32 v105, v105, s20, v249
    s_waitcnt lgkmcnt(3)
    v_mfma_f32_16x16x32_bf16 v[100:103], a[200:203], a[112:115], v[100:103]
    ds_read_b64_tr_b16 a[192:193], v240
    v_mfma_f32_16x16x32_bf16 v[108:111], a[200:203], a[120:123], v[108:111]
    ds_read_b64_tr_b16 a[194:195], v240 offset:512
    v_exp_f32 v104, v104
    s_waitcnt lgkmcnt(4)
    v_mfma_f32_16x16x32_bf16 v[100:103], a[204:207], a[116:119], v[100:103]
    ds_read_b64_tr_b16 a[196:197], v240 offset:8
    v_mfma_f32_16x16x32_bf16 v[108:111], a[204:207], a[124:127], v[108:111]
    ds_read_b64_tr_b16 a[198:199], v240 offset:520
    v_cvt_pk_bf16_f32 v96, v96, v97
    v_exp_f32 v105, v105
    s_waitcnt lgkmcnt(5)
    v_mfma_f32_16x16x32_bf16 v[100:103], a[208:211], a[128:131], v[100:103]
    ds_read_b64_tr_b16 a[200:201], v240 offset:64
    v_cvt_pk_bf16_f32 v104, v104, v105
    v_mfma_f32_16x16x32_bf16 v[108:111], a[208:211], a[136:139], v[108:111]
    ds_read_b64_tr_b16 a[202:203], v240 offset:576
    s_waitcnt lgkmcnt(6)
    v_mfma_f32_16x16x32_bf16 v[100:103], a[212:215], a[132:135], v[100:103]
    ds_read_b64_tr_b16 a[204:205], v240 offset:72
    v_fma_f32 v98, v98, s20, v248
    v_mfma_f32_16x16x32_bf16 v[108:111], a[212:215], a[140:143], v[108:111]
    ds_read_b64_tr_b16 a[206:207], v240 offset:584
    v_fma_f32 v99, v99, s20, v248
    v_fma_f32 v106, v106, s20, v249
    s_waitcnt lgkmcnt(6)
    v_mfma_f32_16x16x32_bf16 a[0:3], a[192:195], v[128:131], a[0:3]
    ds_read_b64_tr_b16 a[208:209], v240 offset:1024
    v_fma_f32 v107, v107, s20, v249
    v_mfma_f32_16x16x32_bf16 a[8:11], a[192:195], v[136:139], a[8:11]
    ds_read_b64_tr_b16 a[210:211], v240 offset:1536
    s_waitcnt lgkmcnt(6)
    v_mfma_f32_16x16x32_bf16 a[4:7], a[196:199], v[128:131], a[4:7]
    ds_read_b64_tr_b16 a[212:213], v240 offset:1032
    v_mfma_f32_16x16x32_bf16 a[12:15], a[196:199], v[136:139], a[12:15]
    ds_read_b64_tr_b16 a[214:215], v240 offset:1544
    s_waitcnt lgkmcnt(6)
    v_mfma_f32_16x16x32_bf16 a[16:19], a[200:203], v[128:131], a[16:19]
    ds_read_b64_tr_b16 a[192:193], v240 offset:1088
    v_mfma_f32_16x16x32_bf16 a[24:27], a[200:203], v[136:139], a[24:27]
    ds_read_b64_tr_b16 a[194:195], v240 offset:1600
    v_exp_f32 v98, v98
    s_waitcnt lgkmcnt(6)
    v_mfma_f32_16x16x32_bf16 a[20:23], a[204:207], v[128:131], a[20:23]
    ds_read_b64_tr_b16 a[196:197], v240 offset:1096
    v_mfma_f32_16x16x32_bf16 a[28:31], a[204:207], v[136:139], a[28:31]
    ds_read_b64_tr_b16 a[198:199], v240 offset:1608
    v_fma_f32 v100, v100, s20, v248
    v_exp_f32 v99, v99
    s_nop 0
    v_cvt_pk_bf16_f32 v97, v98, v99
    s_waitcnt lgkmcnt(6)
    v_mfma_f32_16x16x32_bf16 a[32:35], a[208:211], v[128:131], a[32:35]
    ds_read_b64_tr_b16 a[200:201], v240 offset:2048
    v_fma_f32 v101, v101, s20, v248
    v_mfma_f32_16x16x32_bf16 a[40:43], a[208:211], v[136:139], a[40:43]
    ds_read_b64_tr_b16 a[202:203], v240 offset:2560
    v_exp_f32 v106, v106
    s_waitcnt lgkmcnt(6)
    v_mfma_f32_16x16x32_bf16 a[36:39], a[212:215], v[128:131], a[36:39]
    ds_read_b64_tr_b16 a[204:205], v240 offset:2056
    v_fma_f32 v102, v102, s20, v248
    v_mfma_f32_16x16x32_bf16 a[44:47], a[212:215], v[136:139], a[44:47]
    ds_read_b64_tr_b16 a[206:207], v240 offset:2568
    v_fma_f32 v103, v103, s20, v248
    v_exp_f32 v107, v107
    s_nop 0
    v_cvt_pk_bf16_f32 v105, v106, v107
    s_waitcnt lgkmcnt(6)
    v_mfma_f32_16x16x32_bf16 v[0:3], a[192:195], v[128:131], v[0:3]
    ds_read_b64_tr_b16 a[208:209], v240 offset:2112
    v_fma_f32 v108, v108, s20, v249
    v_mfma_f32_16x16x32_bf16 v[8:11], a[192:195], v[136:139], v[8:11]
    ds_read_b64_tr_b16 a[210:211], v240 offset:2624
    s_waitcnt lgkmcnt(6)
    v_mfma_f32_16x16x32_bf16 v[4:7], a[196:199], v[128:131], v[4:7]
    ds_read_b64_tr_b16 a[212:213], v240 offset:2120
    v_fma_f32 v109, v109, s20, v249
    v_mfma_f32_16x16x32_bf16 v[12:15], a[196:199], v[136:139], v[12:15]
    ds_read_b64_tr_b16 a[214:215], v240 offset:2632
    v_fma_f32 v110, v110, s20, v249
    s_waitcnt lgkmcnt(6)
    v_mfma_f32_16x16x32_bf16 v[16:19], a[200:203], v[128:131], v[16:19]
    v_fma_f32 v111, v111, s20, v249
    v_mfma_f32_16x16x32_bf16 v[24:27], a[200:203], v[136:139], v[24:27]
    s_waitcnt lgkmcnt(4)
    v_mfma_f32_16x16x32_bf16 v[20:23], a[204:207], v[128:131], v[20:23]
    v_mfma_f32_16x16x32_bf16 v[28:31], a[204:207], v[136:139], v[28:31]
    v_exp_f32 v100, v100
    s_waitcnt lgkmcnt(2)
    v_mfma_f32_16x16x32_bf16 v[32:35], a[208:211], v[128:131], v[32:35]
    v_mfma_f32_16x16x32_bf16 v[40:43], a[208:211], v[136:139], v[40:43]
    v_exp_f32 v101, v101
    v_exp_f32 v102, v102
    v_cvt_pk_bf16_f32 v98, v100, v101
    s_waitcnt lgkmcnt(0)
    v_mfma_f32_16x16x32_bf16 v[36:39], a[212:215], v[128:131], v[36:39]
    v_mfma_f32_16x16x32_bf16 v[44:47], a[212:215], v[136:139], v[44:47]
    v_exp_f32 v103, v103
    v_exp_f32 v108, v108
    v_cvt_pk_bf16_f32 v99, v102, v103
    s_add_u32 s29, s31, 49664
    v_add_u32 v240, 37248, v240
    s_add_u32 s34, s39, 36864
    s_add_u32 m0, s27, 36864
    s_nop 0
    buffer_load_dwordx4 v241, s[8:11], s34 offen nt lds
    s_add_u32 m0, s27, 37760
    s_nop 0
    buffer_load_dwordx4 v241, s[8:11], s34 offen offset:128 nt lds
    s_add_u32 m0, s27, 38656
    s_nop 0
    buffer_load_dwordx4 v241, s[8:11], s34 offen offset:256 nt lds
    s_waitcnt vmcnt(14)
    ds_write_b128 v246, v[48:51] offset:4096
    s_waitcnt vmcnt(13)
    ds_write_b128 v246, v[52:55] offset:5120
    s_waitcnt vmcnt(12)
    ds_write_b128 v246, v[56:59] offset:6144
    s_waitcnt vmcnt(11)
    ds_write_b128 v246, v[60:63] offset:7168
    ds_read_b128 a[144:147], v238 offset:4096
    ds_read_b128 a[148:151], v239 offset:4096
    ds_read_b128 a[152:155], v238 offset:6144
    ds_read_b128 a[156:159], v239 offset:6144
    s_add_u32 s34, s39, 24576
    s_add_u32 m0, s31, 24832
    s_nop 0
    buffer_load_dwordx4 v242, s[48:51], s34 offen nt lds
    s_add_u32 m0, s31, 25728
    s_nop 0
    buffer_load_dwordx4 v242, s[48:51], s34 offen offset:128 nt lds
    s_add_u32 m0, s31, 26624
    s_nop 0
    buffer_load_dwordx4 v242, s[48:51], s34 offen offset:256 nt lds
    s_waitcnt vmcnt(13)
    ds_write_b128 v246, v[64:67] offset:4096
    s_waitcnt vmcnt(12)
    ds_write_b128 v246, v[68:71] offset:5120
    s_waitcnt vmcnt(11)
    ds_write_b128 v246, v[72:75] offset:6144
    s_waitcnt vmcnt(10)
    ds_write_b128 v246, v[76:79] offset:7168
    ds_read_b128 a[160:163], v238 offset:4096
    ds_read_b128 a[164:167], v239 offset:4096
    ds_read_b128 a[168:171], v238 offset:6144
    ds_read_b128 a[172:175], v239 offset:6144
    s_add_u32 s34, s39, 49152
    s_add_u32 m0, s27, 0
    s_nop 0
    buffer_load_dwordx4 v241, s[8:11], s34 offen nt lds
    s_add_u32 m0, s27, 896
    s_nop 0
    buffer_load_dwordx4 v241, s[8:11], s34 offen offset:128 nt lds
    s_add_u32 m0, s27, 1792
    s_nop 0
    buffer_load_dwordx4 v241, s[8:11], s34 offen offset:256 nt lds
    s_waitcnt vmcnt(12)
    ds_write_b128 v246, v[80:83] offset:4096
    s_waitcnt vmcnt(11)
    ds_write_b128 v246, v[84:87] offset:5120
    s_waitcnt vmcnt(10)
    ds_write_b128 v246, v[88:91] offset:6144
    s_waitcnt vmcnt(9)
    ds_write_b128 v246, v[92:95] offset:7168
    ds_read_b128 a[176:179], v238 offset:4096
    ds_read_b128 a[180:183], v239 offset:4096
    ds_read_b128 a[184:187], v238 offset:6144
    ds_read_b128 a[188:191], v239 offset:6144
    s_add_u32 s34, s39, 36864
    s_add_u32 m0, s31, 37248
    s_nop 0
    buffer_load_dwordx4 v242, s[48:51], s34 offen nt lds
    s_add_u32 m0, s31, 38144
    s_nop 0
    buffer_load_dwordx4 v242, s[48:51], s34 offen offset:128 nt lds
    s_add_u32 m0, s31, 39040
    s_nop 0
    buffer_load_dwordx4 v242, s[48:51], s34 offen offset:256 nt lds
    global_load_dword v247, v247, s[58:59]
    s_add_u32 s58, s36, 50331648
    ds_read_b128 a[192:195], v236 offset:49152
    ds_read_b128 a[196:199], v237 offset:49152
    ds_read_b128 a[200:203], v236 offset:50176
    ds_read_b128 a[204:207], v237 offset:50176
    s_waitcnt lgkmcnt(3)
    v_mfma_f32_16x16x32_bf16 v[112:115], a[192:195], a[144:147], 0
    ds_read_b128 a[208:211], v236 offset:51200
    v_mfma_f32_16x16x32_bf16 v[120:123], a[192:195], a[152:155], 0
    s_waitcnt lgkmcnt(3)
    v_mfma_f32_16x16x32_bf16 v[112:115], a[196:199], a[148:151], v[112:115]
    ds_read_b128 a[212:215], v237 offset:51200
    v_mfma_f32_16x16x32_bf16 v[120:123], a[196:199], a[156:159], v[120:123]
    s_waitcnt lgkmcnt(3)
    v_mfma_f32_16x16x32_bf16 v[112:115], a[200:203], a[160:163], v[112:115]
    ds_read_b128 a[192:195], v236 offset:55296
    v_mfma_f32_16x16x32_bf16 v[120:123], a[200:203], a[168:171], v[120:123]
    s_waitcnt lgkmcnt(3)
    v_mfma_f32_16x16x32_bf16 v[112:115], a[204:207], a[164:167], v[112:115]
    ds_read_b128 a[196:199], v237 offset:55296
    v_mfma_f32_16x16x32_bf16 v[120:123], a[204:207], a[172:175], v[120:123]
    s_waitcnt lgkmcnt(3)
    v_mfma_f32_16x16x32_bf16 v[112:115], a[208:211], a[176:179], v[112:115]
    ds_read_b128 a[200:203], v236 offset:56320
    v_mfma_f32_16x16x32_bf16 v[120:123], a[208:211], a[184:187], v[120:123]
    s_waitcnt lgkmcnt(3)
    v_mfma_f32_16x16x32_bf16 v[112:115], a[212:215], a[180:183], v[112:115]
    ds_read_b128 a[204:207], v237 offset:56320
    v_mfma_f32_16x16x32_bf16 v[120:123], a[212:215], a[188:191], v[120:123]
    s_waitcnt lgkmcnt(3)
    v_mfma_f32_16x16x32_bf16 v[116:119], a[192:195], a[144:147], 0
    ds_read_b128 a[208:211], v236 offset:57344
    v_mfma_f32_16x16x32_bf16 v[124:127], a[192:195], a[152:155], 0
    s_waitcnt lgkmcnt(3)
    v_mfma_f32_16x16x32_bf16 v[116:119], a[196:199], a[148:151], v[116:119]
    ds_read_b128 a[212:215], v237 offset:57344
    v_mfma_f32_16x16x32_bf16 v[124:127], a[196:199], a[156:159], v[124:127]
    s_waitcnt lgkmcnt(3)
    v_mfma_f32_16x16x32_bf16 v[116:119], a[200:203], a[160:163], v[116:119]
    v_mfma_f32_16x16x32_bf16 v[124:127], a[200:203], a[168:171], v[124:127]
    s_waitcnt lgkmcnt(2)
    v_mfma_f32_16x16x32_bf16 v[116:119], a[204:207], a[164:167], v[116:119]
    v_mfma_f32_16x16x32_bf16 v[124:127], a[204:207], a[172:175], v[124:127]
    s_waitcnt lgkmcnt(1)
    v_mfma_f32_16x16x32_bf16 v[116:119], a[208:211], a[176:179], v[116:119]
    v_mfma_f32_16x16x32_bf16 v[124:127], a[208:211], a[184:187], v[124:127]
    s_waitcnt lgkmcnt(0)
    v_mfma_f32_16x16x32_bf16 v[116:119], a[212:215], a[180:183], v[116:119]
    v_mfma_f32_16x16x32_bf16 v[124:127], a[212:215], a[188:191], v[124:127]
    v_max3_f32 v250, v112, v113, v114
    v_max3_f32 v251, v120, v121, v122
    v_max_f32 v250, v250, v115
    v_max_f32 v251, v251, v123
    s_nop 1
    v_permlane32_swap_b32 v250, v251
    v_max_f32 v250, v250, v251
    v_mov_b32 v251, v250
    s_nop 1
    v_permlane16_swap_b32 v250, v251
    v_max_f32 v250, v250, v251
    v_mul_f32 v251, s21, v250
    v_mul_f32 v250, s21, v250
    s_nop 1
    v_permlane32_swap_b32 v250, v251
    v_fma_f32 v112, v112, s20, v250
    v_fma_f32 v113, v113, s20, v250
    v_fma_f32 v120, v120, s20, v251
    v_exp_f32 v112, v112
    v_fma_f32 v121, v121, s20, v251
    v_exp_f32 v113, v113
    ds_read_b128 a[192:195], v236 offset:12288
    v_exp_f32 v120, v120
    v_cvt_pk_bf16_f32 v112, v112, v113
    ds_read_b128 a[196:199], v237 offset:12288
    v_exp_f32 v121, v121
    s_nop 0
    v_cvt_pk_bf16_f32 v120, v120, v121
    ds_read_b128 a[200:203], v236 offset:13312
    v_fma_f32 v114, v114, s20, v250
    v_fma_f32 v115, v115, s20, v250
    v_fma_f32 v122, v122, s20, v251
    ds_read_b128 a[204:207], v237 offset:13312
    v_exp_f32 v114, v114
    v_fma_f32 v123, v123, s20, v251
    v_exp_f32 v115, v115
    ds_read_b128 a[208:211], v236 offset:14336
    v_exp_f32 v122, v122
    v_cvt_pk_bf16_f32 v113, v114, v115
    s_waitcnt lgkmcnt(4)
    v_mfma_f32_16x16x32_bf16 v[144:147], a[192:195], a[144:147], 0
    v_mfma_f32_16x16x32_bf16 v[152:155], a[192:195], a[152:155], 0
    v_exp_f32 v123, v123
    ds_read_b128 a[212:215], v237 offset:14336
    v_cvt_pk_bf16_f32 v121, v122, v123
    s_waitcnt lgkmcnt(4)
    v_mfma_f32_16x16x32_bf16 v[144:147], a[196:199], a[148:151], v[144:147]
    v_mfma_f32_16x16x32_bf16 v[152:155], a[196:199], a[156:159], v[152:155]
    ds_read_b128 a[192:195], v236 offset:18432
    s_waitcnt lgkmcnt(4)
    v_mfma_f32_16x16x32_bf16 v[144:147], a[200:203], a[160:163], v[144:147]
    v_mfma_f32_16x16x32_bf16 v[152:155], a[200:203], a[168:171], v[152:155]
    ds_read_b128 a[196:199], v237 offset:18432
    s_waitcnt lgkmcnt(4)
    v_mfma_f32_16x16x32_bf16 v[144:147], a[204:207], a[164:167], v[144:147]
    v_fma_f32 v116, v116, s20, v250
    v_mfma_f32_16x16x32_bf16 v[152:155], a[204:207], a[172:175], v[152:155]
    ds_read_b128 a[200:203], v236 offset:19456
    v_fma_f32 v117, v117, s20, v250
    s_waitcnt lgkmcnt(4)
    v_mfma_f32_16x16x32_bf16 v[144:147], a[208:211], a[176:179], v[144:147]
    v_mfma_f32_16x16x32_bf16 v[152:155], a[208:211], a[184:187], v[152:155]
    v_fma_f32 v118, v118, s20, v250
    ds_read_b128 a[204:207], v237 offset:19456
    v_exp_f32 v116, v116
    s_cmp_eq_u32 s29, s30
    s_cselect_b32 s35, -49664, s37
    s_waitcnt lgkmcnt(4)
    v_mfma_f32_16x16x32_bf16 v[144:147], a[212:215], a[180:183], v[144:147]
    v_fma_f32 v119, v119, s20, v250
    v_mfma_f32_16x16x32_bf16 v[152:155], a[212:215], a[188:191], v[152:155]
    s_add_u32 s28, s29, s35
    v_exp_f32 v117, v117
    ds_read_b128 a[208:211], v236 offset:20480
    v_add_u32 v240, s35, v240
    s_waitcnt lgkmcnt(4)
    v_mfma_f32_16x16x32_bf16 v[148:151], a[192:195], a[144:147], 0
    v_fma_f32 v124, v124, s20, v251
    v_exp_f32 v118, v118
    v_mfma_f32_16x16x32_bf16 v[156:159], a[192:195], a[152:155], 0
    v_fma_f32 v125, v125, s20, v251
    v_cvt_pk_bf16_f32 v114, v116, v117
    ds_read_b128 a[212:215], v237 offset:20480
    v_exp_f32 v119, v119
    v_fma_f32 v126, v126, s20, v251
    v_exp_f32 v124, v124
    s_waitcnt lgkmcnt(4)
    v_mfma_f32_16x16x32_bf16 v[148:151], a[196:199], a[148:151], v[148:151]
    v_fma_f32 v127, v127, s20, v251
    v_cvt_pk_bf16_f32 v115, v118, v119
    v_mfma_f32_16x16x32_bf16 v[156:159], a[196:199], a[156:159], v[156:159]
    v_exp_f32 v125, v125
    ds_read_b64_tr_b16 a[192:193], v240
    ds_read_b64_tr_b16 a[194:195], v240 offset:512
    s_waitcnt lgkmcnt(5)
    v_mfma_f32_16x16x32_bf16 v[148:151], a[200:203], a[160:163], v[148:151]
    v_mfma_f32_16x16x32_bf16 v[156:159], a[200:203], a[168:171], v[156:159]
    v_exp_f32 v126, v126
    v_cvt_pk_bf16_f32 v122, v124, v125
    ds_read_b64_tr_b16 a[196:197], v240 offset:8
    v_exp_f32 v127, v127
    ds_read_b64_tr_b16 a[198:199], v240 offset:520
    v_cvt_pk_bf16_f32 v123, v126, v127
    s_waitcnt lgkmcnt(6)
    v_mfma_f32_16x16x32_bf16 v[148:151], a[204:207], a[164:167], v[148:151]
    v_mfma_f32_16x16x32_bf16 a[236:239], a[224:227], v[112:115], 0
    v_mfma_f32_16x16x32_bf16 v[156:159], a[204:207], a[172:175], v[156:159]
    v_mfma_f32_16x16x32_bf16 a[236:239], a[228:231], v[120:123], a[236:239]
    ds_read_b64_tr_b16 a[200:201], v240 offset:64
    ds_read_b64_tr_b16 a[202:203], v240 offset:576
    s_waitcnt lgkmcnt(7)
    v_mfma_f32_16x16x32_bf16 v[148:151], a[208:211], a[176:179], v[148:151]
    v_mfma_f32_16x16x32_bf16 v[156:159], a[208:211], a[184:187], v[156:159]
    ds_read_b64_tr_b16 a[204:205], v240 offset:72
    ds_read_b64_tr_b16 a[206:207], v240 offset:584
    s_waitcnt lgkmcnt(8)
    v_mfma_f32_16x16x32_bf16 v[148:151], a[212:215], a[180:183], v[148:151]
    s_barrier
    v_mfma_f32_16x16x32_bf16 v[156:159], a[212:215], a[188:191], v[156:159]
    ds_read_b64_tr_b16 a[208:209], v240 offset:1024
    v_fma_f32 v144, v144, s20, v250
    ds_read_b64_tr_b16 a[210:211], v240 offset:1536
    s_add_u32 m0, s29, 0
    s_waitcnt lgkmcnt(8)
    v_mfma_f32_16x16x32_bf16 a[48:51], a[192:195], v[112:115], 0
    buffer_load_dwordx4 v242, s[48:51], s26 offen nt lds
    v_mfma_f32_16x16x32_bf16 a[56:59], a[192:195], v[120:123], 0
    ds_read_b64_tr_b16 a[212:213], v240 offset:1032
    v_fma_f32 v145, v145, s20, v250
    ds_read_b64_tr_b16 a[214:215], v240 offset:1544
    s_waitcnt lgkmcnt(8)
    v_mfma_f32_16x16x32_bf16 a[52:55], a[196:199], v[112:115], 0
    v_mfma_f32_16x16x32_bf16 a[60:63], a[196:199], v[120:123], 0
    v_fma_f32 v152, v152, s20, v251
    ds_read_b64_tr_b16 a[192:193], v240 offset:1088
    v_exp_f32 v144, v144
    ds_read_b64_tr_b16 a[194:195], v240 offset:1600
    v_fma_f32 v153, v153, s20, v251
    s_waitcnt lgkmcnt(8)
    v_mfma_f32_16x16x32_bf16 a[64:67], a[200:203], v[112:115], 0
    v_exp_f32 v145, v145
    v_mfma_f32_16x16x32_bf16 a[72:75], a[200:203], v[120:123], 0
    v_exp_f32 v152, v152
    ds_read_b64_tr_b16 a[196:197], v240 offset:1096
    ds_read_b64_tr_b16 a[198:199], v240 offset:1608
    v_cvt_pk_bf16_f32 v144, v144, v145
    s_waitcnt lgkmcnt(8)
    v_mfma_f32_16x16x32_bf16 a[68:71], a[204:207], v[112:115], 0
    v_exp_f32 v153, v153
    v_mfma_f32_16x16x32_bf16 a[76:79], a[204:207], v[120:123], 0
    ds_read_b64_tr_b16 a[200:201], v240 offset:2048
    ds_read_b64_tr_b16 a[202:203], v240 offset:2560
    s_add_u32 m0, s29, 896
    s_waitcnt lgkmcnt(8)
    v_mfma_f32_16x16x32_bf16 a[80:83], a[208:211], v[112:115], 0
    buffer_load_dwordx4 v242, s[48:51], s26 offen offset:128 nt lds
    v_mfma_f32_16x16x32_bf16 a[88:91], a[208:211], v[120:123], 0
    v_cvt_pk_bf16_f32 v152, v152, v153
    ds_read_b64_tr_b16 a[204:205], v240 offset:2056
    ds_read_b64_tr_b16 a[206:207], v240 offset:2568
    v_fma_f32 v146, v146, s20, v250
    s_waitcnt lgkmcnt(8)
    v_mfma_f32_16x16x32_bf16 a[84:87], a[212:215], v[112:115], 0
    v_mfma_f32_16x16x32_bf16 a[92:95], a[212:215], v[120:123], 0
    v_fma_f32 v147, v147, s20, v250
    s_add_u32 m0, s38, 0
    s_nop 0
    buffer_load_dwordx4 v244, s[4:7], s40 offen nt lds
    ds_read_b64_tr_b16 a[208:209], v240 offset:2112
    ds_read_b64_tr_b16 a[210:211], v240 offset:2624
    s_waitcnt lgkmcnt(8)
    v_mfma_f32_16x16x32_bf16 v[48:51], a[192:195], v[112:115], 0
    v_mfma_f32_16x16x32_bf16 v[56:59], a[192:195], v[120:123], 0
    ds_read_b64_tr_b16 a[212:213], v240 offset:2120
    v_fma_f32 v154, v154, s20, v251
    ds_read_b64_tr_b16 a[214:215], v240 offset:2632
    v_exp_f32 v146, v146
    s_waitcnt lgkmcnt(8)
    v_mfma_f32_16x16x32_bf16 v[52:55], a[196:199], v[112:115], 0
    v_fma_f32 v155, v155, s20, v251
    v_mfma_f32_16x16x32_bf16 v[60:63], a[196:199], v[120:123], 0
    v_exp_f32 v147, v147
    ds_read_b128 a[192:195], v236 offset:24576
    s_add_u32 m0, s29, 1792
    v_exp_f32 v154, v154
    s_waitcnt lgkmcnt(7)
    v_mfma_f32_16x16x32_bf16 v[64:67], a[200:203], v[112:115], 0
    buffer_load_dwordx4 v242, s[48:51], s26 offen offset:256 nt lds
    v_mfma_f32_16x16x32_bf16 v[72:75], a[200:203], v[120:123], 0
    v_cvt_pk_bf16_f32 v145, v146, v147
    ds_read_b128 a[196:199], v237 offset:24576
    v_exp_f32 v155, v155
    s_waitcnt lgkmcnt(6)
    v_mfma_f32_16x16x32_bf16 v[68:71], a[204:207], v[112:115], 0
    v_cvt_pk_bf16_f32 v153, v154, v155
    v_mfma_f32_16x16x32_bf16 v[76:79], a[204:207], v[120:123], 0
    s_add_u32 m0, s38, 4096
    s_nop 0
    buffer_load_dwordx4 v244, s[4:7], s42 offen nt lds
    ds_read_b128 a[200:203], v236 offset:25600
    s_waitcnt lgkmcnt(5)
    v_mfma_f32_16x16x32_bf16 v[80:83], a[208:211], v[112:115], 0
    v_mfma_f32_16x16x32_bf16 v[88:91], a[208:211], v[120:123], 0
    s_add_u32 s26, s25, 12288
    ds_read_b128 a[204:207], v237 offset:25600
    s_waitcnt lgkmcnt(4)
    v_mfma_f32_16x16x32_bf16 v[84:87], a[212:215], v[112:115], 0
    v_mfma_f32_16x16x32_bf16 v[92:95], a[212:215], v[120:123], 0
    ds_read_b128 a[208:211], v236 offset:26624
    v_fma_f32 v148, v148, s20, v250
    s_add_u32 m0, s27, 12288
    s_waitcnt lgkmcnt(4)
    v_mfma_f32_16x16x32_bf16 v[112:115], a[192:195], a[144:147], 0
    buffer_load_dwordx4 v241, s[8:11], s25 offen nt lds
    v_mfma_f32_16x16x32_bf16 v[120:123], a[192:195], a[152:155], 0
    v_fma_f32 v149, v149, s20, v250
    ds_read_b128 a[212:215], v237 offset:26624
    v_fma_f32 v150, v150, s20, v250
    v_exp_f32 v148, v148
    s_waitcnt lgkmcnt(4)
    v_mfma_f32_16x16x32_bf16 v[112:115], a[196:199], a[148:151], v[112:115]
    v_fma_f32 v151, v151, s20, v250
    v_mfma_f32_16x16x32_bf16 v[120:123], a[196:199], a[156:159], v[120:123]
    v_exp_f32 v149, v149
    s_add_u32 m0, s38, -2048
    s_nop 0
    buffer_load_dwordx4 v245, s[4:7], s40 offen offset:3072 nt lds
    ds_read_b128 a[192:195], v236 offset:30720
    v_fma_f32 v156, v156, s20, v251
    v_exp_f32 v150, v150
    s_waitcnt lgkmcnt(4)
    v_mfma_f32_16x16x32_bf16 v[112:115], a[200:203], a[160:163], v[112:115]
    v_mfma_f32_16x16x32_bf16 v[120:123], a[200:203], a[168:171], v[120:123]
    v_fma_f32 v157, v157, s20, v251
    v_cvt_pk_bf16_f32 v146, v148, v149
    ds_read_b128 a[196:199], v237 offset:30720
    v_exp_f32 v151, v151
    v_fma_f32 v158, v158, s20, v251
    v_exp_f32 v156, v156
    s_waitcnt lgkmcnt(4)
    v_mfma_f32_16x16x32_bf16 v[112:115], a[204:207], a[164:167], v[112:115]
    v_fma_f32 v159, v159, s20, v251
    v_cvt_pk_bf16_f32 v147, v150, v151
    v_mfma_f32_16x16x32_bf16 v[120:123], a[204:207], a[172:175], v[120:123]
    v_exp_f32 v157, v157
    ds_read_b128 a[200:203], v236 offset:31744
    s_add_u32 m0, s27, 13184
    v_exp_f32 v158, v158
    s_waitcnt lgkmcnt(4)
    v_mfma_f32_16x16x32_bf16 v[112:115], a[208:211], a[176:179], v[112:115]
    buffer_load_dwordx4 v241, s[8:11], s25 offen offset:128 nt lds
    v_mfma_f32_16x16x32_bf16 v[120:123], a[208:211], a[184:187], v[120:123]
    v_cvt_pk_bf16_f32 v154, v156, v157
    v_exp_f32 v159, v159
    ds_read_b128 a[204:207], v237 offset:31744
    v_cvt_pk_bf16_f32 v155, v158, v159
    s_cmp_eq_u32 s28, s30
    s_cselect_b32 s35, -49664, s37
    s_waitcnt lgkmcnt(4)
    v_mfma_f32_16x16x32_bf16 v[112:115], a[212:215], a[180:183], v[112:115]
    v_mfma_f32_16x16x32_bf16 a[236:239], a[224:227], v[144:147], a[236:239]
    v_mfma_f32_16x16x32_bf16 v[120:123], a[212:215], a[188:191], v[120:123]
    s_add_u32 s29, s28, s35
    s_add_u32 m0, s38, 2048
    s_nop 0
    buffer_load_dwordx4 v245, s[4:7], s42 offen offset:3072 nt lds
    ds_read_b128 a[208:211], v236 offset:32768
    v_add_u32 v240, s35, v240
    v_mfma_f32_16x16x32_bf16 a[236:239], a[228:231], v[152:155], a[236:239]
    s_waitcnt lgkmcnt(4)
    v_mfma_f32_16x16x32_bf16 v[116:119], a[192:195], a[144:147], 0
    v_mfma_f32_16x16x32_bf16 v[124:127], a[192:195], a[152:155], 0
    ds_read_b128 a[212:215], v237 offset:32768
    s_waitcnt lgkmcnt(4)
    v_mfma_f32_16x16x32_bf16 v[116:119], a[196:199], a[148:151], v[116:119]
    v_mfma_f32_16x16x32_bf16 v[124:127], a[196:199], a[156:159], v[124:127]
    ds_read_b64_tr_b16 a[192:193], v240
    v_fma_f32 v112, v112, s20, v250
    ds_read_b64_tr_b16 a[194:195], v240 offset:512
    s_add_u32 m0, s27, 14080
    s_waitcnt lgkmcnt(5)
    v_mfma_f32_16x16x32_bf16 v[116:119], a[200:203], a[160:163], v[116:119]
    buffer_load_dwordx4 v241, s[8:11], s25 offen offset:256 nt lds
    v_mfma_f32_16x16x32_bf16 v[124:127], a[200:203], a[168:171], v[124:127]
    ds_read_b64_tr_b16 a[196:197], v240 offset:8
    v_fma_f32 v113, v113, s20, v250
    ds_read_b64_tr_b16 a[198:199], v240 offset:520
    s_waitcnt lgkmcnt(6)
    v_mfma_f32_16x16x32_bf16 v[116:119], a[204:207], a[164:167], v[116:119]
    v_mfma_f32_16x16x32_bf16 v[124:127], a[204:207], a[172:175], v[124:127]
    v_fma_f32 v120, v120, s20, v251
    s_add_u32 m0, s38, 2048
    s_nop 0
    buffer_load_dwordx4 v244, s[4:7], s41 offen nt lds
    ds_read_b64_tr_b16 a[200:201], v240 offset:64
    ds_read_b64_tr_b16 a[202:203], v240 offset:576
    v_fma_f32 v121, v121, s20, v251
    s_waitcnt lgkmcnt(7)
    v_mfma_f32_16x16x32_bf16 v[116:119], a[208:211], a[176:179], v[116:119]
    v_mfma_f32_16x16x32_bf16 v[124:127], a[208:211], a[184:187], v[124:127]
    v_exp_f32 v112, v112
    ds_read_b64_tr_b16 a[204:205], v240 offset:72
    ds_read_b64_tr_b16 a[206:207], v240 offset:584
    s_waitcnt lgkmcnt(8)
    v_mfma_f32_16x16x32_bf16 v[116:119], a[212:215], a[180:183], v[116:119]
    s_waitcnt vmcnt(18)
    s_barrier
    v_mfma_f32_16x16x32_bf16 v[124:127], a[212:215], a[188:191], v[124:127]
    ds_read_b64_tr_b16 a[208:209], v240 offset:1024
    ds_read_b64_tr_b16 a[210:211], v240 offset:1536
    s_add_u32 m0, s28, 0
    s_waitcnt lgkmcnt(8)
    v_mfma_f32_16x16x32_bf16 a[48:51], a[192:195], v[144:147], a[48:51]
    buffer_load_dwordx4 v242, s[48:51], s25 offen nt lds
    v_mfma_f32_16x16x32_bf16 a[56:59], a[192:195], v[152:155], a[56:59]
    v_exp_f32 v113, v113
    ds_read_b64_tr_b16 a[212:213], v240 offset:1032
    v_cvt_pk_bf16_f32 v112, v112, v113
    ds_read_b64_tr_b16 a[214:215], v240 offset:1544
    v_fma_f32 v114, v114, s20, v250
    s_waitcnt lgkmcnt(8)
    v_mfma_f32_16x16x32_bf16 a[52:55], a[196:199], v[144:147], a[52:55]
    v_exp_f32 v120, v120
    v_mfma_f32_16x16x32_bf16 a[60:63], a[196:199], v[152:155], a[60:63]
    v_fma_f32 v115, v115, s20, v250
    s_add_u32 m0, s38, 6144
    s_nop 0
    buffer_load_dwordx4 v244, s[4:7], s43 offen nt lds
    ds_read_b64_tr_b16 a[192:193], v240 offset:1088
    v_fma_f32 v122, v122, s20, v251
    ds_read_b64_tr_b16 a[194:195], v240 offset:1600
    v_fma_f32 v123, v123, s20, v251
    s_waitcnt lgkmcnt(8)
    v_mfma_f32_16x16x32_bf16 a[64:67], a[200:203], v[144:147], a[64:67]
    v_exp_f32 v121, v121
    v_mfma_f32_16x16x32_bf16 a[72:75], a[200:203], v[152:155], a[72:75]
    ds_read_b64_tr_b16 a[196:197], v240 offset:1096
    v_cvt_pk_bf16_f32 v120, v120, v121
    ds_read_b64_tr_b16 a[198:199], v240 offset:1608
    s_waitcnt lgkmcnt(8)
    v_mfma_f32_16x16x32_bf16 a[68:71], a[204:207], v[144:147], a[68:71]
    v_mfma_f32_16x16x32_bf16 a[76:79], a[204:207], v[152:155], a[76:79]
    ds_read_b64_tr_b16 a[200:201], v240 offset:2048
    ds_read_b64_tr_b16 a[202:203], v240 offset:2560
    s_add_u32 m0, s28, 896
    s_waitcnt lgkmcnt(8)
    v_mfma_f32_16x16x32_bf16 a[80:83], a[208:211], v[144:147], a[80:83]
    buffer_load_dwordx4 v242, s[48:51], s25 offen offset:128 nt lds
    v_mfma_f32_16x16x32_bf16 a[88:91], a[208:211], v[152:155], a[88:91]
    ds_read_b64_tr_b16 a[204:205], v240 offset:2056
    ds_read_b64_tr_b16 a[206:207], v240 offset:2568
    s_waitcnt lgkmcnt(8)
    v_mfma_f32_16x16x32_bf16 a[84:87], a[212:215], v[144:147], a[84:87]
    v_mfma_f32_16x16x32_bf16 a[92:95], a[212:215], v[152:155], a[92:95]
    s_add_u32 m0, s38, 0
    s_nop 0
    buffer_load_dwordx4 v245, s[4:7], s41 offen offset:3072 nt lds
    ds_read_b64_tr_b16 a[208:209], v240 offset:2112
    ds_read_b64_tr_b16 a[210:211], v240 offset:2624
    s_waitcnt lgkmcnt(8)
    v_mfma_f32_16x16x32_bf16 v[48:51], a[192:195], v[144:147], v[48:51]
    v_mfma_f32_16x16x32_bf16 v[56:59], a[192:195], v[152:155], v[56:59]
    v_exp_f32 v114, v114
    ds_read_b64_tr_b16 a[212:213], v240 offset:2120
    ds_read_b64_tr_b16 a[214:215], v240 offset:2632
    s_waitcnt lgkmcnt(8)
    v_mfma_f32_16x16x32_bf16 v[52:55], a[196:199], v[144:147], v[52:55]
    v_exp_f32 v115, v115
    v_mfma_f32_16x16x32_bf16 v[60:63], a[196:199], v[152:155], v[60:63]
    v_cvt_pk_bf16_f32 v113, v114, v115
    ds_read_b128 a[192:195], v236 offset:36864
    s_add_u32 m0, s28, 1792
    v_fma_f32 v116, v116, s20, v250
    s_waitcnt lgkmcnt(7)
    v_mfma_f32_16x16x32_bf16 v[64:67], a[200:203], v[144:147], v[64:67]
    buffer_load_dwordx4 v242, s[48:51], s25 offen offset:256 nt lds
    v_mfma_f32_16x16x32_bf16 v[72:75], a[200:203], v[152:155], v[72:75]
    v_exp_f32 v122, v122
    ds_read_b128 a[196:199], v237 offset:36864
    v_fma_f32 v117, v117, s20, v250
    v_exp_f32 v123, v123
    s_waitcnt lgkmcnt(6)
    v_mfma_f32_16x16x32_bf16 v[68:71], a[204:207], v[144:147], v[68:71]
    v_mfma_f32_16x16x32_bf16 v[76:79], a[204:207], v[152:155], v[76:79]
    v_cvt_pk_bf16_f32 v121, v122, v123
    ds_read_b128 a[200:203], v236 offset:37888
    v_fma_f32 v118, v118, s20, v250
    s_waitcnt lgkmcnt(5)
    v_mfma_f32_16x16x32_bf16 v[80:83], a[208:211], v[144:147], v[80:83]
    v_mfma_f32_16x16x32_bf16 v[88:91], a[208:211], v[152:155], v[88:91]
    s_add_u32 s25, s26, 12288
    ds_read_b128 a[204:207], v237 offset:37888
    v_fma_f32 v119, v119, s20, v250
    s_waitcnt lgkmcnt(4)
    v_mfma_f32_16x16x32_bf16 v[84:87], a[212:215], v[144:147], v[84:87]
    v_mfma_f32_16x16x32_bf16 v[92:95], a[212:215], v[152:155], v[92:95]
    s_branch L_join
.p2align 6
L_body:
    s_waitcnt lgkmcnt(2)
    v_mfma_f32_16x16x32_bf16 v[128:131], a[192:195], a[96:99], 0
    ds_read_b128 a[208:211], v236 offset:14336
    v_exp_f32 v122, v122
    v_cvt_pk_bf16_f32 v202, v220, v221
    v_cvt_pk_bf16_f32 v203, v222, v223
    v_accvgpr_read_b32 v216, a72
    v_mfma_f32_16x16x32_bf16 v[136:139], a[192:195], a[104:107], 0
    s_add_u32 m0, s27, 0
    v_fma_f32 v101, v101, s20, v248
    v_cvt_pk_bf16_f32 v113, v114, v115
    v_accvgpr_read_b32 v217, a73
    v_accvgpr_read_b32 v218, a74
    v_accvgpr_read_b32 v219, a75
    v_mfma_f32_16x16x32_bf16 v[144:147], a[192:195], a[144:147], 0
    buffer_load_dwordx4 v241, s[8:11], s26 offen nt lds
    v_mul_f32 v216, v216, v255
    v_mul_f32 v217, v217, v255
    v_mfma_f32_16x16x32_bf16 v[152:155], a[192:195], a[152:155], 0
    v_exp_f32 v123, v123
    v_fma_f32 v102, v102, s20, v248
    v_mul_f32 v218, v218, v255
    v_mul_f32 v219, v219, v255
    v_cvt_pk_bf16_f32 v204, v216, v217
    v_cvt_pk_bf16_f32 v205, v218, v219
    v_mfma_f32_16x16x32_bf16 v[128:131], a[196:199], a[100:103], v[128:131]
    ds_read_b128 a[212:215], v237 offset:14336
    v_exp_f32 v100, v100
    v_accvgpr_read_b32 v220, a76
    v_accvgpr_read_b32 v221, a77
    v_accvgpr_read_b32 v222, a78
    v_mfma_f32_16x16x32_bf16 v[136:139], a[196:199], a[108:111], v[136:139]
    v_fma_f32 v103, v103, s20, v248
    v_cvt_pk_bf16_f32 v121, v122, v123
    v_accvgpr_read_b32 v223, a79
    v_mul_f32 v220, v220, v255
    v_mul_f32 v221, v221, v255
    v_mul_f32 v222, v222, v255
    v_mfma_f32_16x16x32_bf16 v[144:147], a[196:199], a[148:151], v[144:147]
    v_exp_f32 v101, v101
    v_mul_f32 v223, v223, v255
    v_cvt_pk_bf16_f32 v206, v220, v221
    v_cvt_pk_bf16_f32 v207, v222, v223
    v_accvgpr_read_b32 v184, a32
    v_mfma_f32_16x16x32_bf16 v[152:155], a[196:199], a[156:159], v[152:155]
    v_fma_f32 v108, v108, s20, v249
    v_exp_f32 v102, v102
    v_accvgpr_read_b32 v185, a33
    v_accvgpr_read_b32 v186, a34
    s_waitcnt lgkmcnt(2)
    v_mfma_f32_16x16x32_bf16 v[128:131], a[200:203], a[112:115], v[128:131]
    ds_read_b128 a[192:195], v236 offset:18432
    v_fma_f32 v109, v109, s20, v249
    v_accvgpr_read_b32 v187, a35
    v_mul_f32 v184, v184, v252
    v_mul_f32 v185, v185, v252
    v_mul_f32 v186, v186, v252
    v_mfma_f32_16x16x32_bf16 v[136:139], a[200:203], a[120:123], v[136:139]
    s_add_u32 m0, s38, 2048
    v_cvt_pk_bf16_f32 v98, v100, v101
    v_mul_f32 v187, v187, v252
    v_cvt_pk_bf16_f32 v176, v184, v185
    v_cvt_pk_bf16_f32 v177, v186, v187
    v_accvgpr_read_b32 v188, a36
    v_mfma_f32_16x16x32_bf16 v[144:147], a[200:203], a[160:163], v[144:147]
    buffer_load_dwordx4 v245, s[4:7], s42 offen offset:3072 nt lds
    v_accvgpr_read_b32 v189, a37
    v_accvgpr_read_b32 v190, a38
    v_mfma_f32_16x16x32_bf16 v[152:155], a[200:203], a[168:171], v[152:155]
    v_exp_f32 v103, v103
    v_fma_f32 v110, v110, s20, v249
    v_accvgpr_read_b32 v191, a39
    v_mul_f32 v188, v188, v252
    v_mul_f32 v189, v189, v252
    v_mul_f32 v190, v190, v252
    v_mfma_f32_16x16x32_bf16 v[128:131], a[204:207], a[116:119], v[128:131]
    ds_read_b128 a[196:199], v237 offset:18432
    v_exp_f32 v108, v108
    v_mul_f32 v191, v191, v252
    v_cvt_pk_bf16_f32 v178, v188, v189
    v_cvt_pk_bf16_f32 v179, v190, v191
    v_mfma_f32_16x16x32_bf16 v[136:139], a[204:207], a[124:127], v[136:139]
    v_fma_f32 v111, v111, s20, v249
    v_cvt_pk_bf16_f32 v99, v102, v103
    v_accvgpr_read_b32 v184, a40
    v_accvgpr_read_b32 v185, a41
    v_accvgpr_read_b32 v186, a42
    v_accvgpr_read_b32 v187, a43
    v_mfma_f32_16x16x32_bf16 v[144:147], a[204:207], a[164:167], v[144:147]
    v_exp_f32 v109, v109
    v_fma_f32 v116, v116, s20, v250
    v_mul_f32 v184, v184, v253
    v_mul_f32 v185, v185, v253
    v_mul_f32 v186, v186, v253
    v_mfma_f32_16x16x32_bf16 v[152:155], a[204:207], a[172:175], v[152:155]
    v_exp_f32 v110, v110
    v_mul_f32 v187, v187, v253
    v_cvt_pk_bf16_f32 v180, v184, v185
    v_cvt_pk_bf16_f32 v181, v186, v187
    s_waitcnt lgkmcnt(2)
    v_mfma_f32_16x16x32_bf16 v[128:131], a[208:211], a[128:131], v[128:131]
    ds_read_b128 a[200:203], v236 offset:19456
    v_fma_f32 v117, v117, s20, v250
    v_accvgpr_read_b32 v188, a44
    v_accvgpr_read_b32 v189, a45
    v_accvgpr_read_b32 v190, a46
    v_accvgpr_read_b32 v191, a47
    v_mfma_f32_16x16x32_bf16 v[136:139], a[208:211], a[136:139], v[136:139]
    s_add_u32 m0, s27, 896
    v_cvt_pk_bf16_f32 v106, v108, v109
    v_mul_f32 v188, v188, v253
    v_mul_f32 v189, v189, v253
    v_mul_f32 v190, v190, v253
    v_mul_f32 v191, v191, v253
    v_mfma_f32_16x16x32_bf16 v[144:147], a[208:211], a[176:179], v[144:147]
    buffer_load_dwordx4 v241, s[8:11], s26 offen offset:128 nt lds
    v_cvt_pk_bf16_f32 v182, v188, v189
    v_cvt_pk_bf16_f32 v183, v190, v191
    v_mfma_f32_16x16x32_bf16 v[152:155], a[208:211], a[184:187], v[152:155]
    v_exp_f32 v111, v111
    v_fma_f32 v118, v118, s20, v250
    v_accvgpr_read_b32 v216, a80
    v_accvgpr_read_b32 v217, a81
    v_accvgpr_read_b32 v218, a82
    v_accvgpr_read_b32 v219, a83
    v_mfma_f32_16x16x32_bf16 v[128:131], a[212:215], a[132:135], v[128:131]
    ds_read_b128 a[204:207], v237 offset:19456
    v_exp_f32 v116, v116
    v_mul_f32 v216, v216, v254
    v_mul_f32 v217, v217, v254
    v_mul_f32 v218, v218, v254
    v_mfma_f32_16x16x32_bf16 v[136:139], a[212:215], a[140:143], v[136:139]
    s_cmp_eq_u32 s29, s30
    s_cselect_b32 s35, -49664, s37
    v_mul_f32 v219, v219, v254
    v_cvt_pk_bf16_f32 v208, v216, v217
    v_cvt_pk_bf16_f32 v209, v218, v219
    v_accvgpr_read_b32 v220, a84
    v_mfma_f32_16x16x32_bf16 v[144:147], a[212:215], a[180:183], v[144:147]
    v_fma_f32 v119, v119, s20, v250
    v_cvt_pk_bf16_f32 v107, v110, v111
    v_accvgpr_read_b32 v221, a85
    v_accvgpr_read_b32 v222, a86
    v_accvgpr_read_b32 v223, a87
    v_mul_f32 v220, v220, v254
    v_mfma_f32_16x16x32_bf16 v[152:155], a[212:215], a[188:191], v[152:155]
    s_add_u32 s28, s29, s35
    v_exp_f32 v117, v117
    v_mul_f32 v221, v221, v254
    v_mul_f32 v222, v222, v254
    s_waitcnt lgkmcnt(2)
    v_mfma_f32_16x16x32_bf16 v[132:135], a[192:195], a[96:99], 0
    ds_read_b128 a[208:211], v236 offset:20480
    v_add_u32 v240, s35, v240
    v_mul_f32 v223, v223, v254
    v_cvt_pk_bf16_f32 v210, v220, v221
    v_cvt_pk_bf16_f32 v211, v222, v223
    v_accvgpr_read_b32 v216, a88
    v_mfma_f32_16x16x32_bf16 v[140:143], a[192:195], a[104:107], 0
    v_mfma_f32_16x16x32_bf16 a[232:235], a[224:227], v[96:99], 0
    v_accvgpr_read_b32 v217, a89
    v_accvgpr_read_b32 v218, a90
    v_accvgpr_read_b32 v219, a91
    v_mul_f32 v216, v216, v255
    v_mfma_f32_16x16x32_bf16 v[148:151], a[192:195], a[144:147], 0
    v_fma_f32 v124, v124, s20, v251
    v_exp_f32 v118, v118
    v_mul_f32 v217, v217, v255
    v_mul_f32 v218, v218, v255
    v_mul_f32 v219, v219, v255
    v_mfma_f32_16x16x32_bf16 v[156:159], a[192:195], a[152:155], 0
    v_fma_f32 v125, v125, s20, v251
    v_cvt_pk_bf16_f32 v114, v116, v117
    v_cvt_pk_bf16_f32 v212, v216, v217
    v_cvt_pk_bf16_f32 v213, v218, v219
    v_accvgpr_read_b32 v220, a92
    v_accvgpr_read_b32 v221, a93
    v_accvgpr_read_b32 v222, a94
    v_mfma_f32_16x16x32_bf16 v[132:135], a[196:199], a[100:103], v[132:135]
    ds_read_b128 a[212:215], v237 offset:20480
    v_exp_f32 v119, v119
    v_accvgpr_read_b32 v223, a95
    v_mul_f32 v220, v220, v255
    v_mul_f32 v221, v221, v255
    v_mfma_f32_16x16x32_bf16 v[140:143], a[196:199], a[108:111], v[140:143]
    v_fma_f32 v126, v126, s20, v251
    v_exp_f32 v124, v124
    v_mul_f32 v222, v222, v255
    v_mul_f32 v223, v223, v255
    v_cvt_pk_bf16_f32 v214, v220, v221
    v_mfma_f32_16x16x32_bf16 v[148:151], a[196:199], a[148:151], v[148:151]
    v_fma_f32 v127, v127, s20, v251
    v_cvt_pk_bf16_f32 v115, v118, v119
    v_cvt_pk_bf16_f32 v215, v222, v223
    v_mul_f32 v0, v0, v252
    v_mul_f32 v1, v1, v252
    v_mul_f32 v2, v2, v252
    v_mfma_f32_16x16x32_bf16 v[156:159], a[196:199], a[156:159], v[156:159]
    v_exp_f32 v125, v125
    v_mul_f32 v3, v3, v252
    v_cvt_pk_bf16_f32 v184, v0, v1
    v_cvt_pk_bf16_f32 v185, v2, v3
    s_waitcnt lgkmcnt(2)
    v_mfma_f32_16x16x32_bf16 v[132:135], a[200:203], a[112:115], v[132:135]
    ds_read_b64_tr_b16 a[192:193], v240
    v_mfma_f32_16x16x32_bf16 a[232:235], a[228:231], v[104:107], a[232:235]
    v_mul_f32 v4, v4, v252
    v_mul_f32 v5, v5, v252
    v_mul_f32 v6, v6, v252
    v_mfma_f32_16x16x32_bf16 v[140:143], a[200:203], a[120:123], v[140:143]
    ds_read_b64_tr_b16 a[194:195], v240 offset:512
    s_add_u32 m0, s27, 1792
    v_mul_f32 v7, v7, v252
    v_cvt_pk_bf16_f32 v186, v4, v5
    v_cvt_pk_bf16_f32 v187, v6, v7
    v_mul_f32 v8, v8, v253
    v_mfma_f32_16x16x32_bf16 v[148:151], a[200:203], a[160:163], v[148:151]
    buffer_load_dwordx4 v241, s[8:11], s26 offen offset:256 nt lds
    v_mul_f32 v9, v9, v253
    v_mul_f32 v10, v10, v253
    v_mfma_f32_16x16x32_bf16 v[156:159], a[200:203], a[168:171], v[156:159]
    v_exp_f32 v126, v126
    v_cvt_pk_bf16_f32 v122, v124, v125
    v_mul_f32 v11, v11, v253
    v_cvt_pk_bf16_f32 v188, v8, v9
    v_cvt_pk_bf16_f32 v189, v10, v11
    v_mul_f32 v12, v12, v253
    v_mfma_f32_16x16x32_bf16 v[132:135], a[204:207], a[116:119], v[132:135]
    ds_read_b64_tr_b16 a[196:197], v240 offset:8
    v_exp_f32 v127, v127
    v_mul_f32 v13, v13, v253
    v_mul_f32 v14, v14, v253
    v_mul_f32 v15, v15, v253
    v_mfma_f32_16x16x32_bf16 v[140:143], a[204:207], a[124:127], v[140:143]
    ds_read_b64_tr_b16 a[198:199], v240 offset:520
    v_cvt_pk_bf16_f32 v123, v126, v127
    v_cvt_pk_bf16_f32 v190, v12, v13
    v_cvt_pk_bf16_f32 v191, v14, v15
    v_mul_f32 v48, v48, v254
    v_mul_f32 v49, v49, v254
    v_mfma_f32_16x16x32_bf16 v[148:151], a[204:207], a[164:167], v[148:151]
    v_mfma_f32_16x16x32_bf16 a[236:239], a[224:227], v[112:115], 0
    v_mul_f32 v50, v50, v254
    v_mul_f32 v51, v51, v254
    v_cvt_pk_bf16_f32 v216, v48, v49
    v_cvt_pk_bf16_f32 v217, v50, v51
    v_mfma_f32_16x16x32_bf16 v[156:159], a[204:207], a[172:175], v[156:159]
    v_mfma_f32_16x16x32_bf16 a[236:239], a[228:231], v[120:123], a[236:239]
    v_mul_f32 v52, v52, v254
    v_mul_f32 v53, v53, v254
    v_mul_f32 v54, v54, v254
    s_waitcnt lgkmcnt(4)
    v_mfma_f32_16x16x32_bf16 v[132:135], a[208:211], a[128:131], v[132:135]
    ds_read_b64_tr_b16 a[200:201], v240 offset:64
    v_mul_f32 v55, v55, v254
    v_cvt_pk_bf16_f32 v218, v52, v53
    v_cvt_pk_bf16_f32 v219, v54, v55
    v_mul_f32 v56, v56, v255
    v_fma_f32 v128, v128, s20, v248
    v_mfma_f32_16x16x32_bf16 v[140:143], a[208:211], a[136:139], v[140:143]
    ds_read_b64_tr_b16 a[202:203], v240 offset:576
    s_add_u32 m0, s38, 2048
    v_mul_f32 v57, v57, v255
    v_mul_f32 v58, v58, v255
    v_mul_f32 v59, v59, v255
    v_cvt_pk_bf16_f32 v220, v56, v57
    v_mfma_f32_16x16x32_bf16 v[148:151], a[208:211], a[176:179], v[148:151]
    buffer_load_dwordx4 v244, s[4:7], s41 offen nt lds
    v_cvt_pk_bf16_f32 v221, v58, v59
    v_mul_f32 v60, v60, v255
    v_mfma_f32_16x16x32_bf16 v[156:159], a[208:211], a[184:187], v[156:159]
    v_mul_f32 v61, v61, v255
    v_mul_f32 v62, v62, v255
    v_mul_f32 v63, v63, v255
    v_cvt_pk_bf16_f32 v222, v60, v61
    v_cvt_pk_bf16_f32 v223, v62, v63
    v_fma_f32 v129, v129, s20, v248
    v_fma_f32 v136, v136, s20, v249
    v_mfma_f32_16x16x32_bf16 v[132:135], a[212:215], a[132:135], v[132:135]
    ds_read_b64_tr_b16 a[204:205], v240 offset:72
    v_mul_f32 v16, v16, v252
    v_mul_f32 v17, v17, v252
    v_mul_f32 v18, v18, v252
    v_exp_f32 v128, v128
    v_mfma_f32_16x16x32_bf16 v[140:143], a[212:215], a[140:143], v[140:143]
    ds_read_b64_tr_b16 a[206:207], v240 offset:584
    v_mul_f32 v19, v19, v252
    v_cvt_pk_bf16_f32 v16, v16, v17
    v_cvt_pk_bf16_f32 v17, v18, v19
    v_mul_f32 v20, v20, v252
    v_fma_f32 v137, v137, s20, v249
    v_mfma_f32_16x16x32_bf16 v[148:151], a[212:215], a[180:183], v[148:151]
    s_waitcnt vmcnt(17)
    s_barrier
    v_mul_f32 v21, v21, v252
    v_mul_f32 v22, v22, v252
    v_mul_f32 v23, v23, v252
    v_cvt_pk_bf16_f32 v18, v20, v21
    v_mfma_f32_16x16x32_bf16 v[156:159], a[212:215], a[188:191], v[156:159]
    v_cvt_pk_bf16_f32 v19, v22, v23
    v_mul_f32 v24, v24, v253
    v_mul_f32 v25, v25, v253
    v_exp_f32 v129, v129
    s_waitcnt lgkmcnt(4)
    v_mfma_f32_16x16x32_bf16 a[0:3], a[192:195], v[96:99], 0
    ds_read_b64_tr_b16 a[208:209], v240 offset:1024
    v_mul_f32 v26, v26, v253
    v_mul_f32 v27, v27, v253
    v_cvt_pk_bf16_f32 v20, v24, v25
    v_cvt_pk_bf16_f32 v21, v26, v27
    v_fma_f32 v144, v144, s20, v250
    v_mfma_f32_16x16x32_bf16 a[8:11], a[192:195], v[104:107], 0
    ds_read_b64_tr_b16 a[210:211], v240 offset:1536
    s_add_u32 m0, s29, 0
    v_mul_f32 v28, v28, v253
    v_mul_f32 v29, v29, v253
    v_mul_f32 v30, v30, v253
    v_mul_f32 v31, v31, v253
    v_mfma_f32_16x16x32_bf16 a[48:51], a[192:195], v[112:115], 0
    buffer_load_dwordx4 v242, s[48:51], s26 offen nt lds
    v_cvt_pk_bf16_f32 v22, v28, v29
    v_cvt_pk_bf16_f32 v23, v30, v31
    v_mfma_f32_16x16x32_bf16 a[56:59], a[192:195], v[120:123], 0
    v_mul_f32 v64, v64, v254
    v_mul_f32 v65, v65, v254
    v_mul_f32 v66, v66, v254
    v_mul_f32 v67, v67, v254
    v_cvt_pk_bf16_f32 v64, v64, v65
    v_exp_f32 v136, v136
    v_mfma_f32_16x16x32_bf16 a[4:7], a[196:199], v[96:99], 0
    ds_read_b64_tr_b16 a[212:213], v240 offset:1032
    v_cvt_pk_bf16_f32 v65, v66, v67
    v_mul_f32 v68, v68, v254
    v_mul_f32 v69, v69, v254
    v_mul_f32 v70, v70, v254
    v_fma_f32 v145, v145, s20, v250
    v_mfma_f32_16x16x32_bf16 a[12:15], a[196:199], v[104:107], 0
    ds_read_b64_tr_b16 a[214:215], v240 offset:1544
    v_mul_f32 v71, v71, v254
    v_cvt_pk_bf16_f32 v66, v68, v69
    v_cvt_pk_bf16_f32 v67, v70, v71
    v_mul_f32 v72, v72, v255
    v_cvt_pk_bf16_f32 v128, v128, v129
    v_mfma_f32_16x16x32_bf16 a[52:55], a[196:199], v[112:115], 0
    v_mul_f32 v73, v73, v255
    v_mul_f32 v74, v74, v255
    v_mul_f32 v75, v75, v255
    v_cvt_pk_bf16_f32 v68, v72, v73
    v_exp_f32 v137, v137
    v_mfma_f32_16x16x32_bf16 a[60:63], a[196:199], v[120:123], 0
    v_cvt_pk_bf16_f32 v69, v74, v75
    v_mul_f32 v76, v76, v255
    v_mul_f32 v77, v77, v255
    v_mul_f32 v78, v78, v255
    v_fma_f32 v152, v152, s20, v251
    s_waitcnt lgkmcnt(4)
    v_mfma_f32_16x16x32_bf16 a[16:19], a[200:203], v[96:99], 0
    ds_read_b64_tr_b16 a[192:193], v240 offset:1088
    v_mul_f32 v79, v79, v255
    v_cvt_pk_bf16_f32 v70, v76, v77
    v_cvt_pk_bf16_f32 v71, v78, v79
    v_exp_f32 v144, v144
    v_mfma_f32_16x16x32_bf16 a[24:27], a[200:203], v[104:107], 0
    ds_read_b64_tr_b16 a[194:195], v240 offset:1600
    v_mul_f32 v32, v32, v252
    v_mul_f32 v33, v33, v252
    v_mul_f32 v34, v34, v252
    v_mul_f32 v35, v35, v252
    v_fma_f32 v153, v153, s20, v251
    v_mfma_f32_16x16x32_bf16 a[64:67], a[200:203], v[112:115], 0
    v_cvt_pk_bf16_f32 v32, v32, v33
    v_cvt_pk_bf16_f32 v33, v34, v35
    v_mul_f32 v36, v36, v252
    v_cvt_pk_bf16_f32 v136, v136, v137
    v_exp_f32 v145, v145
    v_mfma_f32_16x16x32_bf16 a[72:75], a[200:203], v[120:123], 0
    v_mul_f32 v37, v37, v252
    v_mul_f32 v38, v38, v252
    v_mul_f32 v39, v39, v252
    v_cvt_pk_bf16_f32 v34, v36, v37
    v_fma_f32 v130, v130, s20, v248
    v_exp_f32 v152, v152
    v_mfma_f32_16x16x32_bf16 a[20:23], a[204:207], v[96:99], 0
    ds_read_b64_tr_b16 a[196:197], v240 offset:1096
    v_cvt_pk_bf16_f32 v35, v38, v39
    v_mul_f32 v40, v40, v253
    v_mul_f32 v41, v41, v253
    v_mul_f32 v42, v42, v253
    v_fma_f32 v131, v131, s20, v248
    v_mfma_f32_16x16x32_bf16 a[28:31], a[204:207], v[104:107], 0
    ds_read_b64_tr_b16 a[198:199], v240 offset:1608
    v_mul_f32 v43, v43, v253
    v_cvt_pk_bf16_f32 v36, v40, v41
    v_cvt_pk_bf16_f32 v37, v42, v43
    v_mul_f32 v44, v44, v253
    v_cvt_pk_bf16_f32 v144, v144, v145
    v_mfma_f32_16x16x32_bf16 a[68:71], a[204:207], v[112:115], 0
    v_mul_f32 v45, v45, v253
    v_mul_f32 v46, v46, v253
    v_mul_f32 v47, v47, v253
    v_cvt_pk_bf16_f32 v38, v44, v45
    v_exp_f32 v153, v153
    v_mfma_f32_16x16x32_bf16 a[76:79], a[204:207], v[120:123], 0
    v_cvt_pk_bf16_f32 v39, v46, v47
    s_mov_b64 vcc, s[12:13]
    v_cndmask_b32_dpp v224, v32, v16, vcc quad_perm:[1,0,3,2] row_mask:0xf bank_mask:0xf
    v_cndmask_b32_dpp v225, v33, v17, vcc quad_perm:[1,0,3,2] row_mask:0xf bank_mask:0xf
    v_fma_f32 v138, v138, s20, v249
    s_waitcnt lgkmcnt(4)
    v_mfma_f32_16x16x32_bf16 a[32:35], a[208:211], v[96:99], 0
    ds_read_b64_tr_b16 a[200:201], v240 offset:2048
    v_cndmask_b32_dpp v226, v34, v18, vcc quad_perm:[1,0,3,2] row_mask:0xf bank_mask:0xf
    v_cndmask_b32_dpp v227, v35, v19, vcc quad_perm:[1,0,3,2] row_mask:0xf bank_mask:0xf
    s_mov_b64 vcc, s[14:15]
    v_exp_f32 v130, v130
    v_mfma_f32_16x16x32_bf16 a[40:43], a[208:211], v[104:107], 0
    ds_read_b64_tr_b16 a[202:203], v240 offset:2560
    s_add_u32 m0, s29, 896
    v_cndmask_b32_dpp v32, v16, v32, vcc quad_perm:[1,0,3,2] row_mask:0xf bank_mask:0xf
    v_cndmask_b32_dpp v33, v17, v33, vcc quad_perm:[1,0,3,2] row_mask:0xf bank_mask:0xf
    v_cndmask_b32_dpp v34, v18, v34, vcc quad_perm:[1,0,3,2] row_mask:0xf bank_mask:0xf
    v_cndmask_b32_dpp v35, v19, v35, vcc quad_perm:[1,0,3,2] row_mask:0xf bank_mask:0xf
    v_mfma_f32_16x16x32_bf16 a[80:83], a[208:211], v[112:115], 0
    buffer_load_dwordx4 v242, s[48:51], s26 offen offset:128 nt lds
    v_accvgpr_write_b32 a252, v32
    v_accvgpr_write_b32 a253, v33
    v_mfma_f32_16x16x32_bf16 a[88:91], a[208:211], v[120:123], 0
    v_accvgpr_write_b32 a254, v34
    v_accvgpr_write_b32 a255, v35
    s_mov_b64 vcc, s[12:13]
    v_cndmask_b32_dpp v40, v36, v20, vcc quad_perm:[1,0,3,2] row_mask:0xf bank_mask:0xf
    v_cndmask_b32_dpp v41, v37, v21, vcc quad_perm:[1,0,3,2] row_mask:0xf bank_mask:0xf
    v_fma_f32 v139, v139, s20, v249
    v_cvt_pk_bf16_f32 v152, v152, v153
    v_mfma_f32_16x16x32_bf16 a[36:39], a[212:215], v[96:99], 0
    ds_read_b64_tr_b16 a[204:205], v240 offset:2056
    v_cndmask_b32_dpp v42, v38, v22, vcc quad_perm:[1,0,3,2] row_mask:0xf bank_mask:0xf
    v_cndmask_b32_dpp v43, v39, v23, vcc quad_perm:[1,0,3,2] row_mask:0xf bank_mask:0xf
    s_mov_b64 vcc, s[14:15]
    v_exp_f32 v131, v131
    v_mfma_f32_16x16x32_bf16 a[44:47], a[212:215], v[104:107], 0
    ds_read_b64_tr_b16 a[206:207], v240 offset:2568
    v_cndmask_b32_dpp v36, v20, v36, vcc quad_perm:[1,0,3,2] row_mask:0xf bank_mask:0xf
    v_cndmask_b32_dpp v37, v21, v37, vcc quad_perm:[1,0,3,2] row_mask:0xf bank_mask:0xf
    v_cndmask_b32_dpp v38, v22, v38, vcc quad_perm:[1,0,3,2] row_mask:0xf bank_mask:0xf
    v_cndmask_b32_dpp v39, v23, v39, vcc quad_perm:[1,0,3,2] row_mask:0xf bank_mask:0xf
    v_fma_f32 v146, v146, s20, v250
    v_mfma_f32_16x16x32_bf16 a[84:87], a[212:215], v[112:115], 0
    v_accvgpr_write_b32 a248, v40
    v_accvgpr_write_b32 a249, v41
    v_accvgpr_write_b32 a250, v42
    v_accvgpr_write_b32 a251, v43
    v_exp_f32 v138, v138
    v_mfma_f32_16x16x32_bf16 a[92:95], a[212:215], v[120:123], 0
    buffer_store_dwordx4 v[36:39], v243, s[16:19], s45 offen offset:640 nt
    v_fma_f32 v147, v147, s20, v250
    s_waitcnt lgkmcnt(4)
    v_mfma_f32_16x16x32_bf16 v[0:3], a[192:195], v[96:99], 0
    ds_read_b64_tr_b16 a[208:209], v240 offset:2112
    v_mul_f32 v80, v80, v254
    v_mul_f32 v81, v81, v254
    v_mul_f32 v82, v82, v254
    v_mul_f32 v83, v83, v254
    v_cvt_pk_bf16_f32 v129, v130, v131
    v_mfma_f32_16x16x32_bf16 v[8:11], a[192:195], v[104:107], 0
    ds_read_b64_tr_b16 a[210:211], v240 offset:2624
    s_add_u32 m0, s38, 6144
    v_cvt_pk_bf16_f32 v80, v80, v81
    v_cvt_pk_bf16_f32 v81, v82, v83
    v_mul_f32 v84, v84, v254
    v_mul_f32 v85, v85, v254
    v_mfma_f32_16x16x32_bf16 v[48:51], a[192:195], v[112:115], 0
    buffer_load_dwordx4 v244, s[4:7], s43 offen nt lds
    v_mul_f32 v86, v86, v254
    v_mul_f32 v87, v87, v254
    v_mfma_f32_16x16x32_bf16 v[56:59], a[192:195], v[120:123], 0
    v_cvt_pk_bf16_f32 v82, v84, v85
    v_cvt_pk_bf16_f32 v83, v86, v87
    v_mul_f32 v88, v88, v255
    v_mul_f32 v89, v89, v255
    v_mul_f32 v90, v90, v255
    v_exp_f32 v139, v139
    v_mfma_f32_16x16x32_bf16 v[4:7], a[196:199], v[96:99], 0
    ds_read_b64_tr_b16 a[212:213], v240 offset:2120
    v_mul_f32 v91, v91, v255
    v_cvt_pk_bf16_f32 v84, v88, v89
    v_cvt_pk_bf16_f32 v85, v90, v91
    v_mul_f32 v92, v92, v255
    v_fma_f32 v154, v154, s20, v251
    v_mfma_f32_16x16x32_bf16 v[12:15], a[196:199], v[104:107], 0
    ds_read_b64_tr_b16 a[214:215], v240 offset:2632
    v_mul_f32 v93, v93, v255
    v_mul_f32 v94, v94, v255
    v_mul_f32 v95, v95, v255
    v_exp_f32 v146, v146
    v_mfma_f32_16x16x32_bf16 v[52:55], a[196:199], v[112:115], 0
    v_cvt_pk_bf16_f32 v86, v92, v93
    v_cvt_pk_bf16_f32 v87, v94, v95
    s_mov_b64 vcc, s[12:13]
    v_cndmask_b32_dpp v228, v80, v64, vcc quad_perm:[1,0,3,2] row_mask:0xf bank_mask:0xf
    v_fma_f32 v155, v155, s20, v251
    v_cvt_pk_bf16_f32 v137, v138, v139
    v_mfma_f32_16x16x32_bf16 v[60:63], a[196:199], v[120:123], 0
    v_cndmask_b32_dpp v229, v81, v65, vcc quad_perm:[1,0,3,2] row_mask:0xf bank_mask:0xf
    v_cndmask_b32_dpp v230, v82, v66, vcc quad_perm:[1,0,3,2] row_mask:0xf bank_mask:0xf
    v_cndmask_b32_dpp v231, v83, v67, vcc quad_perm:[1,0,3,2] row_mask:0xf bank_mask:0xf
    s_mov_b64 vcc, s[14:15]
    v_cndmask_b32_dpp v80, v64, v80, vcc quad_perm:[1,0,3,2] row_mask:0xf bank_mask:0xf
    v_cndmask_b32_dpp v81, v65, v81, vcc quad_perm:[1,0,3,2] row_mask:0xf bank_mask:0xf
    v_cndmask_b32_dpp v82, v66, v82, vcc quad_perm:[1,0,3,2] row_mask:0xf bank_mask:0xf
    v_cndmask_b32_dpp v83, v67, v83, vcc quad_perm:[1,0,3,2] row_mask:0xf bank_mask:0xf
    v_accvgpr_write_b32 a244, v80
    v_accvgpr_write_b32 a245, v81
    v_accvgpr_write_b32 a246, v82
    v_accvgpr_write_b32 a247, v83
    s_mov_b64 vcc, s[12:13]
    v_cndmask_b32_dpp v88, v84, v68, vcc quad_perm:[1,0,3,2] row_mask:0xf bank_mask:0xf
    v_cndmask_b32_dpp v89, v85, v69, vcc quad_perm:[1,0,3,2] row_mask:0xf bank_mask:0xf
    v_cndmask_b32_dpp v90, v86, v70, vcc quad_perm:[1,0,3,2] row_mask:0xf bank_mask:0xf
    v_cndmask_b32_dpp v91, v87, v71, vcc quad_perm:[1,0,3,2] row_mask:0xf bank_mask:0xf
    s_mov_b64 vcc, s[14:15]
    v_cndmask_b32_dpp v84, v68, v84, vcc quad_perm:[1,0,3,2] row_mask:0xf bank_mask:0xf
    v_cndmask_b32_dpp v85, v69, v85, vcc quad_perm:[1,0,3,2] row_mask:0xf bank_mask:0xf
    v_cndmask_b32_dpp v86, v70, v86, vcc quad_perm:[1,0,3,2] row_mask:0xf bank_mask:0xf
    v_cndmask_b32_dpp v87, v71, v87, vcc quad_perm:[1,0,3,2] row_mask:0xf bank_mask:0xf
    v_exp_f32 v147, v147
    s_waitcnt lgkmcnt(4)
    v_mfma_f32_16x16x32_bf16 v[16:19], a[200:203], v[96:99], 0
    ds_read_b128 a[192:195], v236 offset:24576
    v_fma_f32 v132, v132, s20, v248
    v_mfma_f32_16x16x32_bf16 v[24:27], a[200:203], v[104:107], 0
    s_add_u32 m0, s29, 1792
    v_exp_f32 v154, v154
    v_mfma_f32_16x16x32_bf16 v[64:67], a[200:203], v[112:115], 0
    buffer_load_dwordx4 v242, s[48:51], s26 offen offset:256 nt lds
    v_mfma_f32_16x16x32_bf16 v[72:75], a[200:203], v[120:123], 0
    v_fma_f32 v133, v133, s20, v248
    v_cvt_pk_bf16_f32 v145, v146, v147
    v_mfma_f32_16x16x32_bf16 v[20:23], a[204:207], v[96:99], 0
    ds_read_b128 a[196:199], v237 offset:24576
    v_exp_f32 v155, v155
    v_mfma_f32_16x16x32_bf16 v[28:31], a[204:207], v[104:107], 0
    v_accvgpr_write_b32 a240, v88
    v_fma_f32 v134, v134, s20, v248
    v_exp_f32 v132, v132
    v_mfma_f32_16x16x32_bf16 v[68:71], a[204:207], v[112:115], 0
    v_accvgpr_write_b32 a241, v89
    v_accvgpr_write_b32 a242, v90
    v_accvgpr_write_b32 a243, v91
    v_fma_f32 v135, v135, s20, v248
    v_cvt_pk_bf16_f32 v153, v154, v155
    v_mfma_f32_16x16x32_bf16 v[76:79], a[204:207], v[120:123], 0
    buffer_store_dwordx4 v[84:87], v243, s[16:19], s47 offen offset:640 nt
    v_exp_f32 v133, v133
    s_waitcnt lgkmcnt(2)
    v_mfma_f32_16x16x32_bf16 v[32:35], a[208:211], v[96:99], 0
    ds_read_b128 a[200:203], v236 offset:25600
    v_fma_f32 v140, v140, s20, v249
    v_mfma_f32_16x16x32_bf16 v[40:43], a[208:211], v[104:107], 0
    v_exp_f32 v134, v134
    v_mfma_f32_16x16x32_bf16 v[80:83], a[208:211], v[112:115], 0
    v_fma_f32 v141, v141, s20, v249
    v_cvt_pk_bf16_f32 v130, v132, v133
    v_mfma_f32_16x16x32_bf16 v[88:91], a[208:211], v[120:123], 0
    s_add_u32 s26, s25, 12288
    v_exp_f32 v135, v135
    v_mfma_f32_16x16x32_bf16 v[36:39], a[212:215], v[96:99], 0
    ds_read_b128 a[204:207], v237 offset:25600
    v_fma_f32 v142, v142, s20, v249
    v_mfma_f32_16x16x32_bf16 v[44:47], a[212:215], v[104:107], 0
    v_exp_f32 v140, v140
    v_mfma_f32_16x16x32_bf16 v[84:87], a[212:215], v[112:115], 0
    v_fma_f32 v143, v143, s20, v249
    v_cvt_pk_bf16_f32 v131, v134, v135
    v_mfma_f32_16x16x32_bf16 v[92:95], a[212:215], v[120:123], 0
    v_exp_f32 v141, v141
    s_waitcnt lgkmcnt(2)
    v_mfma_f32_16x16x32_bf16 v[96:99], a[192:195], a[96:99], 0
    ds_read_b128 a[208:211], v236 offset:26624
    v_fma_f32 v148, v148, s20, v250
    v_mfma_f32_16x16x32_bf16 v[104:107], a[192:195], a[104:107], 0
    s_add_u32 m0, s27, 12288
    v_exp_f32 v142, v142
    v_mfma_f32_16x16x32_bf16 v[112:115], a[192:195], a[144:147], 0
    buffer_load_dwordx4 v241, s[8:11], s25 offen nt lds
    v_mfma_f32_16x16x32_bf16 v[120:123], a[192:195], a[152:155], 0
    v_fma_f32 v149, v149, s20, v250
    v_cvt_pk_bf16_f32 v138, v140, v141
    v_mfma_f32_16x16x32_bf16 v[96:99], a[196:199], a[100:103], v[96:99]
    ds_read_b128 a[212:215], v237 offset:26624
    v_exp_f32 v143, v143
    v_mfma_f32_16x16x32_bf16 v[104:107], a[196:199], a[108:111], v[104:107]
    v_fma_f32 v150, v150, s20, v250
    v_exp_f32 v148, v148
    v_mfma_f32_16x16x32_bf16 v[112:115], a[196:199], a[148:151], v[112:115]
    v_fma_f32 v151, v151, s20, v250
    v_cvt_pk_bf16_f32 v139, v142, v143
    v_mfma_f32_16x16x32_bf16 v[120:123], a[196:199], a[156:159], v[120:123]
    v_exp_f32 v149, v149
    s_waitcnt lgkmcnt(2)
    v_mfma_f32_16x16x32_bf16 v[96:99], a[200:203], a[112:115], v[96:99]
    ds_read_b128 a[192:195], v236 offset:30720
    v_mfma_f32_16x16x32_bf16 a[232:235], a[224:227], v[128:131], a[232:235]
    v_mfma_f32_16x16x32_bf16 v[104:107], a[200:203], a[120:123], v[104:107]
    v_fma_f32 v156, v156, s20, v251
    v_exp_f32 v150, v150
    v_mfma_f32_16x16x32_bf16 v[112:115], a[200:203], a[160:163], v[112:115]
    buffer_store_dwordx4 v[224:227], v243, s[16:19], s44 offen offset:256 nt
    v_mfma_f32_16x16x32_bf16 v[120:123], a[200:203], a[168:171], v[120:123]
    v_fma_f32 v157, v157, s20, v251
    v_cvt_pk_bf16_f32 v146, v148, v149
    v_mfma_f32_16x16x32_bf16 v[96:99], a[204:207], a[116:119], v[96:99]
    ds_read_b128 a[196:199], v237 offset:30720
    v_exp_f32 v151, v151
    v_mfma_f32_16x16x32_bf16 v[104:107], a[204:207], a[124:127], v[104:107]
    v_fma_f32 v158, v158, s20, v251
    v_exp_f32 v156, v156
    v_mfma_f32_16x16x32_bf16 v[112:115], a[204:207], a[164:167], v[112:115]
    v_fma_f32 v159, v159, s20, v251
    v_cvt_pk_bf16_f32 v147, v150, v151
    v_mfma_f32_16x16x32_bf16 v[120:123], a[204:207], a[172:175], v[120:123]
    v_exp_f32 v157, v157
    s_waitcnt lgkmcnt(2)
    v_mfma_f32_16x16x32_bf16 v[96:99], a[208:211], a[128:131], v[96:99]
    ds_read_b128 a[200:203], v236 offset:31744
    v_mfma_f32_16x16x32_bf16 a[232:235], a[228:231], v[136:139], a[232:235]
    v_mfma_f32_16x16x32_bf16 v[104:107], a[208:211], a[136:139], v[104:107]
    s_add_u32 m0, s27, 13184
    v_exp_f32 v158, v158
    v_mfma_f32_16x16x32_bf16 v[112:115], a[208:211], a[176:179], v[112:115]
    buffer_load_dwordx4 v241, s[8:11], s25 offen offset:128 nt lds
    v_mfma_f32_16x16x32_bf16 v[120:123], a[208:211], a[184:187], v[120:123]
    v_cvt_pk_bf16_f32 v154, v156, v157
    v_exp_f32 v159, v159
    v_mfma_f32_16x16x32_bf16 v[96:99], a[212:215], a[132:135], v[96:99]
    ds_read_b128 a[204:207], v237 offset:31744
    v_cvt_pk_bf16_f32 v155, v158, v159
    v_mfma_f32_16x16x32_bf16 v[104:107], a[212:215], a[140:143], v[104:107]
    s_cmp_eq_u32 s28, s30
    s_cselect_b32 s35, -49664, s37
    v_mfma_f32_16x16x32_bf16 v[112:115], a[212:215], a[180:183], v[112:115]
    v_mfma_f32_16x16x32_bf16 a[236:239], a[224:227], v[144:147], a[236:239]
    v_mfma_f32_16x16x32_bf16 v[120:123], a[212:215], a[188:191], v[120:123]
    s_add_u32 s29, s28, s35
    s_waitcnt lgkmcnt(2)
    v_mfma_f32_16x16x32_bf16 v[100:103], a[192:195], a[96:99], 0
    ds_read_b128 a[208:211], v236 offset:32768
    v_add_u32 v240, s35, v240
    v_mfma_f32_16x16x32_bf16 v[108:111], a[192:195], a[104:107], 0
    v_mfma_f32_16x16x32_bf16 a[236:239], a[228:231], v[152:155], a[236:239]
    v_mfma_f32_16x16x32_bf16 v[116:119], a[192:195], a[144:147], 0
    v_mfma_f32_16x16x32_bf16 v[124:127], a[192:195], a[152:155], 0
    v_fma_f32 v96, v96, s20, v248
    v_fma_f32 v97, v97, s20, v248
    v_mfma_f32_16x16x32_bf16 v[100:103], a[196:199], a[100:103], v[100:103]
    ds_read_b128 a[212:215], v237 offset:32768
    v_fma_f32 v104, v104, s20, v249
    v_mfma_f32_16x16x32_bf16 v[108:111], a[196:199], a[108:111], v[108:111]
    v_exp_f32 v96, v96
    v_mfma_f32_16x16x32_bf16 v[116:119], a[196:199], a[148:151], v[116:119]
    v_exp_f32 v97, v97
    v_mfma_f32_16x16x32_bf16 v[124:127], a[196:199], a[156:159], v[124:127]
    v_fma_f32 v105, v105, s20, v249
    s_waitcnt lgkmcnt(2)
    v_mfma_f32_16x16x32_bf16 v[100:103], a[200:203], a[112:115], v[100:103]
    ds_read_b64_tr_b16 a[192:193], v240
    v_fma_f32 v112, v112, s20, v250
    v_mfma_f32_16x16x32_bf16 v[108:111], a[200:203], a[120:123], v[108:111]
    ds_read_b64_tr_b16 a[194:195], v240 offset:512
    s_add_u32 m0, s27, 14080
    v_mfma_f32_16x16x32_bf16 v[116:119], a[200:203], a[160:163], v[116:119]
    buffer_load_dwordx4 v241, s[8:11], s25 offen offset:256 nt lds
    v_mfma_f32_16x16x32_bf16 v[124:127], a[200:203], a[168:171], v[124:127]
    v_exp_f32 v104, v104
    v_mfma_f32_16x16x32_bf16 v[100:103], a[204:207], a[116:119], v[100:103]
    ds_read_b64_tr_b16 a[196:197], v240 offset:8
    v_fma_f32 v113, v113, s20, v250
    v_mfma_f32_16x16x32_bf16 v[108:111], a[204:207], a[124:127], v[108:111]
    ds_read_b64_tr_b16 a[198:199], v240 offset:520
    v_cvt_pk_bf16_f32 v96, v96, v97
    v_mfma_f32_16x16x32_bf16 v[116:119], a[204:207], a[164:167], v[116:119]
    v_exp_f32 v105, v105
    v_mfma_f32_16x16x32_bf16 v[124:127], a[204:207], a[172:175], v[124:127]
    v_fma_f32 v120, v120, s20, v251
    s_waitcnt lgkmcnt(4)
    v_mfma_f32_16x16x32_bf16 v[100:103], a[208:211], a[128:131], v[100:103]
    ds_read_b64_tr_b16 a[200:201], v240 offset:64
    v_cvt_pk_bf16_f32 v104, v104, v105
    v_mfma_f32_16x16x32_bf16 v[108:111], a[208:211], a[136:139], v[108:111]
    ds_read_b64_tr_b16 a[202:203], v240 offset:576
    v_fma_f32 v121, v121, s20, v251
    v_mfma_f32_16x16x32_bf16 v[116:119], a[208:211], a[176:179], v[116:119]
    buffer_store_dwordx4 v[228:231], v243, s[16:19], s46 offen offset:256 nt
    v_mfma_f32_16x16x32_bf16 v[124:127], a[208:211], a[184:187], v[124:127]
    v_exp_f32 v112, v112
    v_mfma_f32_16x16x32_bf16 v[100:103], a[212:215], a[132:135], v[100:103]
    ds_read_b64_tr_b16 a[204:205], v240 offset:72
    v_fma_f32 v98, v98, s20, v248
    v_mfma_f32_16x16x32_bf16 v[108:111], a[212:215], a[140:143], v[108:111]
    ds_read_b64_tr_b16 a[206:207], v240 offset:584
    v_fma_f32 v99, v99, s20, v248
    v_mfma_f32_16x16x32_bf16 v[116:119], a[212:215], a[180:183], v[116:119]
    s_waitcnt vmcnt(21)
    s_barrier
    v_mfma_f32_16x16x32_bf16 v[124:127], a[212:215], a[188:191], v[124:127]
    v_fma_f32 v106, v106, s20, v249
    s_waitcnt lgkmcnt(4)
    v_mfma_f32_16x16x32_bf16 a[0:3], a[192:195], v[128:131], a[0:3]
    ds_read_b64_tr_b16 a[208:209], v240 offset:1024
    v_fma_f32 v107, v107, s20, v249
    v_mfma_f32_16x16x32_bf16 a[8:11], a[192:195], v[136:139], a[8:11]
    ds_read_b64_tr_b16 a[210:211], v240 offset:1536
    s_add_u32 m0, s28, 0
    s_mov_b64 vcc, s[12:13]
    v_mfma_f32_16x16x32_bf16 a[48:51], a[192:195], v[144:147], a[48:51]
    buffer_load_dwordx4 v242, s[48:51], s25 offen nt lds
    v_mfma_f32_16x16x32_bf16 a[56:59], a[192:195], v[152:155], a[56:59]
    v_exp_f32 v113, v113
    v_mfma_f32_16x16x32_bf16 a[4:7], a[196:199], v[128:131], a[4:7]
    ds_read_b64_tr_b16 a[212:213], v240 offset:1032
    v_cvt_pk_bf16_f32 v112, v112, v113
    v_cndmask_b32_dpp v224, v168, v160, vcc quad_perm:[1,0,3,2] row_mask:0xf bank_mask:0xf
    v_mfma_f32_16x16x32_bf16 a[12:15], a[196:199], v[136:139], a[12:15]
    ds_read_b64_tr_b16 a[214:215], v240 offset:1544
    v_fma_f32 v114, v114, s20, v250
    v_mfma_f32_16x16x32_bf16 a[52:55], a[196:199], v[144:147], a[52:55]
    v_exp_f32 v120, v120
    v_cndmask_b32_dpp v225, v169, v161, vcc quad_perm:[1,0,3,2] row_mask:0xf bank_mask:0xf
    v_mfma_f32_16x16x32_bf16 a[60:63], a[196:199], v[152:155], a[60:63]
    v_fma_f32 v115, v115, s20, v250
    s_waitcnt lgkmcnt(4)
    v_mfma_f32_16x16x32_bf16 a[16:19], a[200:203], v[128:131], a[16:19]
    ds_read_b64_tr_b16 a[192:193], v240 offset:1088
    v_fma_f32 v122, v122, s20, v251
    v_cndmask_b32_dpp v226, v170, v162, vcc quad_perm:[1,0,3,2] row_mask:0xf bank_mask:0xf
    v_mfma_f32_16x16x32_bf16 a[24:27], a[200:203], v[136:139], a[24:27]
    ds_read_b64_tr_b16 a[194:195], v240 offset:1600
    v_fma_f32 v123, v123, s20, v251
    v_mfma_f32_16x16x32_bf16 a[64:67], a[200:203], v[144:147], a[64:67]
    v_exp_f32 v121, v121
    v_cndmask_b32_dpp v227, v171, v163, vcc quad_perm:[1,0,3,2] row_mask:0xf bank_mask:0xf
    v_mfma_f32_16x16x32_bf16 a[72:75], a[200:203], v[152:155], a[72:75]
    v_exp_f32 v98, v98
    v_mfma_f32_16x16x32_bf16 a[20:23], a[204:207], v[128:131], a[20:23]
    ds_read_b64_tr_b16 a[196:197], v240 offset:1096
    v_cvt_pk_bf16_f32 v120, v120, v121
    s_mov_b64 vcc, s[14:15]
    v_mfma_f32_16x16x32_bf16 a[28:31], a[204:207], v[136:139], a[28:31]
    ds_read_b64_tr_b16 a[198:199], v240 offset:1608
    v_fma_f32 v100, v100, s20, v248
    v_mfma_f32_16x16x32_bf16 a[68:71], a[204:207], v[144:147], a[68:71]
    v_exp_f32 v99, v99
    v_cndmask_b32_dpp v168, v160, v168, vcc quad_perm:[1,0,3,2] row_mask:0xf bank_mask:0xf
    v_mfma_f32_16x16x32_bf16 a[76:79], a[204:207], v[152:155], a[76:79]
    v_cvt_pk_bf16_f32 v97, v98, v99
    s_waitcnt lgkmcnt(4)
    v_mfma_f32_16x16x32_bf16 a[32:35], a[208:211], v[128:131], a[32:35]
    ds_read_b64_tr_b16 a[200:201], v240 offset:2048
    v_fma_f32 v101, v101, s20, v248
    v_cndmask_b32_dpp v169, v161, v169, vcc quad_perm:[1,0,3,2] row_mask:0xf bank_mask:0xf
    v_mfma_f32_16x16x32_bf16 a[40:43], a[208:211], v[136:139], a[40:43]
    ds_read_b64_tr_b16 a[202:203], v240 offset:2560
    s_add_u32 m0, s28, 896
    v_mfma_f32_16x16x32_bf16 a[80:83], a[208:211], v[144:147], a[80:83]
    buffer_load_dwordx4 v242, s[48:51], s25 offen offset:128 nt lds
    v_mfma_f32_16x16x32_bf16 a[88:91], a[208:211], v[152:155], a[88:91]
    v_exp_f32 v106, v106
    v_cndmask_b32_dpp v170, v162, v170, vcc quad_perm:[1,0,3,2] row_mask:0xf bank_mask:0xf
    v_mfma_f32_16x16x32_bf16 a[36:39], a[212:215], v[128:131], a[36:39]
    ds_read_b64_tr_b16 a[204:205], v240 offset:2056
    v_fma_f32 v102, v102, s20, v248
    v_mfma_f32_16x16x32_bf16 a[44:47], a[212:215], v[136:139], a[44:47]
    ds_read_b64_tr_b16 a[206:207], v240 offset:2568
    v_fma_f32 v103, v103, s20, v248
    v_cndmask_b32_dpp v171, v163, v171, vcc quad_perm:[1,0,3,2] row_mask:0xf bank_mask:0xf
    v_mfma_f32_16x16x32_bf16 a[84:87], a[212:215], v[144:147], a[84:87]
    v_exp_f32 v107, v107
    v_mfma_f32_16x16x32_bf16 a[92:95], a[212:215], v[152:155], a[92:95]
    v_cvt_pk_bf16_f32 v105, v106, v107
    s_mov_b64 vcc, s[12:13]
    s_waitcnt lgkmcnt(4)
    v_mfma_f32_16x16x32_bf16 v[0:3], a[192:195], v[128:131], v[0:3]
    ds_read_b64_tr_b16 a[208:209], v240 offset:2112
    v_fma_f32 v108, v108, s20, v249
    v_mfma_f32_16x16x32_bf16 v[8:11], a[192:195], v[136:139], v[8:11]
    ds_read_b64_tr_b16 a[210:211], v240 offset:2624
    s_add_u32 m0, s38, 0
    v_cndmask_b32_dpp v160, v172, v164, vcc quad_perm:[1,0,3,2] row_mask:0xf bank_mask:0xf
    v_mfma_f32_16x16x32_bf16 v[48:51], a[192:195], v[144:147], v[48:51]
    buffer_load_dwordx4 v245, s[4:7], s41 offen offset:3072 nt lds
    v_mfma_f32_16x16x32_bf16 v[56:59], a[192:195], v[152:155], v[56:59]
    v_exp_f32 v114, v114
    v_mfma_f32_16x16x32_bf16 v[4:7], a[196:199], v[128:131], v[4:7]
    ds_read_b64_tr_b16 a[212:213], v240 offset:2120
    v_fma_f32 v109, v109, s20, v249
    v_mfma_f32_16x16x32_bf16 v[12:15], a[196:199], v[136:139], v[12:15]
    ds_read_b64_tr_b16 a[214:215], v240 offset:2632
    v_fma_f32 v110, v110, s20, v249
    v_cndmask_b32_dpp v161, v173, v165, vcc quad_perm:[1,0,3,2] row_mask:0xf bank_mask:0xf
    v_mfma_f32_16x16x32_bf16 v[52:55], a[196:199], v[144:147], v[52:55]
    v_exp_f32 v115, v115
    v_mfma_f32_16x16x32_bf16 v[60:63], a[196:199], v[152:155], v[60:63]
    v_cvt_pk_bf16_f32 v113, v114, v115
    v_cndmask_b32_dpp v162, v174, v166, vcc quad_perm:[1,0,3,2] row_mask:0xf bank_mask:0xf
    s_waitcnt lgkmcnt(4)
    v_mfma_f32_16x16x32_bf16 v[16:19], a[200:203], v[128:131], v[16:19]
    ds_read_b128 a[192:195], v236 offset:36864
    v_fma_f32 v111, v111, s20, v249
    v_mfma_f32_16x16x32_bf16 v[24:27], a[200:203], v[136:139], v[24:27]
    s_add_u32 m0, s28, 1792
    v_fma_f32 v116, v116, s20, v250
    v_cndmask_b32_dpp v163, v175, v167, vcc quad_perm:[1,0,3,2] row_mask:0xf bank_mask:0xf
    v_mfma_f32_16x16x32_bf16 v[64:67], a[200:203], v[144:147], v[64:67]
    buffer_load_dwordx4 v242, s[48:51], s25 offen offset:256 nt lds
    v_mfma_f32_16x16x32_bf16 v[72:75], a[200:203], v[152:155], v[72:75]
    v_exp_f32 v122, v122
    v_mfma_f32_16x16x32_bf16 v[20:23], a[204:207], v[128:131], v[20:23]
    ds_read_b128 a[196:199], v237 offset:36864
    v_fma_f32 v117, v117, s20, v250
    s_mov_b64 vcc, s[14:15]
    v_mfma_f32_16x16x32_bf16 v[28:31], a[204:207], v[136:139], v[28:31]
    v_exp_f32 v123, v123
    v_mfma_f32_16x16x32_bf16 v[68:71], a[204:207], v[144:147], v[68:71]
    v_exp_f32 v100, v100
    v_cndmask_b32_dpp v172, v164, v172, vcc quad_perm:[1,0,3,2] row_mask:0xf bank_mask:0xf
    v_mfma_f32_16x16x32_bf16 v[76:79], a[204:207], v[152:155], v[76:79]
    v_cvt_pk_bf16_f32 v121, v122, v123
    s_waitcnt lgkmcnt(2)
    v_mfma_f32_16x16x32_bf16 v[32:35], a[208:211], v[128:131], v[32:35]
    ds_read_b128 a[200:203], v236 offset:37888
    v_fma_f32 v118, v118, s20, v250
    v_cndmask_b32_dpp v173, v165, v173, vcc quad_perm:[1,0,3,2] row_mask:0xf bank_mask:0xf
    v_mfma_f32_16x16x32_bf16 v[40:43], a[208:211], v[136:139], v[40:43]
    v_exp_f32 v101, v101
    v_mfma_f32_16x16x32_bf16 v[80:83], a[208:211], v[144:147], v[80:83]
    v_exp_f32 v102, v102
    v_cndmask_b32_dpp v174, v166, v174, vcc quad_perm:[1,0,3,2] row_mask:0xf bank_mask:0xf
    v_mfma_f32_16x16x32_bf16 v[88:91], a[208:211], v[152:155], v[88:91]
    s_add_u32 s25, s26, 12288
    v_cvt_pk_bf16_f32 v98, v100, v101
    v_mfma_f32_16x16x32_bf16 v[36:39], a[212:215], v[128:131], v[36:39]
    ds_read_b128 a[204:207], v237 offset:37888
    v_fma_f32 v119, v119, s20, v250
    v_cndmask_b32_dpp v175, v167, v175, vcc quad_perm:[1,0,3,2] row_mask:0xf bank_mask:0xf
    v_mfma_f32_16x16x32_bf16 v[44:47], a[212:215], v[136:139], v[44:47]
    v_exp_f32 v103, v103
    v_mfma_f32_16x16x32_bf16 v[84:87], a[212:215], v[144:147], v[84:87]
    v_exp_f32 v108, v108
    s_mov_b64 vcc, s[12:13]
    v_mfma_f32_16x16x32_bf16 v[92:95], a[212:215], v[152:155], v[92:95]
    v_cvt_pk_bf16_f32 v99, v102, v103
L_join:
    s_waitcnt lgkmcnt(2)
    v_mfma_f32_16x16x32_bf16 v[128:131], a[192:195], a[96:99], 0
    ds_read_b128 a[208:211], v236 offset:38912
    v_fma_f32 v124, v124, s20, v251
    v_mfma_f32_16x16x32_bf16 a[232:235], a[224:227], v[96:99], a[232:235]
    v_exp_f32 v109, v109
    v_cndmask_b32_dpp v228, v200, v192, vcc quad_perm:[1,0,3,2] row_mask:0xf bank_mask:0xf
    v_mfma_f32_16x16x32_bf16 v[136:139], a[192:195], a[104:107], 0
    s_add_u32 m0, s27, 24576
    v_cvt_pk_bf16_f32 v106, v108, v109
    v_mfma_f32_16x16x32_bf16 v[144:147], a[192:195], a[144:147], 0
    buffer_load_dwordx4 v241, s[8:11], s26 offen nt lds
    v_mfma_f32_16x16x32_bf16 v[152:155], a[192:195], a[152:155], 0
    v_exp_f32 v110, v110
    v_cndmask_b32_dpp v229, v201, v193, vcc quad_perm:[1,0,3,2] row_mask:0xf bank_mask:0xf
    v_mfma_f32_16x16x32_bf16 v[128:131], a[196:199], a[100:103], v[128:131]
    ds_read_b128 a[212:215], v237 offset:38912
    v_fma_f32 v125, v125, s20, v251
    v_mfma_f32_16x16x32_bf16 v[136:139], a[196:199], a[108:111], v[136:139]
    v_exp_f32 v111, v111
    v_mfma_f32_16x16x32_bf16 v[144:147], a[196:199], a[148:151], v[144:147]
    v_exp_f32 v116, v116
    v_cndmask_b32_dpp v230, v202, v194, vcc quad_perm:[1,0,3,2] row_mask:0xf bank_mask:0xf
    v_mfma_f32_16x16x32_bf16 v[152:155], a[196:199], a[156:159], v[152:155]
    v_cvt_pk_bf16_f32 v107, v110, v111
    s_waitcnt lgkmcnt(2)
    v_mfma_f32_16x16x32_bf16 v[128:131], a[200:203], a[112:115], v[128:131]
    ds_read_b128 a[192:195], v236 offset:43008
    v_fma_f32 v126, v126, s20, v251
    v_mfma_f32_16x16x32_bf16 a[232:235], a[228:231], v[104:107], a[232:235]
    v_exp_f32 v117, v117
    v_cndmask_b32_dpp v231, v203, v195, vcc quad_perm:[1,0,3,2] row_mask:0xf bank_mask:0xf
    v_mfma_f32_16x16x32_bf16 v[136:139], a[200:203], a[120:123], v[136:139]
    s_add_u32 m0, s38, 4096
    v_cvt_pk_bf16_f32 v114, v116, v117
    v_mfma_f32_16x16x32_bf16 v[144:147], a[200:203], a[160:163], v[144:147]
    buffer_load_dwordx4 v245, s[4:7], s43 offen offset:3072 nt lds
    v_mfma_f32_16x16x32_bf16 v[152:155], a[200:203], a[168:171], v[152:155]
    v_exp_f32 v118, v118
    s_mov_b64 vcc, s[14:15]
    v_mfma_f32_16x16x32_bf16 v[128:131], a[204:207], a[116:119], v[128:131]
    ds_read_b128 a[196:199], v237 offset:43008
    v_fma_f32 v127, v127, s20, v251
    v_mfma_f32_16x16x32_bf16 v[136:139], a[204:207], a[124:127], v[136:139]
    v_exp_f32 v119, v119
    v_cndmask_b32_dpp v200, v192, v200, vcc quad_perm:[1,0,3,2] row_mask:0xf bank_mask:0xf
    v_mfma_f32_16x16x32_bf16 v[144:147], a[204:207], a[164:167], v[144:147]
    v_exp_f32 v124, v124
    v_mfma_f32_16x16x32_bf16 v[152:155], a[204:207], a[172:175], v[152:155]
    v_cvt_pk_bf16_f32 v115, v118, v119
    v_cndmask_b32_dpp v201, v193, v201, vcc quad_perm:[1,0,3,2] row_mask:0xf bank_mask:0xf
    s_waitcnt lgkmcnt(2)
    v_mfma_f32_16x16x32_bf16 v[128:131], a[208:211], a[128:131], v[128:131]
    ds_read_b128 a[200:203], v236 offset:44032
    v_cndmask_b32_dpp v202, v194, v202, vcc quad_perm:[1,0,3,2] row_mask:0xf bank_mask:0xf
    v_mfma_f32_16x16x32_bf16 v[136:139], a[208:211], a[136:139], v[136:139]
    s_add_u32 m0, s27, 25472
    v_cndmask_b32_dpp v203, v195, v203, vcc quad_perm:[1,0,3,2] row_mask:0xf bank_mask:0xf
    s_mov_b64 vcc, s[12:13]
    v_mfma_f32_16x16x32_bf16 v[144:147], a[208:211], a[176:179], v[144:147]
    buffer_load_dwordx4 v241, s[8:11], s26 offen offset:128 nt lds
    v_mfma_f32_16x16x32_bf16 a[236:239], a[224:227], v[112:115], a[236:239]
    v_exp_f32 v125, v125
    v_mfma_f32_16x16x32_bf16 v[152:155], a[208:211], a[184:187], v[152:155]
    v_exp_f32 v126, v126
    v_mfma_f32_16x16x32_bf16 v[128:131], a[212:215], a[132:135], v[128:131]
    ds_read_b128 a[204:207], v237 offset:44032
    v_cvt_pk_bf16_f32 v122, v124, v125
    v_cndmask_b32_dpp v192, v204, v196, vcc quad_perm:[1,0,3,2] row_mask:0xf bank_mask:0xf
    v_mfma_f32_16x16x32_bf16 v[136:139], a[212:215], a[140:143], v[136:139]
    s_cmp_eq_u32 s29, s30
    s_cselect_b32 s35, -49664, s37
    v_mfma_f32_16x16x32_bf16 v[144:147], a[212:215], a[180:183], v[144:147]
    v_exp_f32 v127, v127
    v_cndmask_b32_dpp v193, v205, v197, vcc quad_perm:[1,0,3,2] row_mask:0xf bank_mask:0xf
    v_mfma_f32_16x16x32_bf16 v[152:155], a[212:215], a[188:191], v[152:155]
    s_add_u32 s28, s29, s35
    s_waitcnt lgkmcnt(2)
    v_mfma_f32_16x16x32_bf16 v[132:135], a[192:195], a[96:99], 0
    ds_read_b128 a[208:211], v236 offset:45056
    v_add_u32 v240, s35, v240
    v_cndmask_b32_dpp v194, v206, v198, vcc quad_perm:[1,0,3,2] row_mask:0xf bank_mask:0xf
    v_mfma_f32_16x16x32_bf16 v[140:143], a[192:195], a[104:107], 0
    v_cvt_pk_bf16_f32 v123, v126, v127
    v_cndmask_b32_dpp v195, v207, v199, vcc quad_perm:[1,0,3,2] row_mask:0xf bank_mask:0xf
    v_mfma_f32_16x16x32_bf16 v[148:151], a[192:195], a[144:147], 0
    s_mov_b64 vcc, s[14:15]
    v_cndmask_b32_dpp v204, v196, v204, vcc quad_perm:[1,0,3,2] row_mask:0xf bank_mask:0xf
    v_cndmask_b32_dpp v205, v197, v205, vcc quad_perm:[1,0,3,2] row_mask:0xf bank_mask:0xf
    v_mfma_f32_16x16x32_bf16 v[156:159], a[192:195], a[152:155], 0
    v_fma_f32 v128, v128, s20, v248
    v_fma_f32 v129, v129, s20, v248
    v_mfma_f32_16x16x32_bf16 v[132:135], a[196:199], a[100:103], v[132:135]
    ds_read_b128 a[212:215], v237 offset:45056
    v_fma_f32 v136, v136, s20, v249
    v_cndmask_b32_dpp v206, v198, v206, vcc quad_perm:[1,0,3,2] row_mask:0xf bank_mask:0xf
    v_mfma_f32_16x16x32_bf16 v[140:143], a[196:199], a[108:111], v[140:143]
    v_exp_f32 v128, v128
    v_mfma_f32_16x16x32_bf16 v[148:151], a[196:199], a[148:151], v[148:151]
    v_exp_f32 v129, v129
    v_cndmask_b32_dpp v207, v199, v207, vcc quad_perm:[1,0,3,2] row_mask:0xf bank_mask:0xf
    v_mfma_f32_16x16x32_bf16 v[156:159], a[196:199], a[156:159], v[156:159]
    v_fma_f32 v137, v137, s20, v249
    s_waitcnt lgkmcnt(2)
    v_mfma_f32_16x16x32_bf16 v[132:135], a[200:203], a[112:115], v[132:135]
    ds_read_b64_tr_b16 a[192:193], v240
    v_fma_f32 v144, v144, s20, v250
    v_mfma_f32_16x16x32_bf16 v[140:143], a[200:203], a[120:123], v[140:143]
    ds_read_b64_tr_b16 a[194:195], v240 offset:512
    s_add_u32 m0, s27, 26368
    v_mfma_f32_16x16x32_bf16 a[236:239], a[228:231], v[120:123], a[236:239]
    v_exp_f32 v136, v136
    v_mfma_f32_16x16x32_bf16 v[148:151], a[200:203], a[160:163], v[148:151]
    buffer_load_dwordx4 v241, s[8:11], s26 offen offset:256 nt lds
    v_mfma_f32_16x16x32_bf16 v[156:159], a[200:203], a[168:171], v[156:159]
    v_exp_f32 v137, v137
    v_mfma_f32_16x16x32_bf16 v[132:135], a[204:207], a[116:119], v[132:135]
    ds_read_b64_tr_b16 a[196:197], v240 offset:8
    v_fma_f32 v145, v145, s20, v250
    v_mfma_f32_16x16x32_bf16 v[140:143], a[204:207], a[124:127], v[140:143]
    ds_read_b64_tr_b16 a[198:199], v240 offset:520
    v_fma_f32 v152, v152, s20, v251
    v_mfma_f32_16x16x32_bf16 v[148:151], a[204:207], a[164:167], v[148:151]
    v_exp_f32 v144, v144
    v_mfma_f32_16x16x32_bf16 v[156:159], a[204:207], a[172:175], v[156:159]
    v_fma_f32 v153, v153, s20, v251
    s_waitcnt lgkmcnt(4)
    v_mfma_f32_16x16x32_bf16 v[132:135], a[208:211], a[128:131], v[132:135]
    ds_read_b64_tr_b16 a[200:201], v240 offset:64
    v_cvt_pk_bf16_f32 v128, v128, v129
    v_mfma_f32_16x16x32_bf16 v[140:143], a[208:211], a[136:139], v[140:143]
    ds_read_b64_tr_b16 a[202:203], v240 offset:576
    v_cvt_pk_bf16_f32 v136, v136, v137
    v_mfma_f32_16x16x32_bf16 v[148:151], a[208:211], a[176:179], v[148:151]
    buffer_store_dwordx4 v[224:227], v243, s[16:19], s44 offen nt
    v_mfma_f32_16x16x32_bf16 v[156:159], a[208:211], a[184:187], v[156:159]
    v_exp_f32 v145, v145
    v_mfma_f32_16x16x32_bf16 v[132:135], a[212:215], a[132:135], v[132:135]
    ds_read_b64_tr_b16 a[204:205], v240 offset:72
    v_fma_f32 v130, v130, s20, v248
    v_mfma_f32_16x16x32_bf16 v[140:143], a[212:215], a[140:143], v[140:143]
    ds_read_b64_tr_b16 a[206:207], v240 offset:584
    v_cvt_pk_bf16_f32 v144, v144, v145
    v_mfma_f32_16x16x32_bf16 v[148:151], a[212:215], a[180:183], v[148:151]
    s_waitcnt vmcnt(21)
    s_barrier
    v_mfma_f32_16x16x32_bf16 v[156:159], a[212:215], a[188:191], v[156:159]
    v_fma_f32 v131, v131, s20, v248
    s_waitcnt lgkmcnt(4)
    v_mfma_f32_16x16x32_bf16 a[0:3], a[192:195], v[96:99], a[0:3]
    ds_read_b64_tr_b16 a[208:209], v240 offset:1024
    v_fma_f32 v138, v138, s20, v249
    v_mfma_f32_16x16x32_bf16 a[8:11], a[192:195], v[104:107], a[8:11]
    ds_read_b64_tr_b16 a[210:211], v240 offset:1536
    s_add_u32 m0, s29, 0
    v_mfma_f32_16x16x32_bf16 a[48:51], a[192:195], v[112:115], a[48:51]
    buffer_load_dwordx4 v242, s[48:51], s26 offen nt lds
    v_mfma_f32_16x16x32_bf16 a[56:59], a[192:195], v[120:123], a[56:59]
    v_exp_f32 v152, v152
    v_mfma_f32_16x16x32_bf16 a[4:7], a[196:199], v[96:99], a[4:7]
    ds_read_b64_tr_b16 a[212:213], v240 offset:1032
    v_fma_f32 v139, v139, s20, v249
    v_mfma_f32_16x16x32_bf16 a[12:15], a[196:199], v[104:107], a[12:15]
    ds_read_b64_tr_b16 a[214:215], v240 offset:1544
    v_fma_f32 v146, v146, s20, v250
    v_mfma_f32_16x16x32_bf16 a[52:55], a[196:199], v[112:115], a[52:55]
    v_exp_f32 v153, v153
    v_mfma_f32_16x16x32_bf16 a[60:63], a[196:199], v[120:123], a[60:63]
    v_cvt_pk_bf16_f32 v152, v152, v153
    s_waitcnt lgkmcnt(4)
    v_mfma_f32_16x16x32_bf16 a[16:19], a[200:203], v[96:99], a[16:19]
    ds_read_b64_tr_b16 a[192:193], v240 offset:1088
    v_fma_f32 v147, v147, s20, v250
    v_mfma_f32_16x16x32_bf16 a[24:27], a[200:203], v[104:107], a[24:27]
    ds_read_b64_tr_b16 a[194:195], v240 offset:1600
    v_fma_f32 v154, v154, s20, v251
    v_mfma_f32_16x16x32_bf16 a[64:67], a[200:203], v[112:115], a[64:67]
    buffer_load_dword v233, v232, s[4:7], s58 offen
    v_mfma_f32_16x16x32_bf16 a[72:75], a[200:203], v[120:123], a[72:75]
    s_add_u32 s58, s58, 4096
    v_fma_f32 v155, v155, s20, v251
    v_mfma_f32_16x16x32_bf16 a[20:23], a[204:207], v[96:99], a[20:23]
    ds_read_b64_tr_b16 a[196:197], v240 offset:1096
    v_fma_f32 v132, v132, s20, v248
    v_mfma_f32_16x16x32_bf16 a[28:31], a[204:207], v[104:107], a[28:31]
    ds_read_b64_tr_b16 a[198:199], v240 offset:1608
    v_fma_f32 v133, v133, s20, v248
    v_mfma_f32_16x16x32_bf16 a[68:71], a[204:207], v[112:115], a[68:71]
    v_exp_f32 v130, v130
    v_mfma_f32_16x16x32_bf16 a[76:79], a[204:207], v[120:123], a[76:79]
    v_fma_f32 v134, v134, s20, v248
    s_waitcnt lgkmcnt(4)
    v_mfma_f32_16x16x32_bf16 a[32:35], a[208:211], v[96:99], a[32:35]
    ds_read_b64_tr_b16 a[200:201], v240 offset:2048
    v_fma_f32 v135, v135, s20, v248
    v_mfma_f32_16x16x32_bf16 a[40:43], a[208:211], v[104:107], a[40:43]
    ds_read_b64_tr_b16 a[202:203], v240 offset:2560
    s_add_u32 m0, s29, 896
    v_mfma_f32_16x16x32_bf16 a[80:83], a[208:211], v[112:115], a[80:83]
    buffer_load_dwordx4 v242, s[48:51], s26 offen offset:128 nt lds
    v_mfma_f32_16x16x32_bf16 a[88:91], a[208:211], v[120:123], a[88:91]
    v_exp_f32 v131, v131
    v_mfma_f32_16x16x32_bf16 a[36:39], a[212:215], v[96:99], a[36:39]
    ds_read_b64_tr_b16 a[204:205], v240 offset:2056
    v_cvt_pk_bf16_f32 v129, v130, v131
    v_mfma_f32_16x16x32_bf16 a[44:47], a[212:215], v[104:107], a[44:47]
    ds_read_b64_tr_b16 a[206:207], v240 offset:2568
    v_fma_f32 v140, v140, s20, v249
    v_mfma_f32_16x16x32_bf16 a[84:87], a[212:215], v[112:115], a[84:87]
    v_exp_f32 v138, v138
    v_mfma_f32_16x16x32_bf16 a[92:95], a[212:215], v[120:123], a[92:95]
    v_fma_f32 v141, v141, s20, v249
    s_waitcnt lgkmcnt(4)
    v_mfma_f32_16x16x32_bf16 v[0:3], a[192:195], v[96:99], v[0:3]
    ds_read_b64_tr_b16 a[208:209], v240 offset:2112
    v_fma_f32 v142, v142, s20, v249
    v_mfma_f32_16x16x32_bf16 v[8:11], a[192:195], v[104:107], v[8:11]
    ds_read_b64_tr_b16 a[210:211], v240 offset:2624
    v_fma_f32 v143, v143, s20, v249
    v_mfma_f32_16x16x32_bf16 v[48:51], a[192:195], v[112:115], v[48:51]
    buffer_store_dwordx4 v[228:231], v243, s[16:19], s46 offen nt
    v_mfma_f32_16x16x32_bf16 v[56:59], a[192:195], v[120:123], v[56:59]
    v_exp_f32 v139, v139
    v_mfma_f32_16x16x32_bf16 v[4:7], a[196:199], v[96:99], v[4:7]
    ds_read_b64_tr_b16 a[212:213], v240 offset:2120
    v_cvt_pk_bf16_f32 v137, v138, v139
    v_mfma_f32_16x16x32_bf16 v[12:15], a[196:199], v[104:107], v[12:15]
    ds_read_b64_tr_b16 a[214:215], v240 offset:2632
    v_fma_f32 v148, v148, s20, v250
    v_mfma_f32_16x16x32_bf16 v[52:55], a[196:199], v[112:115], v[52:55]
    v_exp_f32 v146, v146
    v_mfma_f32_16x16x32_bf16 v[60:63], a[196:199], v[120:123], v[60:63]
    v_fma_f32 v149, v149, s20, v250
    s_waitcnt lgkmcnt(4)
    v_mfma_f32_16x16x32_bf16 v[16:19], a[200:203], v[96:99], v[16:19]
    ds_read_b128 a[192:195], v236
    v_fma_f32 v150, v150, s20, v250
    v_mfma_f32_16x16x32_bf16 v[24:27], a[200:203], v[104:107], v[24:27]
    s_add_u32 m0, s29, 1792
    v_fma_f32 v151, v151, s20, v250
    v_mfma_f32_16x16x32_bf16 v[64:67], a[200:203], v[112:115], v[64:67]
    buffer_load_dwordx4 v242, s[48:51], s26 offen offset:256 nt lds
    v_mfma_f32_16x16x32_bf16 v[72:75], a[200:203], v[120:123], v[72:75]
    v_exp_f32 v147, v147
    v_mfma_f32_16x16x32_bf16 v[20:23], a[204:207], v[96:99], v[20:23]
    ds_read_b128 a[196:199], v237
    v_cvt_pk_bf16_f32 v145, v146, v147
    v_mfma_f32_16x16x32_bf16 v[28:31], a[204:207], v[104:107], v[28:31]
    v_exp_f32 v154, v154
    v_mfma_f32_16x16x32_bf16 v[68:71], a[204:207], v[112:115], v[68:71]
    v_exp_f32 v155, v155
    v_mfma_f32_16x16x32_bf16 v[76:79], a[204:207], v[120:123], v[76:79]
    v_cvt_pk_bf16_f32 v153, v154, v155
    s_waitcnt lgkmcnt(2)
    v_mfma_f32_16x16x32_bf16 v[32:35], a[208:211], v[96:99], v[32:35]
    ds_read_b128 a[200:203], v236 offset:1024
    v_fma_f32 v156, v156, s20, v251
    v_mfma_f32_16x16x32_bf16 v[40:43], a[208:211], v[104:107], v[40:43]
    v_exp_f32 v132, v132
    v_mfma_f32_16x16x32_bf16 v[80:83], a[208:211], v[112:115], v[80:83]
    v_exp_f32 v133, v133
    v_mfma_f32_16x16x32_bf16 v[88:91], a[208:211], v[120:123], v[88:91]
    s_add_u32 s26, s25, 12288
    v_cvt_pk_bf16_f32 v130, v132, v133
    v_mfma_f32_16x16x32_bf16 v[36:39], a[212:215], v[96:99], v[36:39]
    ds_read_b128 a[204:207], v237 offset:1024
    v_fma_f32 v157, v157, s20, v251
    v_mfma_f32_16x16x32_bf16 v[44:47], a[212:215], v[104:107], v[44:47]
    v_exp_f32 v134, v134
    v_mfma_f32_16x16x32_bf16 v[84:87], a[212:215], v[112:115], v[84:87]
    v_exp_f32 v135, v135
    v_mfma_f32_16x16x32_bf16 v[92:95], a[212:215], v[120:123], v[92:95]
    v_cvt_pk_bf16_f32 v131, v134, v135
    s_waitcnt lgkmcnt(2)
    v_mfma_f32_16x16x32_bf16 v[96:99], a[192:195], a[96:99], 0
    ds_read_b128 a[208:211], v236 offset:2048
    v_fma_f32 v158, v158, s20, v251
    v_mfma_f32_16x16x32_bf16 a[232:235], a[224:227], v[128:131], a[232:235]
    v_exp_f32 v140, v140
    v_mfma_f32_16x16x32_bf16 v[104:107], a[192:195], a[104:107], 0
    s_add_u32 m0, s27, 36864
    v_fma_f32 v159, v159, s20, v251
    s_mov_b64 vcc, s[12:13]
    v_mfma_f32_16x16x32_bf16 v[112:115], a[192:195], a[144:147], 0
    buffer_load_dwordx4 v241, s[8:11], s25 offen nt lds
    v_mfma_f32_16x16x32_bf16 v[120:123], a[192:195], a[152:155], 0
    v_exp_f32 v141, v141
    v_mfma_f32_16x16x32_bf16 v[96:99], a[196:199], a[100:103], v[96:99]
    ds_read_b128 a[212:215], v237 offset:2048
    v_cvt_pk_bf16_f32 v138, v140, v141
    v_cndmask_b32_dpp v224, v184, v176, vcc quad_perm:[1,0,3,2] row_mask:0xf bank_mask:0xf
    v_mfma_f32_16x16x32_bf16 v[104:107], a[196:199], a[108:111], v[104:107]
    v_exp_f32 v142, v142
    v_mfma_f32_16x16x32_bf16 v[112:115], a[196:199], a[148:151], v[112:115]
    v_exp_f32 v143, v143
    v_cndmask_b32_dpp v225, v185, v177, vcc quad_perm:[1,0,3,2] row_mask:0xf bank_mask:0xf
    v_mfma_f32_16x16x32_bf16 v[120:123], a[196:199], a[156:159], v[120:123]
    v_cvt_pk_bf16_f32 v139, v142, v143
    s_waitcnt lgkmcnt(2)
    v_mfma_f32_16x16x32_bf16 v[96:99], a[200:203], a[112:115], v[96:99]
    ds_read_b128 a[192:195], v236 offset:6144
    v_cndmask_b32_dpp v226, v186, v178, vcc quad_perm:[1,0,3,2] row_mask:0xf bank_mask:0xf
    v_cndmask_b32_dpp v227, v187, v179, vcc quad_perm:[1,0,3,2] row_mask:0xf bank_mask:0xf
    v_mfma_f32_16x16x32_bf16 v[104:107], a[200:203], a[120:123], v[104:107]
    v_exp_f32 v148, v148
    v_mfma_f32_16x16x32_bf16 a[232:235], a[228:231], v[136:139], a[232:235]
    v_exp_f32 v149, v149
    v_mfma_f32_16x16x32_bf16 v[112:115], a[200:203], a[160:163], v[112:115]
    buffer_store_dwordx4 v[160:163], v243, s[16:19], s45 offen nt
    v_mfma_f32_16x16x32_bf16 v[120:123], a[200:203], a[168:171], v[120:123]
    v_exp_f32 v150, v150
    s_mov_b64 vcc, s[14:15]
    v_mfma_f32_16x16x32_bf16 v[96:99], a[204:207], a[116:119], v[96:99]
    ds_read_b128 a[196:199], v237 offset:6144
    v_cvt_pk_bf16_f32 v146, v148, v149
    v_mfma_f32_16x16x32_bf16 v[104:107], a[204:207], a[124:127], v[104:107]
    v_exp_f32 v151, v151
    v_cndmask_b32_dpp v184, v176, v184, vcc quad_perm:[1,0,3,2] row_mask:0xf bank_mask:0xf
    v_mfma_f32_16x16x32_bf16 v[112:115], a[204:207], a[164:167], v[112:115]
    v_exp_f32 v156, v156
    v_mfma_f32_16x16x32_bf16 v[120:123], a[204:207], a[172:175], v[120:123]
    v_cvt_pk_bf16_f32 v147, v150, v151
    v_cndmask_b32_dpp v185, v177, v185, vcc quad_perm:[1,0,3,2] row_mask:0xf bank_mask:0xf
    s_waitcnt lgkmcnt(2)
    v_mfma_f32_16x16x32_bf16 v[96:99], a[208:211], a[128:131], v[96:99]
    ds_read_b128 a[200:203], v236 offset:7168
    v_cndmask_b32_dpp v186, v178, v186, vcc quad_perm:[1,0,3,2] row_mask:0xf bank_mask:0xf
    v_mfma_f32_16x16x32_bf16 v[104:107], a[208:211], a[136:139], v[104:107]
    s_add_u32 m0, s27, 37760
    v_cndmask_b32_dpp v187, v179, v187, vcc quad_perm:[1,0,3,2] row_mask:0xf bank_mask:0xf
    s_mov_b64 vcc, s[12:13]
    v_mfma_f32_16x16x32_bf16 v[112:115], a[208:211], a[176:179], v[112:115]
    buffer_load_dwordx4 v241, s[8:11], s25 offen offset:128 nt lds
    v_mfma_f32_16x16x32_bf16 a[236:239], a[224:227], v[144:147], a[236:239]
    v_exp_f32 v157, v157
    v_mfma_f32_16x16x32_bf16 v[120:123], a[208:211], a[184:187], v[120:123]
    v_exp_f32 v158, v158
    v_mfma_f32_16x16x32_bf16 v[96:99], a[212:215], a[132:135], v[96:99]
    ds_read_b128 a[204:207], v237 offset:7168
    v_cvt_pk_bf16_f32 v154, v156, v157
    v_cndmask_b32_dpp v176, v188, v180, vcc quad_perm:[1,0,3,2] row_mask:0xf bank_mask:0xf
    v_mfma_f32_16x16x32_bf16 v[104:107], a[212:215], a[140:143], v[104:107]
    s_cmp_eq_u32 s28, s30
    s_cselect_b32 s35, -49664, s37
    v_mfma_f32_16x16x32_bf16 v[112:115], a[212:215], a[180:183], v[112:115]
    v_exp_f32 v159, v159
    v_cndmask_b32_dpp v177, v189, v181, vcc quad_perm:[1,0,3,2] row_mask:0xf bank_mask:0xf
    v_mfma_f32_16x16x32_bf16 v[120:123], a[212:215], a[188:191], v[120:123]
    s_add_u32 s29, s28, s35
    s_waitcnt lgkmcnt(2)
    v_mfma_f32_16x16x32_bf16 v[100:103], a[192:195], a[96:99], 0
    ds_read_b128 a[208:211], v236 offset:8192
    v_add_u32 v240, s35, v240
    v_cndmask_b32_dpp v178, v190, v182, vcc quad_perm:[1,0,3,2] row_mask:0xf bank_mask:0xf
    v_mfma_f32_16x16x32_bf16 v[108:111], a[192:195], a[104:107], 0
    v_cvt_pk_bf16_f32 v155, v158, v159
    v_cndmask_b32_dpp v179, v191, v183, vcc quad_perm:[1,0,3,2] row_mask:0xf bank_mask:0xf
    v_mfma_f32_16x16x32_bf16 v[116:119], a[192:195], a[144:147], 0
    s_waitcnt vmcnt(22)
    ds_read_b128 v[160:163], v238
    s_mov_b64 vcc, s[14:15]
    v_cndmask_b32_dpp v188, v180, v188, vcc quad_perm:[1,0,3,2] row_mask:0xf bank_mask:0xf
    v_mfma_f32_16x16x32_bf16 v[124:127], a[192:195], a[152:155], 0
    ds_read_b128 v[164:167], v239
    v_fma_f32 v96, v96, s20, v248
    v_mfma_f32_16x16x32_bf16 v[100:103], a[196:199], a[100:103], v[100:103]
    ds_read_b128 a[212:215], v237 offset:8192
    v_fma_f32 v97, v97, s20, v248
    v_cndmask_b32_dpp v189, v181, v189, vcc quad_perm:[1,0,3,2] row_mask:0xf bank_mask:0xf
    v_mfma_f32_16x16x32_bf16 v[108:111], a[196:199], a[108:111], v[108:111]
    v_exp_f32 v96, v96
    v_mfma_f32_16x16x32_bf16 v[116:119], a[196:199], a[148:151], v[116:119]
    v_exp_f32 v97, v97
    v_cndmask_b32_dpp v190, v182, v190, vcc quad_perm:[1,0,3,2] row_mask:0xf bank_mask:0xf
    v_mfma_f32_16x16x32_bf16 v[124:127], a[196:199], a[156:159], v[124:127]
    v_fma_f32 v104, v104, s20, v249
    s_waitcnt lgkmcnt(4)
    v_mfma_f32_16x16x32_bf16 v[100:103], a[200:203], a[112:115], v[100:103]
    ds_read_b64_tr_b16 a[192:193], v240
    v_fma_f32 v105, v105, s20, v249
    v_cndmask_b32_dpp v191, v183, v191, vcc quad_perm:[1,0,3,2] row_mask:0xf bank_mask:0xf
    v_mfma_f32_16x16x32_bf16 v[108:111], a[200:203], a[120:123], v[108:111]
    ds_read_b64_tr_b16 a[194:195], v240 offset:512
    s_add_u32 m0, s27, 38656
    v_mfma_f32_16x16x32_bf16 a[236:239], a[228:231], v[152:155], a[236:239]
    v_exp_f32 v104, v104
    v_mfma_f32_16x16x32_bf16 v[116:119], a[200:203], a[160:163], v[116:119]
    buffer_load_dwordx4 v241, s[8:11], s25 offen offset:256 nt lds
    v_mfma_f32_16x16x32_bf16 v[124:127], a[200:203], a[168:171], v[124:127]
    v_exp_f32 v105, v105
    s_mov_b64 vcc, s[12:13]
    v_mfma_f32_16x16x32_bf16 v[100:103], a[204:207], a[116:119], v[100:103]
    ds_read_b64_tr_b16 a[196:197], v240 offset:8
    v_fma_f32 v112, v112, s20, v250
    v_mfma_f32_16x16x32_bf16 v[108:111], a[204:207], a[124:127], v[108:111]
    ds_read_b64_tr_b16 a[198:199], v240 offset:520
    v_fma_f32 v113, v113, s20, v250
    v_cndmask_b32_dpp v228, v216, v208, vcc quad_perm:[1,0,3,2] row_mask:0xf bank_mask:0xf
    v_mfma_f32_16x16x32_bf16 v[116:119], a[204:207], a[164:167], v[116:119]
    v_exp_f32 v112, v112
    v_mfma_f32_16x16x32_bf16 v[124:127], a[204:207], a[172:175], v[124:127]
    v_fma_f32 v120, v120, s20, v251
    s_waitcnt lgkmcnt(4)
    v_mfma_f32_16x16x32_bf16 v[100:103], a[208:211], a[128:131], v[100:103]
    ds_read_b64_tr_b16 a[200:201], v240 offset:64
    v_fma_f32 v121, v121, s20, v251
    v_cndmask_b32_dpp v229, v217, v209, vcc quad_perm:[1,0,3,2] row_mask:0xf bank_mask:0xf
    v_mfma_f32_16x16x32_bf16 v[108:111], a[208:211], a[136:139], v[108:111]
    ds_read_b64_tr_b16 a[202:203], v240 offset:576
    v_cvt_pk_bf16_f32 v96, v96, v97
    v_mfma_f32_16x16x32_bf16 v[116:119], a[208:211], a[176:179], v[116:119]
    buffer_store_dwordx4 v[192:195], v243, s[16:19], s47 offen nt
    v_mfma_f32_16x16x32_bf16 v[124:127], a[208:211], a[184:187], v[124:127]
    v_exp_f32 v113, v113
    v_cndmask_b32_dpp v230, v218, v210, vcc quad_perm:[1,0,3,2] row_mask:0xf bank_mask:0xf
    v_mfma_f32_16x16x32_bf16 v[100:103], a[212:215], a[132:135], v[100:103]
    ds_read_b64_tr_b16 a[204:205], v240 offset:72
    v_fma_f32 v98, v98, s20, v248
    v_mfma_f32_16x16x32_bf16 v[108:111], a[212:215], a[140:143], v[108:111]
    ds_read_b64_tr_b16 a[206:207], v240 offset:584
    v_cvt_pk_bf16_f32 v104, v104, v105
    v_cndmask_b32_dpp v231, v219, v211, vcc quad_perm:[1,0,3,2] row_mask:0xf bank_mask:0xf
    v_mfma_f32_16x16x32_bf16 v[116:119], a[212:215], a[180:183], v[116:119]
    s_waitcnt vmcnt(20)
    s_barrier
    v_mfma_f32_16x16x32_bf16 v[124:127], a[212:215], a[188:191], v[124:127]
    v_cvt_pk_bf16_f32 v112, v112, v113
    s_mov_b64 vcc, s[14:15]
    s_waitcnt lgkmcnt(4)
    v_mfma_f32_16x16x32_bf16 a[0:3], a[192:195], v[128:131], a[0:3]
    ds_read_b64_tr_b16 a[208:209], v240 offset:1024
    v_fma_f32 v99, v99, s20, v248
    v_mfma_f32_16x16x32_bf16 a[8:11], a[192:195], v[136:139], a[8:11]
    ds_read_b64_tr_b16 a[210:211], v240 offset:1536
    s_add_u32 m0, s28, 0
    v_cndmask_b32_dpp v216, v208, v216, vcc quad_perm:[1,0,3,2] row_mask:0xf bank_mask:0xf
    v_mfma_f32_16x16x32_bf16 a[48:51], a[192:195], v[144:147], a[48:51]
    buffer_load_dwordx4 v242, s[48:51], s25 offen nt lds
    v_mfma_f32_16x16x32_bf16 a[56:59], a[192:195], v[152:155], a[56:59]
    v_exp_f32 v120, v120
    v_mfma_f32_16x16x32_bf16 a[4:7], a[196:199], v[128:131], a[4:7]
    ds_read_b64_tr_b16 a[212:213], v240 offset:1032
    v_fma_f32 v106, v106, s20, v249
    v_cndmask_b32_dpp v217, v209, v217, vcc quad_perm:[1,0,3,2] row_mask:0xf bank_mask:0xf
    v_mfma_f32_16x16x32_bf16 a[12:15], a[196:199], v[136:139], a[12:15]
    ds_read_b64_tr_b16 a[214:215], v240 offset:1544
    v_fma_f32 v107, v107, s20, v249
    v_mfma_f32_16x16x32_bf16 a[52:55], a[196:199], v[144:147], a[52:55]
    v_exp_f32 v121, v121
    v_cndmask_b32_dpp v218, v210, v218, vcc quad_perm:[1,0,3,2] row_mask:0xf bank_mask:0xf
    v_mfma_f32_16x16x32_bf16 a[60:63], a[196:199], v[152:155], a[60:63]
    v_cvt_pk_bf16_f32 v120, v120, v121
    s_waitcnt lgkmcnt(4)
    v_mfma_f32_16x16x32_bf16 a[16:19], a[200:203], v[128:131], a[16:19]
    ds_read_b64_tr_b16 a[192:193], v240 offset:1088
    v_fma_f32 v114, v114, s20, v250
    v_cndmask_b32_dpp v219, v211, v219, vcc quad_perm:[1,0,3,2] row_mask:0xf bank_mask:0xf
    v_mfma_f32_16x16x32_bf16 a[24:27], a[200:203], v[136:139], a[24:27]
    ds_read_b64_tr_b16 a[194:195], v240 offset:1600
    v_fma_f32 v115, v115, s20, v250
    v_mfma_f32_16x16x32_bf16 a[64:67], a[200:203], v[144:147], a[64:67]
    ds_read_b128 v[192:195], v238 offset:4096
    v_fma_f32 v122, v122, s20, v251
    s_mov_b64 vcc, s[12:13]
    v_mfma_f32_16x16x32_bf16 a[72:75], a[200:203], v[152:155], a[72:75]
    ds_read_b128 v[196:199], v239 offset:4096
    v_fma_f32 v123, v123, s20, v251
    v_mfma_f32_16x16x32_bf16 a[20:23], a[204:207], v[128:131], a[20:23]
    ds_read_b64_tr_b16 a[196:197], v240 offset:1096
    v_fma_f32 v100, v100, s20, v248
    v_cndmask_b32_dpp v208, v220, v212, vcc quad_perm:[1,0,3,2] row_mask:0xf bank_mask:0xf
    v_mfma_f32_16x16x32_bf16 a[28:31], a[204:207], v[136:139], a[28:31]
    ds_read_b64_tr_b16 a[198:199], v240 offset:1608
    v_fma_f32 v101, v101, s20, v248
    v_mfma_f32_16x16x32_bf16 a[68:71], a[204:207], v[144:147], a[68:71]
    v_exp_f32 v98, v98
    v_cndmask_b32_dpp v209, v221, v213, vcc quad_perm:[1,0,3,2] row_mask:0xf bank_mask:0xf
    v_mfma_f32_16x16x32_bf16 a[76:79], a[204:207], v[152:155], a[76:79]
    v_fma_f32 v102, v102, s20, v248
    s_waitcnt lgkmcnt(6)
    v_mfma_f32_16x16x32_bf16 a[32:35], a[208:211], v[128:131], a[32:35]
    ds_read_b64_tr_b16 a[200:201], v240 offset:2048
    v_fma_f32 v103, v103, s20, v248
    v_cndmask_b32_dpp v210, v222, v214, vcc quad_perm:[1,0,3,2] row_mask:0xf bank_mask:0xf
    v_mfma_f32_16x16x32_bf16 a[40:43], a[208:211], v[136:139], a[40:43]
    ds_read_b64_tr_b16 a[202:203], v240 offset:2560
    s_add_u32 m0, s28, 896
    v_mfma_f32_16x16x32_bf16 a[80:83], a[208:211], v[144:147], a[80:83]
    buffer_load_dwordx4 v242, s[48:51], s25 offen offset:128 nt lds
    v_mfma_f32_16x16x32_bf16 a[88:91], a[208:211], v[152:155], a[88:91]
    v_exp_f32 v99, v99
    v_cndmask_b32_dpp v211, v223, v215, vcc quad_perm:[1,0,3,2] row_mask:0xf bank_mask:0xf
    v_mfma_f32_16x16x32_bf16 a[36:39], a[212:215], v[128:131], a[36:39]
    ds_read_b64_tr_b16 a[204:205], v240 offset:2056
    v_cvt_pk_bf16_f32 v97, v98, v99
    v_mfma_f32_16x16x32_bf16 a[44:47], a[212:215], v[136:139], a[44:47]
    ds_read_b64_tr_b16 a[206:207], v240 offset:2568
    v_fma_f32 v108, v108, s20, v249
    s_mov_b64 vcc, s[14:15]
    v_mfma_f32_16x16x32_bf16 a[84:87], a[212:215], v[144:147], a[84:87]
    v_exp_f32 v106, v106
    v_mfma_f32_16x16x32_bf16 a[92:95], a[212:215], v[152:155], a[92:95]
    v_fma_f32 v109, v109, s20, v249
    v_cndmask_b32_dpp v220, v212, v220, vcc quad_perm:[1,0,3,2] row_mask:0xf bank_mask:0xf
    s_waitcnt lgkmcnt(4)
    v_mfma_f32_16x16x32_bf16 v[0:3], a[192:195], v[128:131], v[0:3]
    ds_read_b64_tr_b16 a[208:209], v240 offset:2112
    v_fma_f32 v110, v110, s20, v249
    v_mfma_f32_16x16x32_bf16 v[8:11], a[192:195], v[136:139], v[8:11]
    ds_read_b64_tr_b16 a[210:211], v240 offset:2624
    s_add_u32 m0, s38, -128
    v_cndmask_b32_dpp v221, v213, v221, vcc quad_perm:[1,0,3,2] row_mask:0xf bank_mask:0xf
    v_mfma_f32_16x16x32_bf16 v[48:51], a[192:195], v[144:147], v[48:51]
    buffer_load_dwordx4 v244, s[4:7], s40 offen offset:128 nt lds
    v_mfma_f32_16x16x32_bf16 v[56:59], a[192:195], v[152:155], v[56:59]
    v_exp_f32 v107, v107
    v_mfma_f32_16x16x32_bf16 v[4:7], a[196:199], v[128:131], v[4:7]
    ds_read_b64_tr_b16 a[212:213], v240 offset:2120
    v_cvt_pk_bf16_f32 v105, v106, v107
    v_cndmask_b32_dpp v222, v214, v222, vcc quad_perm:[1,0,3,2] row_mask:0xf bank_mask:0xf
    v_mfma_f32_16x16x32_bf16 v[12:15], a[196:199], v[136:139], v[12:15]
    ds_read_b64_tr_b16 a[214:215], v240 offset:2632
    v_fma_f32 v111, v111, s20, v249
    v_mfma_f32_16x16x32_bf16 v[52:55], a[196:199], v[144:147], v[52:55]
    v_exp_f32 v114, v114
    v_cndmask_b32_dpp v223, v215, v223, vcc quad_perm:[1,0,3,2] row_mask:0xf bank_mask:0xf
    v_mfma_f32_16x16x32_bf16 v[60:63], a[196:199], v[152:155], v[60:63]
    v_fma_f32 v116, v116, s20, v250
    s_waitcnt lgkmcnt(4)
    v_mfma_f32_16x16x32_bf16 v[16:19], a[200:203], v[128:131], v[16:19]
    ds_read_b128 a[192:195], v236 offset:12288
    v_fma_f32 v117, v117, s20, v250
    v_mfma_f32_16x16x32_bf16 v[24:27], a[200:203], v[136:139], v[24:27]
    s_add_u32 m0, s28, 1792
    v_fma_f32 v118, v118, s20, v250
    v_mfma_f32_16x16x32_bf16 v[64:67], a[200:203], v[144:147], v[64:67]
    buffer_load_dwordx4 v242, s[48:51], s25 offen offset:256 nt lds
    v_mfma_f32_16x16x32_bf16 v[72:75], a[200:203], v[152:155], v[72:75]
    v_exp_f32 v115, v115
    v_mfma_f32_16x16x32_bf16 v[20:23], a[204:207], v[128:131], v[20:23]
    ds_read_b128 a[196:199], v237 offset:12288
    v_cvt_pk_bf16_f32 v113, v114, v115
    v_mfma_f32_16x16x32_bf16 v[28:31], a[204:207], v[136:139], v[28:31]
    v_exp_f32 v122, v122
    v_mfma_f32_16x16x32_bf16 v[68:71], a[204:207], v[144:147], v[68:71]
    v_exp_f32 v123, v123
    v_mfma_f32_16x16x32_bf16 v[76:79], a[204:207], v[152:155], v[76:79]
    v_cvt_pk_bf16_f32 v121, v122, v123
    s_waitcnt lgkmcnt(2)
    v_mfma_f32_16x16x32_bf16 v[32:35], a[208:211], v[128:131], v[32:35]
    ds_read_b128 a[200:203], v236 offset:13312
    v_fma_f32 v119, v119, s20, v250
    v_mfma_f32_16x16x32_bf16 v[40:43], a[208:211], v[136:139], v[40:43]
    v_exp_f32 v100, v100
    v_mfma_f32_16x16x32_bf16 v[80:83], a[208:211], v[144:147], v[80:83]
    v_exp_f32 v101, v101
    v_mfma_f32_16x16x32_bf16 v[88:91], a[208:211], v[152:155], v[88:91]
    s_add_u32 s25, s26, 12288
    v_cvt_pk_bf16_f32 v98, v100, v101
    v_mfma_f32_16x16x32_bf16 v[36:39], a[212:215], v[128:131], v[36:39]
    ds_read_b128 a[204:207], v237 offset:13312
    v_fma_f32 v124, v124, s20, v251
    v_mfma_f32_16x16x32_bf16 v[44:47], a[212:215], v[136:139], v[44:47]
    v_exp_f32 v102, v102
    v_mfma_f32_16x16x32_bf16 v[84:87], a[212:215], v[144:147], v[84:87]
    v_exp_f32 v103, v103
    v_mfma_f32_16x16x32_bf16 v[92:95], a[212:215], v[152:155], v[92:95]
    v_cvt_pk_bf16_f32 v99, v102, v103
    s_waitcnt lgkmcnt(2)
    v_mfma_f32_16x16x32_bf16 v[128:131], a[192:195], a[96:99], 0
    ds_read_b128 a[208:211], v236 offset:14336
    v_fma_f32 v125, v125, s20, v251
    v_mfma_f32_16x16x32_bf16 a[232:235], a[224:227], v[96:99], a[232:235]
    v_exp_f32 v108, v108
    v_mfma_f32_16x16x32_bf16 v[136:139], a[192:195], a[104:107], 0
    s_add_u32 m0, s27, 0
    v_fma_f32 v126, v126, s20, v251
    v_mfma_f32_16x16x32_bf16 v[144:147], a[192:195], a[144:147], 0
    buffer_load_dwordx4 v241, s[8:11], s26 offen nt lds
    v_mfma_f32_16x16x32_bf16 v[152:155], a[192:195], a[152:155], 0
    v_exp_f32 v109, v109
    v_mfma_f32_16x16x32_bf16 v[128:131], a[196:199], a[100:103], v[128:131]
    ds_read_b128 a[212:215], v237 offset:14336
    v_cvt_pk_bf16_f32 v106, v108, v109
    v_mfma_f32_16x16x32_bf16 v[136:139], a[196:199], a[108:111], v[136:139]
    v_exp_f32 v110, v110
    v_mfma_f32_16x16x32_bf16 v[144:147], a[196:199], a[148:151], v[144:147]
    v_exp_f32 v111, v111
    v_mfma_f32_16x16x32_bf16 v[152:155], a[196:199], a[156:159], v[152:155]
    v_cvt_pk_bf16_f32 v107, v110, v111
    s_waitcnt lgkmcnt(2)
    v_mfma_f32_16x16x32_bf16 v[128:131], a[200:203], a[112:115], v[128:131]
    ds_read_b128 a[192:195], v236 offset:18432
    v_fma_f32 v127, v127, s20, v251
    v_mfma_f32_16x16x32_bf16 a[232:235], a[228:231], v[104:107], a[232:235]
    v_exp_f32 v116, v116
    v_mfma_f32_16x16x32_bf16 v[136:139], a[200:203], a[120:123], v[136:139]
    s_add_u32 m0, s38, 3968
    v_mfma_f32_16x16x32_bf16 v[144:147], a[200:203], a[160:163], v[144:147]
    buffer_load_dwordx4 v244, s[4:7], s42 offen offset:128 nt lds
    v_mfma_f32_16x16x32_bf16 v[152:155], a[200:203], a[168:171], v[152:155]
    v_exp_f32 v117, v117
    v_mfma_f32_16x16x32_bf16 v[128:131], a[204:207], a[116:119], v[128:131]
    ds_read_b128 a[196:199], v237 offset:18432
    v_cvt_pk_bf16_f32 v114, v116, v117
    v_mfma_f32_16x16x32_bf16 v[136:139], a[204:207], a[124:127], v[136:139]
    v_exp_f32 v118, v118
    v_mfma_f32_16x16x32_bf16 v[144:147], a[204:207], a[164:167], v[144:147]
    v_exp_f32 v119, v119
    v_mfma_f32_16x16x32_bf16 v[152:155], a[204:207], a[172:175], v[152:155]
    v_cvt_pk_bf16_f32 v115, v118, v119
    s_waitcnt lgkmcnt(2)
    v_mfma_f32_16x16x32_bf16 v[128:131], a[208:211], a[128:131], v[128:131]
    ds_read_b128 a[200:203], v236 offset:19456
    v_mfma_f32_16x16x32_bf16 v[136:139], a[208:211], a[136:139], v[136:139]
    s_add_u32 m0, s27, 896
    v_mfma_f32_16x16x32_bf16 v[144:147], a[208:211], a[176:179], v[144:147]
    buffer_load_dwordx4 v241, s[8:11], s26 offen offset:128 nt lds
    v_mfma_f32_16x16x32_bf16 a[236:239], a[224:227], v[112:115], a[236:239]
    v_exp_f32 v124, v124
    v_mfma_f32_16x16x32_bf16 v[152:155], a[208:211], a[184:187], v[152:155]
    v_exp_f32 v125, v125
    v_mfma_f32_16x16x32_bf16 v[128:131], a[212:215], a[132:135], v[128:131]
    ds_read_b128 a[204:207], v237 offset:19456
    v_cvt_pk_bf16_f32 v122, v124, v125
    v_mfma_f32_16x16x32_bf16 v[136:139], a[212:215], a[140:143], v[136:139]
    s_cmp_eq_u32 s29, s30
    s_cselect_b32 s35, -49664, s37
    v_mfma_f32_16x16x32_bf16 v[144:147], a[212:215], a[180:183], v[144:147]
    v_exp_f32 v126, v126
    v_mfma_f32_16x16x32_bf16 v[152:155], a[212:215], a[188:191], v[152:155]
    s_add_u32 s28, s29, s35
    s_waitcnt lgkmcnt(2)
    v_mfma_f32_16x16x32_bf16 v[132:135], a[192:195], a[96:99], 0
    ds_read_b128 a[208:211], v236 offset:20480
    v_add_u32 v240, s35, v240
    v_mfma_f32_16x16x32_bf16 v[140:143], a[192:195], a[104:107], 0
    v_exp_f32 v127, v127
    v_mfma_f32_16x16x32_bf16 v[148:151], a[192:195], a[144:147], 0
    v_cvt_pk_bf16_f32 v123, v126, v127
    v_mfma_f32_16x16x32_bf16 v[156:159], a[192:195], a[152:155], 0
    v_fma_f32 v128, v128, s20, v248
    v_fma_f32 v129, v129, s20, v248
    v_mfma_f32_16x16x32_bf16 v[132:135], a[196:199], a[100:103], v[132:135]
    ds_read_b128 a[212:215], v237 offset:20480
    v_fma_f32 v136, v136, s20, v249
    v_mfma_f32_16x16x32_bf16 v[140:143], a[196:199], a[108:111], v[140:143]
    v_exp_f32 v128, v128
    v_mfma_f32_16x16x32_bf16 v[148:151], a[196:199], a[148:151], v[148:151]
    v_exp_f32 v129, v129
    v_mfma_f32_16x16x32_bf16 v[156:159], a[196:199], a[156:159], v[156:159]
    v_fma_f32 v137, v137, s20, v249
    s_waitcnt lgkmcnt(2)
    v_mfma_f32_16x16x32_bf16 v[132:135], a[200:203], a[112:115], v[132:135]
    ds_read_b64_tr_b16 a[192:193], v240
    v_fma_f32 v144, v144, s20, v250
    v_mfma_f32_16x16x32_bf16 v[140:143], a[200:203], a[120:123], v[140:143]
    ds_read_b64_tr_b16 a[194:195], v240 offset:512
    s_add_u32 m0, s27, 1792
    v_mfma_f32_16x16x32_bf16 a[236:239], a[228:231], v[120:123], a[236:239]
    v_exp_f32 v136, v136
    v_mfma_f32_16x16x32_bf16 v[148:151], a[200:203], a[160:163], v[148:151]
    buffer_load_dwordx4 v241, s[8:11], s26 offen offset:256 nt lds
    v_mfma_f32_16x16x32_bf16 v[156:159], a[200:203], a[168:171], v[156:159]
    v_exp_f32 v137, v137
    v_mfma_f32_16x16x32_bf16 v[132:135], a[204:207], a[116:119], v[132:135]
    ds_read_b64_tr_b16 a[196:197], v240 offset:8
    v_fma_f32 v145, v145, s20, v250
    v_mfma_f32_16x16x32_bf16 v[140:143], a[204:207], a[124:127], v[140:143]
    ds_read_b64_tr_b16 a[198:199], v240 offset:520
    v_fma_f32 v152, v152, s20, v251
    v_mfma_f32_16x16x32_bf16 v[148:151], a[204:207], a[164:167], v[148:151]
    v_exp_f32 v144, v144
    v_mfma_f32_16x16x32_bf16 v[156:159], a[204:207], a[172:175], v[156:159]
    v_fma_f32 v153, v153, s20, v251
    s_waitcnt lgkmcnt(4)
    v_mfma_f32_16x16x32_bf16 v[132:135], a[208:211], a[128:131], v[132:135]
    ds_read_b64_tr_b16 a[200:201], v240 offset:64
    v_cvt_pk_bf16_f32 v128, v128, v129
    v_mfma_f32_16x16x32_bf16 v[140:143], a[208:211], a[136:139], v[140:143]
    ds_read_b64_tr_b16 a[202:203], v240 offset:576
    v_cvt_pk_bf16_f32 v136, v136, v137
    v_mfma_f32_16x16x32_bf16 v[148:151], a[208:211], a[176:179], v[148:151]
    buffer_store_dwordx4 v[168:171], v243, s[16:19], s44 offen offset:384 nt
    v_mfma_f32_16x16x32_bf16 v[156:159], a[208:211], a[184:187], v[156:159]
    v_exp_f32 v145, v145
    v_mfma_f32_16x16x32_bf16 v[132:135], a[212:215], a[132:135], v[132:135]
    ds_read_b64_tr_b16 a[204:205], v240 offset:72
    v_fma_f32 v130, v130, s20, v248
    v_mfma_f32_16x16x32_bf16 v[140:143], a[212:215], a[140:143], v[140:143]
    ds_read_b64_tr_b16 a[206:207], v240 offset:584
    v_cvt_pk_bf16_f32 v144, v144, v145
    v_mfma_f32_16x16x32_bf16 v[148:151], a[212:215], a[180:183], v[148:151]
    s_waitcnt vmcnt(20)
    s_barrier
    v_mfma_f32_16x16x32_bf16 v[156:159], a[212:215], a[188:191], v[156:159]
    v_fma_f32 v131, v131, s20, v248
    s_waitcnt lgkmcnt(4)
    v_mfma_f32_16x16x32_bf16 a[0:3], a[192:195], v[96:99], a[0:3]
    ds_read_b64_tr_b16 a[208:209], v240 offset:1024
    v_fma_f32 v138, v138, s20, v249
    v_mfma_f32_16x16x32_bf16 a[8:11], a[192:195], v[104:107], a[8:11]
    ds_read_b64_tr_b16 a[210:211], v240 offset:1536
    s_add_u32 m0, s29, 0
    v_mfma_f32_16x16x32_bf16 a[48:51], a[192:195], v[112:115], a[48:51]
    buffer_load_dwordx4 v242, s[48:51], s26 offen nt lds
    v_mfma_f32_16x16x32_bf16 a[56:59], a[192:195], v[120:123], a[56:59]
    v_exp_f32 v152, v152
    v_mfma_f32_16x16x32_bf16 a[4:7], a[196:199], v[96:99], a[4:7]
    ds_read_b64_tr_b16 a[212:213], v240 offset:1032
    v_fma_f32 v139, v139, s20, v249
    v_mfma_f32_16x16x32_bf16 a[12:15], a[196:199], v[104:107], a[12:15]
    ds_read_b64_tr_b16 a[214:215], v240 offset:1544
    v_fma_f32 v146, v146, s20, v250
    v_mfma_f32_16x16x32_bf16 a[52:55], a[196:199], v[112:115], a[52:55]
    v_exp_f32 v153, v153
    v_mfma_f32_16x16x32_bf16 a[60:63], a[196:199], v[120:123], a[60:63]
    v_cvt_pk_bf16_f32 v152, v152, v153
    s_waitcnt lgkmcnt(4)
    v_mfma_f32_16x16x32_bf16 a[16:19], a[200:203], v[96:99], a[16:19]
    ds_read_b64_tr_b16 a[192:193], v240 offset:1088
    v_fma_f32 v147, v147, s20, v250
    v_mfma_f32_16x16x32_bf16 a[24:27], a[200:203], v[104:107], a[24:27]
    ds_read_b64_tr_b16 a[194:195], v240 offset:1600
    v_fma_f32 v154, v154, s20, v251
    v_mfma_f32_16x16x32_bf16 a[64:67], a[200:203], v[112:115], a[64:67]
    v_exp_f32 v130, v130
    v_mfma_f32_16x16x32_bf16 a[72:75], a[200:203], v[120:123], a[72:75]
    v_exp_f32 v131, v131
    v_mfma_f32_16x16x32_bf16 a[20:23], a[204:207], v[96:99], a[20:23]
    ds_read_b64_tr_b16 a[196:197], v240 offset:1096
    v_cvt_pk_bf16_f32 v129, v130, v131
    v_mfma_f32_16x16x32_bf16 a[28:31], a[204:207], v[104:107], a[28:31]
    ds_read_b64_tr_b16 a[198:199], v240 offset:1608
    v_fma_f32 v155, v155, s20, v251
    v_mfma_f32_16x16x32_bf16 a[68:71], a[204:207], v[112:115], a[68:71]
    v_exp_f32 v138, v138
    v_mfma_f32_16x16x32_bf16 a[76:79], a[204:207], v[120:123], a[76:79]
    v_fma_f32 v132, v132, s20, v248
    s_waitcnt lgkmcnt(4)
    v_mfma_f32_16x16x32_bf16 a[32:35], a[208:211], v[96:99], a[32:35]
    ds_read_b64_tr_b16 a[200:201], v240 offset:2048
    v_fma_f32 v133, v133, s20, v248
    v_mfma_f32_16x16x32_bf16 a[40:43], a[208:211], v[104:107], a[40:43]
    ds_read_b64_tr_b16 a[202:203], v240 offset:2560
    s_add_u32 m0, s29, 896
    v_mfma_f32_16x16x32_bf16 a[80:83], a[208:211], v[112:115], a[80:83]
    buffer_load_dwordx4 v242, s[48:51], s26 offen offset:128 nt lds
    v_mfma_f32_16x16x32_bf16 a[88:91], a[208:211], v[120:123], a[88:91]
    v_exp_f32 v139, v139
    v_mfma_f32_16x16x32_bf16 a[36:39], a[212:215], v[96:99], a[36:39]
    ds_read_b64_tr_b16 a[204:205], v240 offset:2056
    v_cvt_pk_bf16_f32 v137, v138, v139
    v_mfma_f32_16x16x32_bf16 a[44:47], a[212:215], v[104:107], a[44:47]
    ds_read_b64_tr_b16 a[206:207], v240 offset:2568
    v_fma_f32 v134, v134, s20, v248
    v_mfma_f32_16x16x32_bf16 a[84:87], a[212:215], v[112:115], a[84:87]
    v_exp_f32 v146, v146
    v_mfma_f32_16x16x32_bf16 a[92:95], a[212:215], v[120:123], a[92:95]
    v_fma_f32 v135, v135, s20, v248
    s_waitcnt lgkmcnt(4)
    v_mfma_f32_16x16x32_bf16 v[0:3], a[192:195], v[96:99], v[0:3]
    ds_read_b64_tr_b16 a[208:209], v240 offset:2112
    v_fma_f32 v140, v140, s20, v249
    v_mfma_f32_16x16x32_bf16 v[8:11], a[192:195], v[104:107], v[8:11]
    ds_read_b64_tr_b16 a[210:211], v240 offset:2624
    v_fma_f32 v141, v141, s20, v249
    v_mfma_f32_16x16x32_bf16 v[48:51], a[192:195], v[112:115], v[48:51]
    buffer_store_dwordx4 v[200:203], v243, s[16:19], s46 offen offset:384 nt
    v_mfma_f32_16x16x32_bf16 v[56:59], a[192:195], v[120:123], v[56:59]
    v_exp_f32 v147, v147
    v_mfma_f32_16x16x32_bf16 v[4:7], a[196:199], v[96:99], v[4:7]
    ds_read_b64_tr_b16 a[212:213], v240 offset:2120
    v_cvt_pk_bf16_f32 v145, v146, v147
    v_mfma_f32_16x16x32_bf16 v[12:15], a[196:199], v[104:107], v[12:15]
    ds_read_b64_tr_b16 a[214:215], v240 offset:2632
    v_fma_f32 v142, v142, s20, v249
    v_mfma_f32_16x16x32_bf16 v[52:55], a[196:199], v[112:115], v[52:55]
    v_exp_f32 v154, v154
    v_mfma_f32_16x16x32_bf16 v[60:63], a[196:199], v[120:123], v[60:63]
    v_fma_f32 v143, v143, s20, v249
    s_waitcnt lgkmcnt(4)
    v_mfma_f32_16x16x32_bf16 v[16:19], a[200:203], v[96:99], v[16:19]
    ds_read_b128 a[192:195], v236 offset:24576
    v_fma_f32 v148, v148, s20, v250
    v_mfma_f32_16x16x32_bf16 v[24:27], a[200:203], v[104:107], v[24:27]
    s_add_u32 m0, s29, 1792
    v_fma_f32 v149, v149, s20, v250
    v_mfma_f32_16x16x32_bf16 v[64:67], a[200:203], v[112:115], v[64:67]
    buffer_load_dwordx4 v242, s[48:51], s26 offen offset:256 nt lds
    v_mfma_f32_16x16x32_bf16 v[72:75], a[200:203], v[120:123], v[72:75]
    v_exp_f32 v155, v155
    v_mfma_f32_16x16x32_bf16 v[20:23], a[204:207], v[96:99], v[20:23]
    ds_read_b128 a[196:199], v237 offset:24576
    v_cvt_pk_bf16_f32 v153, v154, v155
    v_mfma_f32_16x16x32_bf16 v[28:31], a[204:207], v[104:107], v[28:31]
    v_exp_f32 v132, v132
    v_mfma_f32_16x16x32_bf16 v[68:71], a[204:207], v[112:115], v[68:71]
    v_exp_f32 v133, v133
    v_mfma_f32_16x16x32_bf16 v[76:79], a[204:207], v[120:123], v[76:79]
    v_cvt_pk_bf16_f32 v130, v132, v133
    s_waitcnt lgkmcnt(2)
    v_mfma_f32_16x16x32_bf16 v[32:35], a[208:211], v[96:99], v[32:35]
    ds_read_b128 a[200:203], v236 offset:25600
    v_fma_f32 v150, v150, s20, v250
    v_mfma_f32_16x16x32_bf16 v[40:43], a[208:211], v[104:107], v[40:43]
    v_exp_f32 v134, v134
    v_mfma_f32_16x16x32_bf16 v[80:83], a[208:211], v[112:115], v[80:83]
    v_exp_f32 v135, v135
    v_mfma_f32_16x16x32_bf16 v[88:91], a[208:211], v[120:123], v[88:91]
    s_add_u32 s26, s25, 12288
    v_cvt_pk_bf16_f32 v131, v134, v135
    v_mfma_f32_16x16x32_bf16 v[36:39], a[212:215], v[96:99], v[36:39]
    ds_read_b128 a[204:207], v237 offset:25600
    v_fma_f32 v151, v151, s20, v250
    v_mfma_f32_16x16x32_bf16 a[232:235], a[224:227], v[128:131], a[232:235]
    v_exp_f32 v140, v140
    v_mfma_f32_16x16x32_bf16 v[44:47], a[212:215], v[104:107], v[44:47]
    v_exp_f32 v141, v141
    v_mfma_f32_16x16x32_bf16 v[84:87], a[212:215], v[112:115], v[84:87]
    v_exp_f32 v142, v142
    v_mfma_f32_16x16x32_bf16 v[92:95], a[212:215], v[120:123], v[92:95]
    v_cvt_pk_bf16_f32 v138, v140, v141
    s_waitcnt lgkmcnt(2)
    v_mfma_f32_16x16x32_bf16 v[96:99], a[192:195], a[96:99], 0
    ds_read_b128 a[208:211], v236 offset:26624
    v_fma_f32 v156, v156, s20, v251
    v_mfma_f32_16x16x32_bf16 v[104:107], a[192:195], a[104:107], 0
    s_add_u32 m0, s27, 12288
    v_fma_f32 v157, v157, s20, v251
    v_mfma_f32_16x16x32_bf16 v[112:115], a[192:195], a[144:147], 0
    buffer_load_dwordx4 v241, s[8:11], s25 offen nt lds
    v_mfma_f32_16x16x32_bf16 v[120:123], a[192:195], a[152:155], 0
    v_exp_f32 v143, v143
    v_mfma_f32_16x16x32_bf16 v[96:99], a[196:199], a[100:103], v[96:99]
    ds_read_b128 a[212:215], v237 offset:26624
    v_cvt_pk_bf16_f32 v139, v142, v143
    v_mfma_f32_16x16x32_bf16 v[104:107], a[196:199], a[108:111], v[104:107]
    v_exp_f32 v148, v148
    v_mfma_f32_16x16x32_bf16 a[232:235], a[228:231], v[136:139], a[232:235]
    v_exp_f32 v149, v149
    v_mfma_f32_16x16x32_bf16 v[112:115], a[196:199], a[148:151], v[112:115]
    v_exp_f32 v150, v150
    v_mfma_f32_16x16x32_bf16 v[120:123], a[196:199], a[156:159], v[120:123]
    v_cvt_pk_bf16_f32 v146, v148, v149
    s_waitcnt lgkmcnt(2)
    v_mfma_f32_16x16x32_bf16 v[96:99], a[200:203], a[112:115], v[96:99]
    ds_read_b128 a[192:195], v236 offset:30720
    v_fma_f32 v158, v158, s20, v251
    v_mfma_f32_16x16x32_bf16 v[104:107], a[200:203], a[120:123], v[104:107]
    s_add_u32 m0, s38, -2176
    v_fma_f32 v159, v159, s20, v251
    v_mfma_f32_16x16x32_bf16 v[112:115], a[200:203], a[160:163], v[112:115]
    buffer_load_dwordx4 v245, s[4:7], s40 offen offset:3200 nt lds
    v_mfma_f32_16x16x32_bf16 v[120:123], a[200:203], a[168:171], v[120:123]
    v_exp_f32 v151, v151
    v_mfma_f32_16x16x32_bf16 v[96:99], a[204:207], a[116:119], v[96:99]
    ds_read_b128 a[196:199], v237 offset:30720
    v_cvt_pk_bf16_f32 v147, v150, v151
    v_mfma_f32_16x16x32_bf16 v[104:107], a[204:207], a[124:127], v[104:107]
    v_exp_f32 v156, v156
    v_mfma_f32_16x16x32_bf16 a[236:239], a[224:227], v[144:147], a[236:239]
    v_exp_f32 v157, v157
    v_mfma_f32_16x16x32_bf16 v[112:115], a[204:207], a[164:167], v[112:115]
    v_exp_f32 v158, v158
    v_mfma_f32_16x16x32_bf16 v[120:123], a[204:207], a[172:175], v[120:123]
    v_cvt_pk_bf16_f32 v154, v156, v157
    s_waitcnt lgkmcnt(2)
    v_mfma_f32_16x16x32_bf16 v[96:99], a[208:211], a[128:131], v[96:99]
    ds_read_b128 a[200:203], v236 offset:31744
    v_mfma_f32_16x16x32_bf16 v[104:107], a[208:211], a[136:139], v[104:107]
    s_add_u32 m0, s27, 13184
    v_mfma_f32_16x16x32_bf16 v[112:115], a[208:211], a[176:179], v[112:115]
    buffer_load_dwordx4 v241, s[8:11], s25 offen offset:128 nt lds
    v_mfma_f32_16x16x32_bf16 v[120:123], a[208:211], a[184:187], v[120:123]
    v_exp_f32 v159, v159
    v_mfma_f32_16x16x32_bf16 v[96:99], a[212:215], a[132:135], v[96:99]
    ds_read_b128 a[204:207], v237 offset:31744
    v_cvt_pk_bf16_f32 v155, v158, v159
    v_mfma_f32_16x16x32_bf16 v[104:107], a[212:215], a[140:143], v[104:107]
    s_cmp_eq_u32 s28, s30
    s_cselect_b32 s35, -49664, s37
    v_mfma_f32_16x16x32_bf16 a[236:239], a[228:231], v[152:155], a[236:239]
    v_mfma_f32_16x16x32_bf16 v[112:115], a[212:215], a[180:183], v[112:115]
    v_mfma_f32_16x16x32_bf16 v[120:123], a[212:215], a[188:191], v[120:123]
    s_add_u32 s29, s28, s35
    s_waitcnt lgkmcnt(2)
    v_mfma_f32_16x16x32_bf16 v[100:103], a[192:195], a[96:99], 0
    ds_read_b128 a[208:211], v236 offset:32768
    v_add_u32 v240, s35, v240
    v_mfma_f32_16x16x32_bf16 v[108:111], a[192:195], a[104:107], 0
    v_mfma_f32_16x16x32_bf16 v[116:119], a[192:195], a[144:147], 0
    v_mfma_f32_16x16x32_bf16 v[124:127], a[192:195], a[152:155], 0
    v_fma_f32 v96, v96, s20, v248
    v_fma_f32 v97, v97, s20, v248
    v_mfma_f32_16x16x32_bf16 v[100:103], a[196:199], a[100:103], v[100:103]
    ds_read_b128 a[212:215], v237 offset:32768
    v_fma_f32 v104, v104, s20, v249
    v_mfma_f32_16x16x32_bf16 v[108:111], a[196:199], a[108:111], v[108:111]
    v_exp_f32 v96, v96
    v_mfma_f32_16x16x32_bf16 v[116:119], a[196:199], a[148:151], v[116:119]
    v_exp_f32 v97, v97
    v_mfma_f32_16x16x32_bf16 v[124:127], a[196:199], a[156:159], v[124:127]
    v_fma_f32 v105, v105, s20, v249
    s_waitcnt lgkmcnt(2)
    v_mfma_f32_16x16x32_bf16 v[100:103], a[200:203], a[112:115], v[100:103]
    ds_read_b64_tr_b16 a[192:193], v240
    v_fma_f32 v112, v112, s20, v250
    v_mfma_f32_16x16x32_bf16 v[108:111], a[200:203], a[120:123], v[108:111]
    ds_read_b64_tr_b16 a[194:195], v240 offset:512
    s_add_u32 m0, s27, 14080
    v_mfma_f32_16x16x32_bf16 v[116:119], a[200:203], a[160:163], v[116:119]
    buffer_load_dwordx4 v241, s[8:11], s25 offen offset:256 nt lds
    v_mfma_f32_16x16x32_bf16 v[124:127], a[200:203], a[168:171], v[124:127]
    v_exp_f32 v104, v104
    v_mfma_f32_16x16x32_bf16 v[100:103], a[204:207], a[116:119], v[100:103]
    ds_read_b64_tr_b16 a[196:197], v240 offset:8
    v_fma_f32 v113, v113, s20, v250
    v_mfma_f32_16x16x32_bf16 v[108:111], a[204:207], a[124:127], v[108:111]
    ds_read_b64_tr_b16 a[198:199], v240 offset:520
    v_cvt_pk_bf16_f32 v96, v96, v97
    v_mfma_f32_16x16x32_bf16 v[116:119], a[204:207], a[164:167], v[116:119]
    v_exp_f32 v105, v105
    v_mfma_f32_16x16x32_bf16 v[124:127], a[204:207], a[172:175], v[124:127]
    v_fma_f32 v120, v120, s20, v251
    s_waitcnt lgkmcnt(4)
    v_mfma_f32_16x16x32_bf16 v[100:103], a[208:211], a[128:131], v[100:103]
    ds_read_b64_tr_b16 a[200:201], v240 offset:64
    v_cvt_pk_bf16_f32 v104, v104, v105
    v_mfma_f32_16x16x32_bf16 v[108:111], a[208:211], a[136:139], v[108:111]
    ds_read_b64_tr_b16 a[202:203], v240 offset:576
    s_add_u32 m0, s38, 1920
    v_mfma_f32_16x16x32_bf16 v[116:119], a[208:211], a[176:179], v[116:119]
    buffer_load_dwordx4 v245, s[4:7], s42 offen offset:3200 nt lds
    v_mfma_f32_16x16x32_bf16 v[124:127], a[208:211], a[184:187], v[124:127]
    v_exp_f32 v112, v112
    v_mfma_f32_16x16x32_bf16 v[100:103], a[212:215], a[132:135], v[100:103]
    ds_read_b64_tr_b16 a[204:205], v240 offset:72
    v_fma_f32 v121, v121, s20, v251
    v_mfma_f32_16x16x32_bf16 v[108:111], a[212:215], a[140:143], v[108:111]
    ds_read_b64_tr_b16 a[206:207], v240 offset:584
    v_fma_f32 v98, v98, s20, v248
    v_mfma_f32_16x16x32_bf16 v[116:119], a[212:215], a[180:183], v[116:119]
    s_waitcnt vmcnt(19)
    s_barrier
    v_mfma_f32_16x16x32_bf16 v[124:127], a[212:215], a[188:191], v[124:127]
    v_fma_f32 v99, v99, s20, v248
    s_waitcnt lgkmcnt(4)
    v_mfma_f32_16x16x32_bf16 a[0:3], a[192:195], v[128:131], a[0:3]
    ds_read_b64_tr_b16 a[208:209], v240 offset:1024
    v_fma_f32 v106, v106, s20, v249
    v_mfma_f32_16x16x32_bf16 a[8:11], a[192:195], v[136:139], a[8:11]
    ds_read_b64_tr_b16 a[210:211], v240 offset:1536
    s_add_u32 m0, s28, 0
    v_mfma_f32_16x16x32_bf16 a[48:51], a[192:195], v[144:147], a[48:51]
    buffer_load_dwordx4 v242, s[48:51], s25 offen nt lds
    v_mfma_f32_16x16x32_bf16 a[56:59], a[192:195], v[152:155], a[56:59]
    v_exp_f32 v113, v113
    v_mfma_f32_16x16x32_bf16 a[4:7], a[196:199], v[128:131], a[4:7]
    ds_read_b64_tr_b16 a[212:213], v240 offset:1032
    v_cvt_pk_bf16_f32 v112, v112, v113
    v_mfma_f32_16x16x32_bf16 a[12:15], a[196:199], v[136:139], a[12:15]
    ds_read_b64_tr_b16 a[214:215], v240 offset:1544
    v_fma_f32 v107, v107, s20, v249
    v_mfma_f32_16x16x32_bf16 a[52:55], a[196:199], v[144:147], a[52:55]
    v_exp_f32 v120, v120
    v_mfma_f32_16x16x32_bf16 a[60:63], a[196:199], v[152:155], a[60:63]
    v_fma_f32 v114, v114, s20, v250
    s_waitcnt lgkmcnt(4)
    v_mfma_f32_16x16x32_bf16 a[16:19], a[200:203], v[128:131], a[16:19]
    ds_read_b64_tr_b16 a[192:193], v240 offset:1088
    v_fma_f32 v115, v115, s20, v250
    v_mfma_f32_16x16x32_bf16 a[24:27], a[200:203], v[136:139], a[24:27]
    ds_read_b64_tr_b16 a[194:195], v240 offset:1600
    v_fma_f32 v122, v122, s20, v251
    v_mfma_f32_16x16x32_bf16 a[64:67], a[200:203], v[144:147], a[64:67]
    v_exp_f32 v121, v121
    v_mfma_f32_16x16x32_bf16 a[72:75], a[200:203], v[152:155], a[72:75]
    v_exp_f32 v98, v98
    v_mfma_f32_16x16x32_bf16 a[20:23], a[204:207], v[128:131], a[20:23]
    ds_read_b64_tr_b16 a[196:197], v240 offset:1096
    v_cvt_pk_bf16_f32 v120, v120, v121
    v_mfma_f32_16x16x32_bf16 a[28:31], a[204:207], v[136:139], a[28:31]
    ds_read_b64_tr_b16 a[198:199], v240 offset:1608
    v_fma_f32 v123, v123, s20, v251
    v_mfma_f32_16x16x32_bf16 a[68:71], a[204:207], v[144:147], a[68:71]
    v_exp_f32 v99, v99
    v_mfma_f32_16x16x32_bf16 a[76:79], a[204:207], v[152:155], a[76:79]
    v_cvt_pk_bf16_f32 v97, v98, v99
    s_waitcnt lgkmcnt(4)
    v_mfma_f32_16x16x32_bf16 a[32:35], a[208:211], v[128:131], a[32:35]
    ds_read_b64_tr_b16 a[200:201], v240 offset:2048
    v_fma_f32 v100, v100, s20, v248
    v_mfma_f32_16x16x32_bf16 a[40:43], a[208:211], v[136:139], a[40:43]
    ds_read_b64_tr_b16 a[202:203], v240 offset:2560
    s_add_u32 m0, s28, 896
    v_mfma_f32_16x16x32_bf16 a[80:83], a[208:211], v[144:147], a[80:83]
    buffer_load_dwordx4 v242, s[48:51], s25 offen offset:128 nt lds
    v_mfma_f32_16x16x32_bf16 a[88:91], a[208:211], v[152:155], a[88:91]
    v_exp_f32 v106, v106
    v_mfma_f32_16x16x32_bf16 a[36:39], a[212:215], v[128:131], a[36:39]
    ds_read_b64_tr_b16 a[204:205], v240 offset:2056
    v_fma_f32 v101, v101, s20, v248
    v_mfma_f32_16x16x32_bf16 a[44:47], a[212:215], v[136:139], a[44:47]
    ds_read_b64_tr_b16 a[206:207], v240 offset:2568
    v_fma_f32 v102, v102, s20, v248
    v_mfma_f32_16x16x32_bf16 a[84:87], a[212:215], v[144:147], a[84:87]
    v_exp_f32 v107, v107
    v_mfma_f32_16x16x32_bf16 a[92:95], a[212:215], v[152:155], a[92:95]
    v_cvt_pk_bf16_f32 v105, v106, v107
    s_waitcnt lgkmcnt(4)
    v_mfma_f32_16x16x32_bf16 v[0:3], a[192:195], v[128:131], v[0:3]
    ds_read_b64_tr_b16 a[208:209], v240 offset:2112
    v_fma_f32 v103, v103, s20, v248
    v_mfma_f32_16x16x32_bf16 v[8:11], a[192:195], v[136:139], v[8:11]
    ds_read_b64_tr_b16 a[210:211], v240 offset:2624
    v_fma_f32 v108, v108, s20, v249
    v_mfma_f32_16x16x32_bf16 v[48:51], a[192:195], v[144:147], v[48:51]
    buffer_store_dwordx4 v[172:175], v243, s[16:19], s45 offen offset:384 nt
    v_mfma_f32_16x16x32_bf16 v[56:59], a[192:195], v[152:155], v[56:59]
    v_exp_f32 v114, v114
    v_mfma_f32_16x16x32_bf16 v[4:7], a[196:199], v[128:131], v[4:7]
    ds_read_b64_tr_b16 a[212:213], v240 offset:2120
    v_fma_f32 v109, v109, s20, v249
    v_mfma_f32_16x16x32_bf16 v[12:15], a[196:199], v[136:139], v[12:15]
    ds_read_b64_tr_b16 a[214:215], v240 offset:2632
    v_fma_f32 v110, v110, s20, v249
    v_mfma_f32_16x16x32_bf16 v[52:55], a[196:199], v[144:147], v[52:55]
    v_exp_f32 v115, v115
    v_mfma_f32_16x16x32_bf16 v[60:63], a[196:199], v[152:155], v[60:63]
    v_cvt_pk_bf16_f32 v113, v114, v115
    s_waitcnt lgkmcnt(4)
    v_mfma_f32_16x16x32_bf16 v[16:19], a[200:203], v[128:131], v[16:19]
    ds_read_b128 a[192:195], v236 offset:36864
    v_fma_f32 v111, v111, s20, v249
    v_mfma_f32_16x16x32_bf16 v[24:27], a[200:203], v[136:139], v[24:27]
    s_add_u32 m0, s28, 1792
    v_fma_f32 v116, v116, s20, v250
    v_mfma_f32_16x16x32_bf16 v[64:67], a[200:203], v[144:147], v[64:67]
    buffer_load_dwordx4 v242, s[48:51], s25 offen offset:256 nt lds
    v_mfma_f32_16x16x32_bf16 v[72:75], a[200:203], v[152:155], v[72:75]
    v_exp_f32 v122, v122
    v_mfma_f32_16x16x32_bf16 v[20:23], a[204:207], v[128:131], v[20:23]
    ds_read_b128 a[196:199], v237 offset:36864
    v_fma_f32 v117, v117, s20, v250
    v_mfma_f32_16x16x32_bf16 v[28:31], a[204:207], v[136:139], v[28:31]
    v_exp_f32 v123, v123
    v_mfma_f32_16x16x32_bf16 v[68:71], a[204:207], v[144:147], v[68:71]
    v_exp_f32 v100, v100
    v_mfma_f32_16x16x32_bf16 v[76:79], a[204:207], v[152:155], v[76:79]
    v_cvt_pk_bf16_f32 v121, v122, v123
    s_waitcnt lgkmcnt(2)
    v_mfma_f32_16x16x32_bf16 v[32:35], a[208:211], v[128:131], v[32:35]
    ds_read_b128 a[200:203], v236 offset:37888
    v_fma_f32 v118, v118, s20, v250
    v_mfma_f32_16x16x32_bf16 v[40:43], a[208:211], v[136:139], v[40:43]
    v_exp_f32 v101, v101
    v_mfma_f32_16x16x32_bf16 v[80:83], a[208:211], v[144:147], v[80:83]
    ds_read_b128 v[168:171], v238 offset:2048
    buffer_load_dword v233, v232, s[4:7], s58 offen
    v_mfma_f32_16x16x32_bf16 v[88:91], a[208:211], v[152:155], v[88:91]
    s_add_u32 s25, s26, 12288
    ds_read_b128 v[172:175], v239 offset:2048
    s_add_u32 s58, s58, 25161728
    v_mfma_f32_16x16x32_bf16 v[36:39], a[212:215], v[128:131], v[36:39]
    ds_read_b128 a[204:207], v237 offset:37888
    v_cvt_pk_bf16_f32 v98, v100, v101
    v_mfma_f32_16x16x32_bf16 v[44:47], a[212:215], v[136:139], v[44:47]
    v_exp_f32 v102, v102
    v_mfma_f32_16x16x32_bf16 v[84:87], a[212:215], v[144:147], v[84:87]
    v_exp_f32 v103, v103
    v_mfma_f32_16x16x32_bf16 v[92:95], a[212:215], v[152:155], v[92:95]
    v_cvt_pk_bf16_f32 v99, v102, v103
    s_waitcnt lgkmcnt(4)
    v_mfma_f32_16x16x32_bf16 v[128:131], a[192:195], a[96:99], 0
    ds_read_b128 a[208:211], v236 offset:38912
    v_fma_f32 v119, v119, s20, v250
    v_mfma_f32_16x16x32_bf16 a[232:235], a[224:227], v[96:99], a[232:235]
    v_exp_f32 v108, v108
    v_mfma_f32_16x16x32_bf16 v[136:139], a[192:195], a[104:107], 0
    s_add_u32 m0, s27, 24576
    v_fma_f32 v124, v124, s20, v251
    v_mfma_f32_16x16x32_bf16 v[144:147], a[192:195], a[144:147], 0
    buffer_load_dwordx4 v241, s[8:11], s26 offen nt lds
    v_mfma_f32_16x16x32_bf16 v[152:155], a[192:195], a[152:155], 0
    v_exp_f32 v109, v109
    v_mfma_f32_16x16x32_bf16 v[128:131], a[196:199], a[100:103], v[128:131]
    ds_read_b128 a[212:215], v237 offset:38912
    v_cvt_pk_bf16_f32 v106, v108, v109
    v_mfma_f32_16x16x32_bf16 v[136:139], a[196:199], a[108:111], v[136:139]
    v_exp_f32 v110, v110
    v_mfma_f32_16x16x32_bf16 v[144:147], a[196:199], a[148:151], v[144:147]
    v_exp_f32 v111, v111
    v_mfma_f32_16x16x32_bf16 v[152:155], a[196:199], a[156:159], v[152:155]
    v_cvt_pk_bf16_f32 v107, v110, v111
    s_waitcnt lgkmcnt(2)
    v_mfma_f32_16x16x32_bf16 v[128:131], a[200:203], a[112:115], v[128:131]
    ds_read_b128 a[192:195], v236 offset:43008
    v_fma_f32 v125, v125, s20, v251
    v_mfma_f32_16x16x32_bf16 a[232:235], a[228:231], v[104:107], a[232:235]
    v_exp_f32 v116, v116
    v_mfma_f32_16x16x32_bf16 v[136:139], a[200:203], a[120:123], v[136:139]
    v_exp_f32 v117, v117
    v_mfma_f32_16x16x32_bf16 v[144:147], a[200:203], a[160:163], v[144:147]
    buffer_store_dwordx4 v[204:207], v243, s[16:19], s47 offen offset:384 nt
    v_mfma_f32_16x16x32_bf16 v[152:155], a[200:203], a[168:171], v[152:155]
    v_exp_f32 v118, v118
    v_mfma_f32_16x16x32_bf16 v[128:131], a[204:207], a[116:119], v[128:131]
    ds_read_b128 a[196:199], v237 offset:43008
    v_cvt_pk_bf16_f32 v114, v116, v117
    v_mfma_f32_16x16x32_bf16 v[136:139], a[204:207], a[124:127], v[136:139]
    v_exp_f32 v119, v119
    v_mfma_f32_16x16x32_bf16 v[144:147], a[204:207], a[164:167], v[144:147]
    v_exp_f32 v124, v124
    v_mfma_f32_16x16x32_bf16 v[152:155], a[204:207], a[172:175], v[152:155]
    v_fma_f32 v126, v126, s20, v251
    s_waitcnt lgkmcnt(2)
    v_mfma_f32_16x16x32_bf16 v[128:131], a[208:211], a[128:131], v[128:131]
    ds_read_b128 a[200:203], v236 offset:44032
    v_fma_f32 v127, v127, s20, v251
    v_mfma_f32_16x16x32_bf16 v[136:139], a[208:211], a[136:139], v[136:139]
    s_add_u32 m0, s27, 25472
    v_cvt_pk_bf16_f32 v115, v118, v119
    v_mfma_f32_16x16x32_bf16 v[144:147], a[208:211], a[176:179], v[144:147]
    buffer_load_dwordx4 v241, s[8:11], s26 offen offset:128 nt lds
    v_mfma_f32_16x16x32_bf16 a[236:239], a[224:227], v[112:115], a[236:239]
    v_exp_f32 v125, v125
    v_mfma_f32_16x16x32_bf16 v[152:155], a[208:211], a[184:187], v[152:155]
    v_exp_f32 v126, v126
    v_mfma_f32_16x16x32_bf16 v[128:131], a[212:215], a[132:135], v[128:131]
    ds_read_b128 a[204:207], v237 offset:44032
    v_cvt_pk_bf16_f32 v122, v124, v125
    v_mfma_f32_16x16x32_bf16 v[136:139], a[212:215], a[140:143], v[136:139]
    s_cmp_eq_u32 s29, s30
    s_cselect_b32 s35, -49664, s37
    v_mfma_f32_16x16x32_bf16 v[144:147], a[212:215], a[180:183], v[144:147]
    v_exp_f32 v127, v127
    v_mfma_f32_16x16x32_bf16 v[152:155], a[212:215], a[188:191], v[152:155]
    s_add_u32 s28, s29, s35
    s_waitcnt lgkmcnt(2)
    v_mfma_f32_16x16x32_bf16 v[132:135], a[192:195], a[96:99], 0
    ds_read_b128 a[208:211], v236 offset:45056
    v_add_u32 v240, s35, v240
    v_mfma_f32_16x16x32_bf16 v[140:143], a[192:195], a[104:107], 0
    v_cvt_pk_bf16_f32 v123, v126, v127
    v_mfma_f32_16x16x32_bf16 v[148:151], a[192:195], a[144:147], 0
    ds_read_b128 v[200:203], v238 offset:6144
    v_mfma_f32_16x16x32_bf16 v[156:159], a[192:195], a[152:155], 0
    ds_read_b128 v[204:207], v239 offset:6144
    v_fma_f32 v128, v128, s20, v248
    v_mfma_f32_16x16x32_bf16 v[132:135], a[196:199], a[100:103], v[132:135]
    ds_read_b128 a[212:215], v237 offset:45056
    v_fma_f32 v129, v129, s20, v248
    v_mfma_f32_16x16x32_bf16 v[140:143], a[196:199], a[108:111], v[140:143]
    v_exp_f32 v128, v128
    v_mfma_f32_16x16x32_bf16 v[148:151], a[196:199], a[148:151], v[148:151]
    v_exp_f32 v129, v129
    v_mfma_f32_16x16x32_bf16 v[156:159], a[196:199], a[156:159], v[156:159]
    v_fma_f32 v136, v136, s20, v249
    s_waitcnt lgkmcnt(4)
    v_mfma_f32_16x16x32_bf16 v[132:135], a[200:203], a[112:115], v[132:135]
    ds_read_b64_tr_b16 a[192:193], v240
    v_fma_f32 v137, v137, s20, v249
    v_mfma_f32_16x16x32_bf16 v[140:143], a[200:203], a[120:123], v[140:143]
    ds_read_b64_tr_b16 a[194:195], v240 offset:512
    s_add_u32 m0, s27, 26368
    v_mfma_f32_16x16x32_bf16 a[236:239], a[228:231], v[120:123], a[236:239]
    v_exp_f32 v136, v136
    v_mfma_f32_16x16x32_bf16 v[148:151], a[200:203], a[160:163], v[148:151]
    buffer_load_dwordx4 v241, s[8:11], s26 offen offset:256 nt lds
    v_mfma_f32_16x16x32_bf16 v[156:159], a[200:203], a[168:171], v[156:159]
    v_exp_f32 v137, v137
    v_mfma_f32_16x16x32_bf16 v[132:135], a[204:207], a[116:119], v[132:135]
    ds_read_b64_tr_b16 a[196:197], v240 offset:8
    v_fma_f32 v144, v144, s20, v250
    v_mfma_f32_16x16x32_bf16 v[140:143], a[204:207], a[124:127], v[140:143]
    ds_read_b64_tr_b16 a[198:199], v240 offset:520
    v_fma_f32 v145, v145, s20, v250
    v_mfma_f32_16x16x32_bf16 v[148:151], a[204:207], a[164:167], v[148:151]
    v_exp_f32 v144, v144
    v_mfma_f32_16x16x32_bf16 v[156:159], a[204:207], a[172:175], v[156:159]
    v_fma_f32 v152, v152, s20, v251
    s_waitcnt lgkmcnt(4)
    v_mfma_f32_16x16x32_bf16 v[132:135], a[208:211], a[128:131], v[132:135]
    ds_read_b64_tr_b16 a[200:201], v240 offset:64
    v_fma_f32 v153, v153, s20, v251
    v_mfma_f32_16x16x32_bf16 v[140:143], a[208:211], a[136:139], v[140:143]
    ds_read_b64_tr_b16 a[202:203], v240 offset:576
    s_add_u32 m0, s38, 1920
    v_mfma_f32_16x16x32_bf16 v[148:151], a[208:211], a[176:179], v[148:151]
    buffer_load_dwordx4 v244, s[4:7], s41 offen offset:128 nt lds
    v_mfma_f32_16x16x32_bf16 v[156:159], a[208:211], a[184:187], v[156:159]
    v_exp_f32 v145, v145
    v_mfma_f32_16x16x32_bf16 v[132:135], a[212:215], a[132:135], v[132:135]
    ds_read_b64_tr_b16 a[204:205], v240 offset:72
    v_fma_f32 v130, v130, s20, v248
    v_mfma_f32_16x16x32_bf16 v[140:143], a[212:215], a[140:143], v[140:143]
    ds_read_b64_tr_b16 a[206:207], v240 offset:584
    v_cvt_pk_bf16_f32 v128, v128, v129
    v_mfma_f32_16x16x32_bf16 v[148:151], a[212:215], a[180:183], v[148:151]
    s_waitcnt vmcnt(20)
    s_barrier
    v_mfma_f32_16x16x32_bf16 v[156:159], a[212:215], a[188:191], v[156:159]
    v_cvt_pk_bf16_f32 v136, v136, v137
    s_waitcnt lgkmcnt(4)
    v_mfma_f32_16x16x32_bf16 a[0:3], a[192:195], v[96:99], a[0:3]
    ds_read_b64_tr_b16 a[208:209], v240 offset:1024
    v_cvt_pk_bf16_f32 v144, v144, v145
    v_mfma_f32_16x16x32_bf16 a[8:11], a[192:195], v[104:107], a[8:11]
    ds_read_b64_tr_b16 a[210:211], v240 offset:1536
    s_add_u32 m0, s29, 0
    v_mfma_f32_16x16x32_bf16 a[48:51], a[192:195], v[112:115], a[48:51]
    buffer_load_dwordx4 v242, s[48:51], s26 offen nt lds
    v_mfma_f32_16x16x32_bf16 a[56:59], a[192:195], v[120:123], a[56:59]
    v_exp_f32 v152, v152
    v_mfma_f32_16x16x32_bf16 a[4:7], a[196:199], v[96:99], a[4:7]
    ds_read_b64_tr_b16 a[212:213], v240 offset:1032
    v_fma_f32 v131, v131, s20, v248
    v_mfma_f32_16x16x32_bf16 a[12:15], a[196:199], v[104:107], a[12:15]
    ds_read_b64_tr_b16 a[214:215], v240 offset:1544
    v_fma_f32 v138, v138, s20, v249
    v_mfma_f32_16x16x32_bf16 a[52:55], a[196:199], v[112:115], a[52:55]
    v_exp_f32 v153, v153
    v_mfma_f32_16x16x32_bf16 a[60:63], a[196:199], v[120:123], a[60:63]
    v_cvt_pk_bf16_f32 v152, v152, v153
    s_waitcnt lgkmcnt(4)
    v_mfma_f32_16x16x32_bf16 a[16:19], a[200:203], v[96:99], a[16:19]
    ds_read_b64_tr_b16 a[192:193], v240 offset:1088
    v_fma_f32 v139, v139, s20, v249
    v_mfma_f32_16x16x32_bf16 a[24:27], a[200:203], v[104:107], a[24:27]
    ds_read_b64_tr_b16 a[194:195], v240 offset:1600
    v_fma_f32 v146, v146, s20, v250
    v_mfma_f32_16x16x32_bf16 a[64:67], a[200:203], v[112:115], a[64:67]
    v_exp_f32 v130, v130
    v_mfma_f32_16x16x32_bf16 a[72:75], a[200:203], v[120:123], a[72:75]
    v_exp_f32 v131, v131
    v_mfma_f32_16x16x32_bf16 a[20:23], a[204:207], v[96:99], a[20:23]
    ds_read_b64_tr_b16 a[196:197], v240 offset:1096
    v_cvt_pk_bf16_f32 v129, v130, v131
    v_mfma_f32_16x16x32_bf16 a[28:31], a[204:207], v[104:107], a[28:31]
    ds_read_b64_tr_b16 a[198:199], v240 offset:1608
    v_fma_f32 v147, v147, s20, v250
    v_mfma_f32_16x16x32_bf16 a[68:71], a[204:207], v[112:115], a[68:71]
    v_exp_f32 v138, v138
    v_mfma_f32_16x16x32_bf16 a[76:79], a[204:207], v[120:123], a[76:79]
    v_fma_f32 v154, v154, s20, v251
    s_waitcnt lgkmcnt(4)
    v_mfma_f32_16x16x32_bf16 a[32:35], a[208:211], v[96:99], a[32:35]
    ds_read_b64_tr_b16 a[200:201], v240 offset:2048
    v_fma_f32 v155, v155, s20, v251
    v_mfma_f32_16x16x32_bf16 a[40:43], a[208:211], v[104:107], a[40:43]
    ds_read_b64_tr_b16 a[202:203], v240 offset:2560
    s_add_u32 m0, s29, 896
    v_mfma_f32_16x16x32_bf16 a[80:83], a[208:211], v[112:115], a[80:83]
    buffer_load_dwordx4 v242, s[48:51], s26 offen offset:128 nt lds
    v_mfma_f32_16x16x32_bf16 a[88:91], a[208:211], v[120:123], a[88:91]
    v_exp_f32 v139, v139
    v_mfma_f32_16x16x32_bf16 a[36:39], a[212:215], v[96:99], a[36:39]
    ds_read_b64_tr_b16 a[204:205], v240 offset:2056
    v_cvt_pk_bf16_f32 v137, v138, v139
    v_mfma_f32_16x16x32_bf16 a[44:47], a[212:215], v[104:107], a[44:47]
    ds_read_b64_tr_b16 a[206:207], v240 offset:2568
    v_fma_f32 v132, v132, s20, v248
    v_mfma_f32_16x16x32_bf16 a[84:87], a[212:215], v[112:115], a[84:87]
    v_exp_f32 v146, v146
    v_mfma_f32_16x16x32_bf16 a[92:95], a[212:215], v[120:123], a[92:95]
    v_fma_f32 v133, v133, s20, v248
    s_waitcnt lgkmcnt(4)
    v_mfma_f32_16x16x32_bf16 v[0:3], a[192:195], v[96:99], v[0:3]
    ds_read_b64_tr_b16 a[208:209], v240 offset:2112
    v_fma_f32 v134, v134, s20, v248
    v_mfma_f32_16x16x32_bf16 v[8:11], a[192:195], v[104:107], v[8:11]
    ds_read_b64_tr_b16 a[210:211], v240 offset:2624
    s_add_u32 m0, s38, 6016
    v_mfma_f32_16x16x32_bf16 v[48:51], a[192:195], v[112:115], v[48:51]
    buffer_load_dwordx4 v244, s[4:7], s43 offen offset:128 nt lds
    v_mfma_f32_16x16x32_bf16 v[56:59], a[192:195], v[120:123], v[56:59]
    v_exp_f32 v147, v147
    v_mfma_f32_16x16x32_bf16 v[4:7], a[196:199], v[96:99], v[4:7]
    ds_read_b64_tr_b16 a[212:213], v240 offset:2120
    v_cvt_pk_bf16_f32 v145, v146, v147
    v_mfma_f32_16x16x32_bf16 v[12:15], a[196:199], v[104:107], v[12:15]
    ds_read_b64_tr_b16 a[214:215], v240 offset:2632
    v_fma_f32 v135, v135, s20, v248
    v_mfma_f32_16x16x32_bf16 v[52:55], a[196:199], v[112:115], v[52:55]
    v_exp_f32 v154, v154
    v_mfma_f32_16x16x32_bf16 v[60:63], a[196:199], v[120:123], v[60:63]
    v_fma_f32 v140, v140, s20, v249
    s_waitcnt lgkmcnt(4)
    v_mfma_f32_16x16x32_bf16 v[16:19], a[200:203], v[96:99], v[16:19]
    ds_read_b128 a[192:195], v236
    v_fma_f32 v141, v141, s20, v249
    v_mfma_f32_16x16x32_bf16 v[24:27], a[200:203], v[104:107], v[24:27]
    s_add_u32 m0, s29, 1792
    v_fma_f32 v142, v142, s20, v249
    v_mfma_f32_16x16x32_bf16 v[64:67], a[200:203], v[112:115], v[64:67]
    buffer_load_dwordx4 v242, s[48:51], s26 offen offset:256 nt lds
    v_mfma_f32_16x16x32_bf16 v[72:75], a[200:203], v[120:123], v[72:75]
    v_exp_f32 v155, v155
    v_mfma_f32_16x16x32_bf16 v[20:23], a[204:207], v[96:99], v[20:23]
    ds_read_b128 a[196:199], v237
    v_cvt_pk_bf16_f32 v153, v154, v155
    v_mfma_f32_16x16x32_bf16 v[28:31], a[204:207], v[104:107], v[28:31]
    v_exp_f32 v132, v132
    v_mfma_f32_16x16x32_bf16 v[68:71], a[204:207], v[112:115], v[68:71]
    v_exp_f32 v133, v133
    v_mfma_f32_16x16x32_bf16 v[76:79], a[204:207], v[120:123], v[76:79]
    v_cvt_pk_bf16_f32 v130, v132, v133
    s_waitcnt lgkmcnt(2)
    v_mfma_f32_16x16x32_bf16 v[32:35], a[208:211], v[96:99], v[32:35]
    ds_read_b128 a[200:203], v236 offset:1024
    v_fma_f32 v143, v143, s20, v249
    v_mfma_f32_16x16x32_bf16 v[40:43], a[208:211], v[104:107], v[40:43]
    v_exp_f32 v134, v134
    v_mfma_f32_16x16x32_bf16 v[80:83], a[208:211], v[112:115], v[80:83]
    v_exp_f32 v135, v135
    v_mfma_f32_16x16x32_bf16 v[88:91], a[208:211], v[120:123], v[88:91]
    s_add_u32 s26, s25, 12288
    v_cvt_pk_bf16_f32 v131, v134, v135
    v_mfma_f32_16x16x32_bf16 v[36:39], a[212:215], v[96:99], v[36:39]
    ds_read_b128 a[204:207], v237 offset:1024
    v_fma_f32 v148, v148, s20, v250
    v_mfma_f32_16x16x32_bf16 a[232:235], a[224:227], v[128:131], a[232:235]
    v_exp_f32 v140, v140
    v_mfma_f32_16x16x32_bf16 v[44:47], a[212:215], v[104:107], v[44:47]
    v_exp_f32 v141, v141
    v_mfma_f32_16x16x32_bf16 v[84:87], a[212:215], v[112:115], v[84:87]
    v_exp_f32 v142, v142
    v_mfma_f32_16x16x32_bf16 v[92:95], a[212:215], v[120:123], v[92:95]
    v_fma_f32 v149, v149, s20, v250
    s_waitcnt lgkmcnt(2)
    v_mfma_f32_16x16x32_bf16 v[96:99], a[192:195], a[96:99], 0
    ds_read_b128 a[208:211], v236 offset:2048
    v_cvt_pk_bf16_f32 v138, v140, v141
    v_mfma_f32_16x16x32_bf16 v[104:107], a[192:195], a[104:107], 0
    s_add_u32 m0, s27, 36864
    v_fma_f32 v150, v150, s20, v250
    v_mfma_f32_16x16x32_bf16 v[112:115], a[192:195], a[144:147], 0
    buffer_load_dwordx4 v241, s[8:11], s25 offen nt lds
    v_mfma_f32_16x16x32_bf16 v[120:123], a[192:195], a[152:155], 0
    v_exp_f32 v143, v143
    v_mfma_f32_16x16x32_bf16 v[96:99], a[196:199], a[100:103], v[96:99]
    ds_read_b128 a[212:215], v237 offset:2048
    v_cvt_pk_bf16_f32 v139, v142, v143
    v_mfma_f32_16x16x32_bf16 v[104:107], a[196:199], a[108:111], v[104:107]
    v_exp_f32 v148, v148
    v_mfma_f32_16x16x32_bf16 a[232:235], a[228:231], v[136:139], a[232:235]
    v_exp_f32 v149, v149
    v_mfma_f32_16x16x32_bf16 v[112:115], a[196:199], a[148:151], v[112:115]
    v_exp_f32 v150, v150
    v_mfma_f32_16x16x32_bf16 v[120:123], a[196:199], a[156:159], v[120:123]
    v_fma_f32 v151, v151, s20, v250
    s_waitcnt lgkmcnt(2)
    v_mfma_f32_16x16x32_bf16 v[96:99], a[200:203], a[112:115], v[96:99]
    ds_read_b128 a[192:195], v236 offset:6144
    v_fma_f32 v156, v156, s20, v251
    v_mfma_f32_16x16x32_bf16 v[104:107], a[200:203], a[120:123], v[104:107]
    v_exp_f32 v151, v151
    v_mfma_f32_16x16x32_bf16 v[112:115], a[200:203], a[160:163], v[112:115]
    buffer_store_dwordx4 v[176:179], v243, s[16:19], s45 offen offset:128 nt
    v_mfma_f32_16x16x32_bf16 v[120:123], a[200:203], a[168:171], v[120:123]
    v_exp_f32 v156, v156
    v_mfma_f32_16x16x32_bf16 v[96:99], a[204:207], a[116:119], v[96:99]
    ds_read_b128 a[196:199], v237 offset:6144
    v_fma_f32 v157, v157, s20, v251
    v_mfma_f32_16x16x32_bf16 v[104:107], a[204:207], a[124:127], v[104:107]
    v_exp_f32 v157, v157
    v_mfma_f32_16x16x32_bf16 v[112:115], a[204:207], a[164:167], v[112:115]
    v_fma_f32 v158, v158, s20, v251
    v_fma_f32 v159, v159, s20, v251
    v_mfma_f32_16x16x32_bf16 v[120:123], a[204:207], a[172:175], v[120:123]
    v_cvt_pk_bf16_f32 v146, v148, v149
    s_waitcnt lgkmcnt(2)
    v_mfma_f32_16x16x32_bf16 v[96:99], a[208:211], a[128:131], v[96:99]
    ds_read_b128 a[200:203], v236 offset:7168
    v_cvt_pk_bf16_f32 v147, v150, v151
    v_mfma_f32_16x16x32_bf16 v[104:107], a[208:211], a[136:139], v[104:107]
    s_add_u32 m0, s27, 37760
    v_cvt_pk_bf16_f32 v154, v156, v157
    v_mfma_f32_16x16x32_bf16 a[236:239], a[224:227], v[144:147], a[236:239]
    v_exp_f32 v158, v158
    v_mfma_f32_16x16x32_bf16 v[112:115], a[208:211], a[176:179], v[112:115]
    buffer_load_dwordx4 v241, s[8:11], s25 offen offset:128 nt lds
    v_mfma_f32_16x16x32_bf16 v[120:123], a[208:211], a[184:187], v[120:123]
    v_exp_f32 v159, v159
    v_mfma_f32_16x16x32_bf16 v[96:99], a[212:215], a[132:135], v[96:99]
    ds_read_b128 a[204:207], v237 offset:7168
    v_cvt_pk_bf16_f32 v155, v158, v159
    v_mfma_f32_16x16x32_bf16 v[104:107], a[212:215], a[140:143], v[104:107]
    s_cmp_eq_u32 s28, s30
    s_cselect_b32 s35, -49664, s37
    v_mfma_f32_16x16x32_bf16 a[236:239], a[228:231], v[152:155], a[236:239]
    v_mfma_f32_16x16x32_bf16 v[112:115], a[212:215], a[180:183], v[112:115]
    v_mfma_f32_16x16x32_bf16 v[120:123], a[212:215], a[188:191], v[120:123]
    s_add_u32 s29, s28, s35
    s_waitcnt lgkmcnt(2)
    v_mfma_f32_16x16x32_bf16 v[100:103], a[192:195], a[96:99], 0
    ds_read_b128 a[208:211], v236 offset:8192
    v_add_u32 v240, s35, v240
    v_mfma_f32_16x16x32_bf16 v[108:111], a[192:195], a[104:107], 0
    v_mfma_f32_16x16x32_bf16 v[116:119], a[192:195], a[144:147], 0
    s_waitcnt vmcnt(20)
    ds_read_b128 v[176:179], v238
    v_mfma_f32_16x16x32_bf16 v[124:127], a[192:195], a[152:155], 0
    ds_read_b128 v[180:183], v239
    v_fma_f32 v96, v96, s20, v248
    v_mfma_f32_16x16x32_bf16 v[100:103], a[196:199], a[100:103], v[100:103]
    ds_read_b128 a[212:215], v237 offset:8192
    v_fma_f32 v97, v97, s20, v248
    v_mfma_f32_16x16x32_bf16 v[108:111], a[196:199], a[108:111], v[108:111]
    v_exp_f32 v96, v96
    v_mfma_f32_16x16x32_bf16 v[116:119], a[196:199], a[148:151], v[116:119]
    v_exp_f32 v97, v97
    v_mfma_f32_16x16x32_bf16 v[124:127], a[196:199], a[156:159], v[124:127]
    v_fma_f32 v104, v104, s20, v249
    s_waitcnt lgkmcnt(4)
    v_mfma_f32_16x16x32_bf16 v[100:103], a[200:203], a[112:115], v[100:103]
    ds_read_b64_tr_b16 a[192:193], v240
    v_fma_f32 v105, v105, s20, v249
    v_mfma_f32_16x16x32_bf16 v[108:111], a[200:203], a[120:123], v[108:111]
    ds_read_b64_tr_b16 a[194:195], v240 offset:512
    s_add_u32 m0, s27, 38656
    v_mfma_f32_16x16x32_bf16 v[116:119], a[200:203], a[160:163], v[116:119]
    buffer_load_dwordx4 v241, s[8:11], s25 offen offset:256 nt lds
    v_mfma_f32_16x16x32_bf16 v[124:127], a[200:203], a[168:171], v[124:127]
    v_exp_f32 v104, v104
    v_mfma_f32_16x16x32_bf16 v[100:103], a[204:207], a[116:119], v[100:103]
    ds_read_b64_tr_b16 a[196:197], v240 offset:8
    v_fma_f32 v112, v112, s20, v250
    v_mfma_f32_16x16x32_bf16 v[108:111], a[204:207], a[124:127], v[108:111]
    ds_read_b64_tr_b16 a[198:199], v240 offset:520
    v_fma_f32 v113, v113, s20, v250
    v_mfma_f32_16x16x32_bf16 v[116:119], a[204:207], a[164:167], v[116:119]
    v_exp_f32 v105, v105
    v_mfma_f32_16x16x32_bf16 v[124:127], a[204:207], a[172:175], v[124:127]
    v_fma_f32 v120, v120, s20, v251
    s_waitcnt lgkmcnt(4)
    v_mfma_f32_16x16x32_bf16 v[100:103], a[208:211], a[128:131], v[100:103]
    ds_read_b64_tr_b16 a[200:201], v240 offset:64
    v_cvt_pk_bf16_f32 v96, v96, v97
    v_mfma_f32_16x16x32_bf16 v[108:111], a[208:211], a[136:139], v[108:111]
    ds_read_b64_tr_b16 a[202:203], v240 offset:576
    v_cvt_pk_bf16_f32 v104, v104, v105
    v_mfma_f32_16x16x32_bf16 v[116:119], a[208:211], a[176:179], v[116:119]
    buffer_store_dwordx4 v[208:211], v243, s[16:19], s47 offen offset:128 nt
    v_mfma_f32_16x16x32_bf16 v[124:127], a[208:211], a[184:187], v[124:127]
    v_exp_f32 v112, v112
    v_mfma_f32_16x16x32_bf16 v[100:103], a[212:215], a[132:135], v[100:103]
    ds_read_b64_tr_b16 a[204:205], v240 offset:72
    v_fma_f32 v121, v121, s20, v251
    v_mfma_f32_16x16x32_bf16 v[108:111], a[212:215], a[140:143], v[108:111]
    ds_read_b64_tr_b16 a[206:207], v240 offset:584
    v_fma_f32 v98, v98, s20, v248
    v_mfma_f32_16x16x32_bf16 v[116:119], a[212:215], a[180:183], v[116:119]
    s_waitcnt vmcnt(20)
    s_barrier
    v_mfma_f32_16x16x32_bf16 v[124:127], a[212:215], a[188:191], v[124:127]
    v_fma_f32 v99, v99, s20, v248
    s_waitcnt lgkmcnt(4)
    v_mfma_f32_16x16x32_bf16 a[0:3], a[192:195], v[128:131], a[0:3]
    ds_read_b64_tr_b16 a[208:209], v240 offset:1024
    v_fma_f32 v106, v106, s20, v249
    v_mfma_f32_16x16x32_bf16 a[8:11], a[192:195], v[136:139], a[8:11]
    ds_read_b64_tr_b16 a[210:211], v240 offset:1536
    s_add_u32 m0, s28, 0
    v_mfma_f32_16x16x32_bf16 a[48:51], a[192:195], v[144:147], a[48:51]
    buffer_load_dwordx4 v242, s[48:51], s25 offen nt lds
    v_mfma_f32_16x16x32_bf16 a[56:59], a[192:195], v[152:155], a[56:59]
    v_exp_f32 v113, v113
    v_mfma_f32_16x16x32_bf16 a[4:7], a[196:199], v[128:131], a[4:7]
    ds_read_b64_tr_b16 a[212:213], v240 offset:1032
    v_cvt_pk_bf16_f32 v112, v112, v113
    v_mfma_f32_16x16x32_bf16 a[12:15], a[196:199], v[136:139], a[12:15]
    ds_read_b64_tr_b16 a[214:215], v240 offset:1544
    v_fma_f32 v107, v107, s20, v249
    v_mfma_f32_16x16x32_bf16 a[52:55], a[196:199], v[144:147], a[52:55]
    v_exp_f32 v120, v120
    v_mfma_f32_16x16x32_bf16 a[60:63], a[196:199], v[152:155], a[60:63]
    v_fma_f32 v114, v114, s20, v250
    s_waitcnt lgkmcnt(4)
    v_mfma_f32_16x16x32_bf16 a[16:19], a[200:203], v[128:131], a[16:19]
    ds_read_b64_tr_b16 a[192:193], v240 offset:1088
    v_fma_f32 v115, v115, s20, v250
    v_mfma_f32_16x16x32_bf16 a[24:27], a[200:203], v[136:139], a[24:27]
    ds_read_b64_tr_b16 a[194:195], v240 offset:1600
    v_fma_f32 v122, v122, s20, v251
    v_mfma_f32_16x16x32_bf16 a[64:67], a[200:203], v[144:147], a[64:67]
    s_waitcnt vmcnt(20)
    ds_read_b128 v[208:211], v238 offset:4096
    v_fma_f32 v123, v123, s20, v251
    v_mfma_f32_16x16x32_bf16 a[72:75], a[200:203], v[152:155], a[72:75]
    ds_read_b128 v[212:215], v239 offset:4096
    v_fma_f32 v100, v100, s20, v248
    v_mfma_f32_16x16x32_bf16 a[20:23], a[204:207], v[128:131], a[20:23]
    ds_read_b64_tr_b16 a[196:197], v240 offset:1096
    v_fma_f32 v101, v101, s20, v248
    v_mfma_f32_16x16x32_bf16 a[28:31], a[204:207], v[136:139], a[28:31]
    ds_read_b64_tr_b16 a[198:199], v240 offset:1608
    v_fma_f32 v102, v102, s20, v248
    v_mfma_f32_16x16x32_bf16 a[68:71], a[204:207], v[144:147], a[68:71]
    v_exp_f32 v121, v121
    v_mfma_f32_16x16x32_bf16 a[76:79], a[204:207], v[152:155], a[76:79]
    v_cvt_pk_bf16_f32 v120, v120, v121
    s_waitcnt lgkmcnt(6)
    v_mfma_f32_16x16x32_bf16 a[32:35], a[208:211], v[128:131], a[32:35]
    ds_read_b64_tr_b16 a[200:201], v240 offset:2048
    v_fma_f32 v103, v103, s20, v248
    v_mfma_f32_16x16x32_bf16 a[40:43], a[208:211], v[136:139], a[40:43]
    ds_read_b64_tr_b16 a[202:203], v240 offset:2560
    s_add_u32 m0, s28, 896
    v_mfma_f32_16x16x32_bf16 a[80:83], a[208:211], v[144:147], a[80:83]
    buffer_load_dwordx4 v242, s[48:51], s25 offen offset:128 nt lds
    v_mfma_f32_16x16x32_bf16 a[88:91], a[208:211], v[152:155], a[88:91]
    v_exp_f32 v98, v98
    v_mfma_f32_16x16x32_bf16 a[36:39], a[212:215], v[128:131], a[36:39]
    ds_read_b64_tr_b16 a[204:205], v240 offset:2056
    v_fma_f32 v108, v108, s20, v249
    v_mfma_f32_16x16x32_bf16 a[44:47], a[212:215], v[136:139], a[44:47]
    ds_read_b64_tr_b16 a[206:207], v240 offset:2568
    v_fma_f32 v109, v109, s20, v249
    v_mfma_f32_16x16x32_bf16 a[84:87], a[212:215], v[144:147], a[84:87]
    v_exp_f32 v99, v99
    v_mfma_f32_16x16x32_bf16 a[92:95], a[212:215], v[152:155], a[92:95]
    v_cvt_pk_bf16_f32 v97, v98, v99
    s_waitcnt lgkmcnt(4)
    v_mfma_f32_16x16x32_bf16 v[0:3], a[192:195], v[128:131], v[0:3]
    ds_read_b64_tr_b16 a[208:209], v240 offset:2112
    v_fma_f32 v110, v110, s20, v249
    v_mfma_f32_16x16x32_bf16 v[8:11], a[192:195], v[136:139], v[8:11]
    ds_read_b64_tr_b16 a[210:211], v240 offset:2624
    s_add_u32 m0, s38, -128
    v_mfma_f32_16x16x32_bf16 v[48:51], a[192:195], v[144:147], v[48:51]
    buffer_load_dwordx4 v245, s[4:7], s41 offen offset:3200 nt lds
    v_mfma_f32_16x16x32_bf16 v[56:59], a[192:195], v[152:155], v[56:59]
    v_exp_f32 v106, v106
    v_mfma_f32_16x16x32_bf16 v[4:7], a[196:199], v[128:131], v[4:7]
    ds_read_b64_tr_b16 a[212:213], v240 offset:2120
    v_fma_f32 v111, v111, s20, v249
    v_mfma_f32_16x16x32_bf16 v[12:15], a[196:199], v[136:139], v[12:15]
    ds_read_b64_tr_b16 a[214:215], v240 offset:2632
    v_fma_f32 v116, v116, s20, v250
    v_mfma_f32_16x16x32_bf16 v[52:55], a[196:199], v[144:147], v[52:55]
    v_exp_f32 v107, v107
    v_mfma_f32_16x16x32_bf16 v[60:63], a[196:199], v[152:155], v[60:63]
    v_cvt_pk_bf16_f32 v105, v106, v107
    s_waitcnt lgkmcnt(4)
    v_mfma_f32_16x16x32_bf16 v[16:19], a[200:203], v[128:131], v[16:19]
    ds_read_b128 a[192:195], v236 offset:12288
    v_fma_f32 v117, v117, s20, v250
    v_mfma_f32_16x16x32_bf16 v[24:27], a[200:203], v[136:139], v[24:27]
    s_add_u32 m0, s28, 1792
    v_fma_f32 v118, v118, s20, v250
    v_mfma_f32_16x16x32_bf16 v[64:67], a[200:203], v[144:147], v[64:67]
    buffer_load_dwordx4 v242, s[48:51], s25 offen offset:256 nt lds
    v_mfma_f32_16x16x32_bf16 v[72:75], a[200:203], v[152:155], v[72:75]
    v_exp_f32 v114, v114
    v_mfma_f32_16x16x32_bf16 v[20:23], a[204:207], v[128:131], v[20:23]
    ds_read_b128 a[196:199], v237 offset:12288
    v_fma_f32 v119, v119, s20, v250
    v_mfma_f32_16x16x32_bf16 v[28:31], a[204:207], v[136:139], v[28:31]
    v_exp_f32 v115, v115
    v_mfma_f32_16x16x32_bf16 v[68:71], a[204:207], v[144:147], v[68:71]
    v_exp_f32 v122, v122
    v_mfma_f32_16x16x32_bf16 v[76:79], a[204:207], v[152:155], v[76:79]
    v_cvt_pk_bf16_f32 v113, v114, v115
    s_waitcnt lgkmcnt(2)
    v_mfma_f32_16x16x32_bf16 v[32:35], a[208:211], v[128:131], v[32:35]
    ds_read_b128 a[200:203], v236 offset:13312
    v_fma_f32 v124, v124, s20, v251
    v_mfma_f32_16x16x32_bf16 v[40:43], a[208:211], v[136:139], v[40:43]
    v_exp_f32 v123, v123
    v_mfma_f32_16x16x32_bf16 v[80:83], a[208:211], v[144:147], v[80:83]
    v_exp_f32 v100, v100
    v_mfma_f32_16x16x32_bf16 v[88:91], a[208:211], v[152:155], v[88:91]
    s_add_u32 s25, s26, 12288
    v_cvt_pk_bf16_f32 v121, v122, v123
    v_mfma_f32_16x16x32_bf16 v[36:39], a[212:215], v[128:131], v[36:39]
    ds_read_b128 a[204:207], v237 offset:13312
    v_fma_f32 v125, v125, s20, v251
    v_mfma_f32_16x16x32_bf16 v[44:47], a[212:215], v[136:139], v[44:47]
    v_exp_f32 v101, v101
    v_mfma_f32_16x16x32_bf16 v[84:87], a[212:215], v[144:147], v[84:87]
    v_exp_f32 v102, v102
    v_mfma_f32_16x16x32_bf16 v[92:95], a[212:215], v[152:155], v[92:95]
    v_cvt_pk_bf16_f32 v98, v100, v101
    s_waitcnt lgkmcnt(2)
    v_mfma_f32_16x16x32_bf16 v[128:131], a[192:195], a[96:99], 0
    ds_read_b128 a[208:211], v236 offset:14336
    v_fma_f32 v126, v126, s20, v251
    v_mfma_f32_16x16x32_bf16 v[136:139], a[192:195], a[104:107], 0
    s_add_u32 m0, s27, 0
    v_fma_f32 v127, v127, s20, v251
    v_mfma_f32_16x16x32_bf16 v[144:147], a[192:195], a[144:147], 0
    buffer_load_dwordx4 v241, s[8:11], s26 offen nt lds
    v_mfma_f32_16x16x32_bf16 v[152:155], a[192:195], a[152:155], 0
    v_exp_f32 v103, v103
    v_mfma_f32_16x16x32_bf16 v[128:131], a[196:199], a[100:103], v[128:131]
    ds_read_b128 a[212:215], v237 offset:14336
    v_cvt_pk_bf16_f32 v99, v102, v103
    v_mfma_f32_16x16x32_bf16 v[136:139], a[196:199], a[108:111], v[136:139]
    v_exp_f32 v108, v108
    v_mfma_f32_16x16x32_bf16 a[232:235], a[224:227], v[96:99], a[232:235]
    v_exp_f32 v109, v109
    v_mfma_f32_16x16x32_bf16 v[144:147], a[196:199], a[148:151], v[144:147]
    v_exp_f32 v110, v110
    v_mfma_f32_16x16x32_bf16 v[152:155], a[196:199], a[156:159], v[152:155]
    v_cvt_pk_bf16_f32 v106, v108, v109
    s_waitcnt lgkmcnt(2)
    v_mfma_f32_16x16x32_bf16 v[128:131], a[200:203], a[112:115], v[128:131]
    ds_read_b128 a[192:195], v236 offset:18432
    v_mfma_f32_16x16x32_bf16 v[136:139], a[200:203], a[120:123], v[136:139]
    s_add_u32 m0, s38, 3968
    v_mfma_f32_16x16x32_bf16 v[144:147], a[200:203], a[160:163], v[144:147]
    buffer_load_dwordx4 v245, s[4:7], s43 offen offset:3200 nt lds
    v_mfma_f32_16x16x32_bf16 v[152:155], a[200:203], a[168:171], v[152:155]
    v_exp_f32 v111, v111
    v_mfma_f32_16x16x32_bf16 v[128:131], a[204:207], a[116:119], v[128:131]
    ds_read_b128 a[196:199], v237 offset:18432
    v_cvt_pk_bf16_f32 v107, v110, v111
    v_mfma_f32_16x16x32_bf16 v[136:139], a[204:207], a[124:127], v[136:139]
    v_exp_f32 v116, v116
    v_mfma_f32_16x16x32_bf16 a[232:235], a[228:231], v[104:107], a[232:235]
    v_exp_f32 v117, v117
    v_mfma_f32_16x16x32_bf16 v[144:147], a[204:207], a[164:167], v[144:147]
    v_exp_f32 v118, v118
    v_mfma_f32_16x16x32_bf16 v[152:155], a[204:207], a[172:175], v[152:155]
    v_cvt_pk_bf16_f32 v114, v116, v117
    s_waitcnt lgkmcnt(2)
    v_mfma_f32_16x16x32_bf16 v[128:131], a[208:211], a[128:131], v[128:131]
    ds_read_b128 a[200:203], v236 offset:19456
    v_mfma_f32_16x16x32_bf16 v[136:139], a[208:211], a[136:139], v[136:139]
    s_add_u32 m0, s27, 896
    v_mfma_f32_16x16x32_bf16 v[144:147], a[208:211], a[176:179], v[144:147]
    buffer_load_dwordx4 v241, s[8:11], s26 offen offset:128 nt lds
    v_mfma_f32_16x16x32_bf16 v[152:155], a[208:211], a[184:187], v[152:155]
    v_exp_f32 v119, v119
    v_mfma_f32_16x16x32_bf16 v[128:131], a[212:215], a[132:135], v[128:131]
    ds_read_b128 a[204:207], v237 offset:19456
    v_cvt_pk_bf16_f32 v115, v118, v119
    v_mfma_f32_16x16x32_bf16 v[136:139], a[212:215], a[140:143], v[136:139]
    s_cmp_eq_u32 s29, s30
    s_cselect_b32 s35, -49664, s37
    v_mfma_f32_16x16x32_bf16 a[236:239], a[224:227], v[112:115], a[236:239]
    v_exp_f32 v124, v124
    v_mfma_f32_16x16x32_bf16 v[144:147], a[212:215], a[180:183], v[144:147]
    v_exp_f32 v125, v125
    v_mfma_f32_16x16x32_bf16 v[152:155], a[212:215], a[188:191], v[152:155]
    s_add_u32 s28, s29, s35
    s_waitcnt lgkmcnt(2)
    v_mfma_f32_16x16x32_bf16 v[132:135], a[192:195], a[96:99], 0
    ds_read_b128 a[208:211], v236 offset:20480
    v_add_u32 v240, s35, v240
    v_mfma_f32_16x16x32_bf16 v[140:143], a[192:195], a[104:107], 0
    v_exp_f32 v126, v126
    v_mfma_f32_16x16x32_bf16 v[148:151], a[192:195], a[144:147], 0
    v_exp_f32 v127, v127
    v_mfma_f32_16x16x32_bf16 v[156:159], a[192:195], a[152:155], 0
    v_cvt_pk_bf16_f32 v122, v124, v125
    v_cvt_pk_bf16_f32 v123, v126, v127
    v_mfma_f32_16x16x32_bf16 v[132:135], a[196:199], a[100:103], v[132:135]
    ds_read_b128 a[212:215], v237 offset:20480
    v_fma_f32 v128, v128, s20, v248
    v_mfma_f32_16x16x32_bf16 v[140:143], a[196:199], a[108:111], v[140:143]
    v_exp_f32 v128, v128
    v_mfma_f32_16x16x32_bf16 v[148:151], a[196:199], a[148:151], v[148:151]
    v_fma_f32 v129, v129, s20, v248
    v_fma_f32 v136, v136, s20, v249
    v_mfma_f32_16x16x32_bf16 v[156:159], a[196:199], a[156:159], v[156:159]
    v_fma_f32 v137, v137, s20, v249
    s_waitcnt lgkmcnt(2)
    v_mfma_f32_16x16x32_bf16 v[132:135], a[200:203], a[112:115], v[132:135]
    ds_read_b64_tr_b16 a[192:193], v240
    v_fma_f32 v144, v144, s20, v250
    v_mfma_f32_16x16x32_bf16 v[140:143], a[200:203], a[120:123], v[140:143]
    ds_read_b64_tr_b16 a[194:195], v240 offset:512
    s_add_u32 m0, s27, 1792
    v_mfma_f32_16x16x32_bf16 a[236:239], a[228:231], v[120:123], a[236:239]
    v_exp_f32 v129, v129
    v_mfma_f32_16x16x32_bf16 v[148:151], a[200:203], a[160:163], v[148:151]
    buffer_load_dwordx4 v241, s[8:11], s26 offen offset:256 nt lds
    v_mfma_f32_16x16x32_bf16 v[156:159], a[200:203], a[168:171], v[156:159]
    v_exp_f32 v136, v136
    v_mfma_f32_16x16x32_bf16 v[132:135], a[204:207], a[116:119], v[132:135]
    ds_read_b64_tr_b16 a[196:197], v240 offset:8
    v_fma_f32 v145, v145, s20, v250
    v_mfma_f32_16x16x32_bf16 v[140:143], a[204:207], a[124:127], v[140:143]
    ds_read_b64_tr_b16 a[198:199], v240 offset:520
    v_cvt_pk_bf16_f32 v128, v128, v129
    v_mfma_f32_16x16x32_bf16 v[148:151], a[204:207], a[164:167], v[148:151]
    v_exp_f32 v137, v137
    v_mfma_f32_16x16x32_bf16 v[156:159], a[204:207], a[172:175], v[156:159]
    v_fma_f32 v152, v152, s20, v251
    s_waitcnt lgkmcnt(4)
    v_mfma_f32_16x16x32_bf16 v[132:135], a[208:211], a[128:131], v[132:135]
    ds_read_b64_tr_b16 a[200:201], v240 offset:64
    v_cvt_pk_bf16_f32 v136, v136, v137
    v_mfma_f32_16x16x32_bf16 v[140:143], a[208:211], a[136:139], v[140:143]
    ds_read_b64_tr_b16 a[202:203], v240 offset:576
    v_fma_f32 v153, v153, s20, v251
    v_mfma_f32_16x16x32_bf16 v[148:151], a[208:211], a[176:179], v[148:151]
    buffer_store_dwordx4 v[184:187], v243, s[16:19], s44 offen offset:512 nt
    v_mfma_f32_16x16x32_bf16 v[156:159], a[208:211], a[184:187], v[156:159]
    v_exp_f32 v144, v144
    v_mfma_f32_16x16x32_bf16 v[132:135], a[212:215], a[132:135], v[132:135]
    ds_read_b64_tr_b16 a[204:205], v240 offset:72
    v_fma_f32 v130, v130, s20, v248
    v_mfma_f32_16x16x32_bf16 v[140:143], a[212:215], a[140:143], v[140:143]
    ds_read_b64_tr_b16 a[206:207], v240 offset:584
    v_fma_f32 v131, v131, s20, v248
    v_mfma_f32_16x16x32_bf16 v[148:151], a[212:215], a[180:183], v[148:151]
    s_waitcnt vmcnt(19)
    s_barrier
    v_mfma_f32_16x16x32_bf16 v[156:159], a[212:215], a[188:191], v[156:159]
    v_fma_f32 v138, v138, s20, v249
    s_waitcnt lgkmcnt(4)
    v_mfma_f32_16x16x32_bf16 a[0:3], a[192:195], v[96:99], a[0:3]
    ds_read_b64_tr_b16 a[208:209], v240 offset:1024
    v_fma_f32 v139, v139, s20, v249
    v_mfma_f32_16x16x32_bf16 a[8:11], a[192:195], v[104:107], a[8:11]
    ds_read_b64_tr_b16 a[210:211], v240 offset:1536
    s_add_u32 m0, s29, 0
    v_mfma_f32_16x16x32_bf16 a[48:51], a[192:195], v[112:115], a[48:51]
    buffer_load_dwordx4 v242, s[48:51], s26 offen nt lds
    v_mfma_f32_16x16x32_bf16 a[56:59], a[192:195], v[120:123], a[56:59]
    v_exp_f32 v145, v145
    v_mfma_f32_16x16x32_bf16 a[4:7], a[196:199], v[96:99], a[4:7]
    ds_read_b64_tr_b16 a[212:213], v240 offset:1032
    v_cvt_pk_bf16_f32 v144, v144, v145
    v_mfma_f32_16x16x32_bf16 a[12:15], a[196:199], v[104:107], a[12:15]
    ds_read_b64_tr_b16 a[214:215], v240 offset:1544
    v_fma_f32 v146, v146, s20, v250
    v_mfma_f32_16x16x32_bf16 a[52:55], a[196:199], v[112:115], a[52:55]
    v_exp_f32 v152, v152
    v_mfma_f32_16x16x32_bf16 a[60:63], a[196:199], v[120:123], a[60:63]
    v_fma_f32 v147, v147, s20, v250
    s_waitcnt lgkmcnt(4)
    v_mfma_f32_16x16x32_bf16 a[16:19], a[200:203], v[96:99], a[16:19]
    ds_read_b64_tr_b16 a[192:193], v240 offset:1088
    v_fma_f32 v154, v154, s20, v251
    v_mfma_f32_16x16x32_bf16 a[24:27], a[200:203], v[104:107], a[24:27]
    ds_read_b64_tr_b16 a[194:195], v240 offset:1600
    v_fma_f32 v155, v155, s20, v251
    v_mfma_f32_16x16x32_bf16 a[64:67], a[200:203], v[112:115], a[64:67]
    buffer_load_dword v233, v232, s[4:7], s58 offen
    v_mfma_f32_16x16x32_bf16 a[72:75], a[200:203], v[120:123], a[72:75]
    s_add_u32 s58, s58, 4096
    v_fma_f32 v132, v132, s20, v248
    v_mfma_f32_16x16x32_bf16 a[20:23], a[204:207], v[96:99], a[20:23]
    ds_read_b64_tr_b16 a[196:197], v240 offset:1096
    v_fma_f32 v133, v133, s20, v248
    v_mfma_f32_16x16x32_bf16 a[28:31], a[204:207], v[104:107], a[28:31]
    ds_read_b64_tr_b16 a[198:199], v240 offset:1608
    v_fma_f32 v134, v134, s20, v248
    v_mfma_f32_16x16x32_bf16 a[68:71], a[204:207], v[112:115], a[68:71]
    v_exp_f32 v153, v153
    v_mfma_f32_16x16x32_bf16 a[76:79], a[204:207], v[120:123], a[76:79]
    v_cvt_pk_bf16_f32 v152, v152, v153
    s_waitcnt lgkmcnt(4)
    v_mfma_f32_16x16x32_bf16 a[32:35], a[208:211], v[96:99], a[32:35]
    ds_read_b64_tr_b16 a[200:201], v240 offset:2048
    v_fma_f32 v135, v135, s20, v248
    v_mfma_f32_16x16x32_bf16 a[40:43], a[208:211], v[104:107], a[40:43]
    ds_read_b64_tr_b16 a[202:203], v240 offset:2560
    s_add_u32 m0, s29, 896
    v_mfma_f32_16x16x32_bf16 a[80:83], a[208:211], v[112:115], a[80:83]
    buffer_load_dwordx4 v242, s[48:51], s26 offen offset:128 nt lds
    v_mfma_f32_16x16x32_bf16 a[88:91], a[208:211], v[120:123], a[88:91]
    v_exp_f32 v130, v130
    v_mfma_f32_16x16x32_bf16 a[36:39], a[212:215], v[96:99], a[36:39]
    ds_read_b64_tr_b16 a[204:205], v240 offset:2056
    v_fma_f32 v140, v140, s20, v249
    v_mfma_f32_16x16x32_bf16 a[44:47], a[212:215], v[104:107], a[44:47]
    ds_read_b64_tr_b16 a[206:207], v240 offset:2568
    v_fma_f32 v141, v141, s20, v249
    v_mfma_f32_16x16x32_bf16 a[84:87], a[212:215], v[112:115], a[84:87]
    v_exp_f32 v131, v131
    v_mfma_f32_16x16x32_bf16 a[92:95], a[212:215], v[120:123], a[92:95]
    v_cvt_pk_bf16_f32 v129, v130, v131
    s_waitcnt lgkmcnt(4)
    v_mfma_f32_16x16x32_bf16 v[0:3], a[192:195], v[96:99], v[0:3]
    ds_read_b64_tr_b16 a[208:209], v240 offset:2112
    v_fma_f32 v142, v142, s20, v249
    v_mfma_f32_16x16x32_bf16 v[8:11], a[192:195], v[104:107], v[8:11]
    ds_read_b64_tr_b16 a[210:211], v240 offset:2624
    v_fma_f32 v143, v143, s20, v249
    v_mfma_f32_16x16x32_bf16 v[48:51], a[192:195], v[112:115], v[48:51]
    buffer_store_dwordx4 v[216:219], v243, s[16:19], s46 offen offset:512 nt
    v_mfma_f32_16x16x32_bf16 v[56:59], a[192:195], v[120:123], v[56:59]
    v_exp_f32 v138, v138
    v_mfma_f32_16x16x32_bf16 v[4:7], a[196:199], v[96:99], v[4:7]
    ds_read_b64_tr_b16 a[212:213], v240 offset:2120
    v_fma_f32 v148, v148, s20, v250
    v_mfma_f32_16x16x32_bf16 v[12:15], a[196:199], v[104:107], v[12:15]
    ds_read_b64_tr_b16 a[214:215], v240 offset:2632
    v_fma_f32 v149, v149, s20, v250
    v_mfma_f32_16x16x32_bf16 v[52:55], a[196:199], v[112:115], v[52:55]
    v_exp_f32 v139, v139
    v_mfma_f32_16x16x32_bf16 v[60:63], a[196:199], v[120:123], v[60:63]
    v_cvt_pk_bf16_f32 v137, v138, v139
    s_waitcnt lgkmcnt(4)
    v_mfma_f32_16x16x32_bf16 v[16:19], a[200:203], v[96:99], v[16:19]
    ds_read_b128 a[192:195], v236 offset:24576
    v_fma_f32 v150, v150, s20, v250
    v_mfma_f32_16x16x32_bf16 v[24:27], a[200:203], v[104:107], v[24:27]
    s_add_u32 m0, s29, 1792
    v_fma_f32 v151, v151, s20, v250
    v_mfma_f32_16x16x32_bf16 v[64:67], a[200:203], v[112:115], v[64:67]
    buffer_load_dwordx4 v242, s[48:51], s26 offen offset:256 nt lds
    v_mfma_f32_16x16x32_bf16 v[72:75], a[200:203], v[120:123], v[72:75]
    v_exp_f32 v146, v146
    v_mfma_f32_16x16x32_bf16 v[20:23], a[204:207], v[96:99], v[20:23]
    ds_read_b128 a[196:199], v237 offset:24576
    v_fma_f32 v156, v156, s20, v251
    v_mfma_f32_16x16x32_bf16 v[28:31], a[204:207], v[104:107], v[28:31]
    v_exp_f32 v147, v147
    v_mfma_f32_16x16x32_bf16 v[68:71], a[204:207], v[112:115], v[68:71]
    v_exp_f32 v154, v154
    v_mfma_f32_16x16x32_bf16 v[76:79], a[204:207], v[120:123], v[76:79]
    v_cvt_pk_bf16_f32 v145, v146, v147
    s_waitcnt lgkmcnt(2)
    v_mfma_f32_16x16x32_bf16 v[32:35], a[208:211], v[96:99], v[32:35]
    ds_read_b128 a[200:203], v236 offset:25600
    v_fma_f32 v157, v157, s20, v251
    v_mfma_f32_16x16x32_bf16 v[40:43], a[208:211], v[104:107], v[40:43]
    v_exp_f32 v155, v155
    v_mfma_f32_16x16x32_bf16 v[80:83], a[208:211], v[112:115], v[80:83]
    v_exp_f32 v132, v132
    v_mfma_f32_16x16x32_bf16 v[88:91], a[208:211], v[120:123], v[88:91]
    s_add_u32 s26, s25, 12288
    v_cvt_pk_bf16_f32 v153, v154, v155
    v_mfma_f32_16x16x32_bf16 v[36:39], a[212:215], v[96:99], v[36:39]
    ds_read_b128 a[204:207], v237 offset:25600
    v_fma_f32 v158, v158, s20, v251
    v_mfma_f32_16x16x32_bf16 v[44:47], a[212:215], v[104:107], v[44:47]
    v_exp_f32 v133, v133
    v_mfma_f32_16x16x32_bf16 v[84:87], a[212:215], v[112:115], v[84:87]
    v_exp_f32 v134, v134
    v_mfma_f32_16x16x32_bf16 v[92:95], a[212:215], v[120:123], v[92:95]
    v_cvt_pk_bf16_f32 v130, v132, v133
    s_waitcnt lgkmcnt(2)
    v_mfma_f32_16x16x32_bf16 v[96:99], a[192:195], a[96:99], 0
    ds_read_b128 a[208:211], v236 offset:26624
    v_fma_f32 v159, v159, s20, v251
    v_mfma_f32_16x16x32_bf16 v[104:107], a[192:195], a[104:107], 0
    s_add_u32 m0, s27, 12288
    v_mfma_f32_16x16x32_bf16 v[112:115], a[192:195], a[144:147], 0
    buffer_load_dwordx4 v241, s[8:11], s25 offen nt lds
    v_mfma_f32_16x16x32_bf16 v[120:123], a[192:195], a[152:155], 0
    v_exp_f32 v135, v135
    v_mfma_f32_16x16x32_bf16 v[96:99], a[196:199], a[100:103], v[96:99]
    ds_read_b128 a[212:215], v237 offset:26624
    v_cvt_pk_bf16_f32 v131, v134, v135
    v_mfma_f32_16x16x32_bf16 v[104:107], a[196:199], a[108:111], v[104:107]
    v_exp_f32 v140, v140
    v_mfma_f32_16x16x32_bf16 a[232:235], a[224:227], v[128:131], a[232:235]
    v_exp_f32 v141, v141
    v_mfma_f32_16x16x32_bf16 v[112:115], a[196:199], a[148:151], v[112:115]
    v_exp_f32 v142, v142
    v_mfma_f32_16x16x32_bf16 v[120:123], a[196:199], a[156:159], v[120:123]
    v_cvt_pk_bf16_f32 v138, v140, v141
    s_waitcnt lgkmcnt(2)
    v_mfma_f32_16x16x32_bf16 v[96:99], a[200:203], a[112:115], v[96:99]
    ds_read_b128 a[192:195], v236 offset:30720
    v_mfma_f32_16x16x32_bf16 v[104:107], a[200:203], a[120:123], v[104:107]
    s_add_u32 m0, s38, -256
    v_mfma_f32_16x16x32_bf16 v[112:115], a[200:203], a[160:163], v[112:115]
    buffer_load_dwordx4 v244, s[4:7], s40 offen offset:256 nt lds
    v_mfma_f32_16x16x32_bf16 v[120:123], a[200:203], a[168:171], v[120:123]
    v_exp_f32 v143, v143
    v_mfma_f32_16x16x32_bf16 v[96:99], a[204:207], a[116:119], v[96:99]
    ds_read_b128 a[196:199], v237 offset:30720
    v_cvt_pk_bf16_f32 v139, v142, v143
    v_mfma_f32_16x16x32_bf16 v[104:107], a[204:207], a[124:127], v[104:107]
    v_exp_f32 v148, v148
    v_mfma_f32_16x16x32_bf16 a[232:235], a[228:231], v[136:139], a[232:235]
    v_exp_f32 v149, v149
    v_mfma_f32_16x16x32_bf16 v[112:115], a[204:207], a[164:167], v[112:115]
    v_exp_f32 v150, v150
    v_mfma_f32_16x16x32_bf16 v[120:123], a[204:207], a[172:175], v[120:123]
    v_cvt_pk_bf16_f32 v146, v148, v149
    s_waitcnt lgkmcnt(2)
    v_mfma_f32_16x16x32_bf16 v[96:99], a[208:211], a[128:131], v[96:99]
    ds_read_b128 a[200:203], v236 offset:31744
    v_mfma_f32_16x16x32_bf16 v[104:107], a[208:211], a[136:139], v[104:107]
    s_add_u32 m0, s27, 13184
    v_mfma_f32_16x16x32_bf16 v[112:115], a[208:211], a[176:179], v[112:115]
    buffer_load_dwordx4 v241, s[8:11], s25 offen offset:128 nt lds
    v_mfma_f32_16x16x32_bf16 v[120:123], a[208:211], a[184:187], v[120:123]
    v_exp_f32 v151, v151
    v_mfma_f32_16x16x32_bf16 v[96:99], a[212:215], a[132:135], v[96:99]
    ds_read_b128 a[204:207], v237 offset:31744
    v_cvt_pk_bf16_f32 v147, v150, v151
    v_mfma_f32_16x16x32_bf16 v[104:107], a[212:215], a[140:143], v[104:107]
    s_cmp_eq_u32 s28, s30
    s_cselect_b32 s35, -49664, s37
    v_mfma_f32_16x16x32_bf16 a[236:239], a[224:227], v[144:147], a[236:239]
    v_exp_f32 v156, v156
    v_mfma_f32_16x16x32_bf16 v[112:115], a[212:215], a[180:183], v[112:115]
    v_exp_f32 v157, v157
    v_mfma_f32_16x16x32_bf16 v[120:123], a[212:215], a[188:191], v[120:123]
    s_add_u32 s29, s28, s35
    s_waitcnt lgkmcnt(2)
    v_mfma_f32_16x16x32_bf16 v[100:103], a[192:195], a[96:99], 0
    ds_read_b128 a[208:211], v236 offset:32768
    v_add_u32 v240, s35, v240
    v_mfma_f32_16x16x32_bf16 v[108:111], a[192:195], a[104:107], 0
    v_exp_f32 v158, v158
    v_mfma_f32_16x16x32_bf16 v[116:119], a[192:195], a[144:147], 0
    v_exp_f32 v159, v159
    v_mfma_f32_16x16x32_bf16 v[124:127], a[192:195], a[152:155], 0
    v_cvt_pk_bf16_f32 v154, v156, v157
    v_cvt_pk_bf16_f32 v155, v158, v159
    v_mfma_f32_16x16x32_bf16 v[100:103], a[196:199], a[100:103], v[100:103]
    ds_read_b128 a[212:215], v237 offset:32768
    v_fma_f32 v96, v96, s20, v248
    v_mfma_f32_16x16x32_bf16 v[108:111], a[196:199], a[108:111], v[108:111]
    v_exp_f32 v96, v96
    v_mfma_f32_16x16x32_bf16 v[116:119], a[196:199], a[148:151], v[116:119]
    v_fma_f32 v97, v97, s20, v248
    v_fma_f32 v104, v104, s20, v249
    v_mfma_f32_16x16x32_bf16 v[124:127], a[196:199], a[156:159], v[124:127]
    v_fma_f32 v105, v105, s20, v249
    s_waitcnt lgkmcnt(2)
    v_mfma_f32_16x16x32_bf16 v[100:103], a[200:203], a[112:115], v[100:103]
    ds_read_b64_tr_b16 a[192:193], v240
    v_fma_f32 v112, v112, s20, v250
    v_mfma_f32_16x16x32_bf16 v[108:111], a[200:203], a[120:123], v[108:111]
    ds_read_b64_tr_b16 a[194:195], v240 offset:512
    s_add_u32 m0, s27, 14080
    v_mfma_f32_16x16x32_bf16 a[236:239], a[228:231], v[152:155], a[236:239]
    v_exp_f32 v97, v97
    v_mfma_f32_16x16x32_bf16 v[116:119], a[200:203], a[160:163], v[116:119]
    buffer_load_dwordx4 v241, s[8:11], s25 offen offset:256 nt lds
    v_mfma_f32_16x16x32_bf16 v[124:127], a[200:203], a[168:171], v[124:127]
    v_exp_f32 v104, v104
    v_mfma_f32_16x16x32_bf16 v[100:103], a[204:207], a[116:119], v[100:103]
    ds_read_b64_tr_b16 a[196:197], v240 offset:8
    v_fma_f32 v113, v113, s20, v250
    v_mfma_f32_16x16x32_bf16 v[108:111], a[204:207], a[124:127], v[108:111]
    ds_read_b64_tr_b16 a[198:199], v240 offset:520
    v_cvt_pk_bf16_f32 v96, v96, v97
    v_mfma_f32_16x16x32_bf16 v[116:119], a[204:207], a[164:167], v[116:119]
    v_exp_f32 v105, v105
    v_mfma_f32_16x16x32_bf16 v[124:127], a[204:207], a[172:175], v[124:127]
    v_fma_f32 v120, v120, s20, v251
    s_waitcnt lgkmcnt(4)
    v_mfma_f32_16x16x32_bf16 v[100:103], a[208:211], a[128:131], v[100:103]
    ds_read_b64_tr_b16 a[200:201], v240 offset:64
    v_cvt_pk_bf16_f32 v104, v104, v105
    v_mfma_f32_16x16x32_bf16 v[108:111], a[208:211], a[136:139], v[108:111]
    ds_read_b64_tr_b16 a[202:203], v240 offset:576
    s_add_u32 m0, s38, 3840
    v_mfma_f32_16x16x32_bf16 v[116:119], a[208:211], a[176:179], v[116:119]
    buffer_load_dwordx4 v244, s[4:7], s42 offen offset:256 nt lds
    v_mfma_f32_16x16x32_bf16 v[124:127], a[208:211], a[184:187], v[124:127]
    v_exp_f32 v112, v112
    v_mfma_f32_16x16x32_bf16 v[100:103], a[212:215], a[132:135], v[100:103]
    ds_read_b64_tr_b16 a[204:205], v240 offset:72
    v_fma_f32 v121, v121, s20, v251
    v_mfma_f32_16x16x32_bf16 v[108:111], a[212:215], a[140:143], v[108:111]
    ds_read_b64_tr_b16 a[206:207], v240 offset:584
    v_fma_f32 v98, v98, s20, v248
    v_mfma_f32_16x16x32_bf16 v[116:119], a[212:215], a[180:183], v[116:119]
    s_waitcnt vmcnt(20)
    s_barrier
    v_mfma_f32_16x16x32_bf16 v[124:127], a[212:215], a[188:191], v[124:127]
    v_fma_f32 v99, v99, s20, v248
    s_waitcnt lgkmcnt(4)
    v_mfma_f32_16x16x32_bf16 a[0:3], a[192:195], v[128:131], a[0:3]
    ds_read_b64_tr_b16 a[208:209], v240 offset:1024
    v_fma_f32 v106, v106, s20, v249
    v_mfma_f32_16x16x32_bf16 a[8:11], a[192:195], v[136:139], a[8:11]
    ds_read_b64_tr_b16 a[210:211], v240 offset:1536
    s_add_u32 m0, s28, 0
    v_mfma_f32_16x16x32_bf16 a[48:51], a[192:195], v[144:147], a[48:51]
    buffer_load_dwordx4 v242, s[48:51], s25 offen nt lds
    v_mfma_f32_16x16x32_bf16 a[56:59], a[192:195], v[152:155], a[56:59]
    v_exp_f32 v113, v113
    v_mfma_f32_16x16x32_bf16 a[4:7], a[196:199], v[128:131], a[4:7]
    ds_read_b64_tr_b16 a[212:213], v240 offset:1032
    v_cvt_pk_bf16_f32 v112, v112, v113
    v_mfma_f32_16x16x32_bf16 a[12:15], a[196:199], v[136:139], a[12:15]
    ds_read_b64_tr_b16 a[214:215], v240 offset:1544
    v_fma_f32 v107, v107, s20, v249
    v_mfma_f32_16x16x32_bf16 a[52:55], a[196:199], v[144:147], a[52:55]
    v_exp_f32 v120, v120
    v_mfma_f32_16x16x32_bf16 a[60:63], a[196:199], v[152:155], a[60:63]
    v_fma_f32 v114, v114, s20, v250
    s_waitcnt lgkmcnt(4)
    v_mfma_f32_16x16x32_bf16 a[16:19], a[200:203], v[128:131], a[16:19]
    ds_read_b64_tr_b16 a[192:193], v240 offset:1088
    v_fma_f32 v115, v115, s20, v250
    v_mfma_f32_16x16x32_bf16 a[24:27], a[200:203], v[136:139], a[24:27]
    ds_read_b64_tr_b16 a[194:195], v240 offset:1600
    v_fma_f32 v122, v122, s20, v251
    v_mfma_f32_16x16x32_bf16 a[64:67], a[200:203], v[144:147], a[64:67]
    v_exp_f32 v121, v121
    v_mfma_f32_16x16x32_bf16 a[72:75], a[200:203], v[152:155], a[72:75]
    v_exp_f32 v98, v98
    v_mfma_f32_16x16x32_bf16 a[20:23], a[204:207], v[128:131], a[20:23]
    ds_read_b64_tr_b16 a[196:197], v240 offset:1096
    v_cvt_pk_bf16_f32 v120, v120, v121
    v_mfma_f32_16x16x32_bf16 a[28:31], a[204:207], v[136:139], a[28:31]
    ds_read_b64_tr_b16 a[198:199], v240 offset:1608
    v_fma_f32 v123, v123, s20, v251
    v_mfma_f32_16x16x32_bf16 a[68:71], a[204:207], v[144:147], a[68:71]
    v_exp_f32 v99, v99
    v_mfma_f32_16x16x32_bf16 a[76:79], a[204:207], v[152:155], a[76:79]
    v_cvt_pk_bf16_f32 v97, v98, v99
    s_waitcnt lgkmcnt(4)
    v_mfma_f32_16x16x32_bf16 a[32:35], a[208:211], v[128:131], a[32:35]
    ds_read_b64_tr_b16 a[200:201], v240 offset:2048
    v_fma_f32 v100, v100, s20, v248
    v_mfma_f32_16x16x32_bf16 a[40:43], a[208:211], v[136:139], a[40:43]
    ds_read_b64_tr_b16 a[202:203], v240 offset:2560
    s_add_u32 m0, s28, 896
    v_mfma_f32_16x16x32_bf16 a[80:83], a[208:211], v[144:147], a[80:83]
    buffer_load_dwordx4 v242, s[48:51], s25 offen offset:128 nt lds
    v_mfma_f32_16x16x32_bf16 a[88:91], a[208:211], v[152:155], a[88:91]
    v_exp_f32 v106, v106
    v_mfma_f32_16x16x32_bf16 a[36:39], a[212:215], v[128:131], a[36:39]
    ds_read_b64_tr_b16 a[204:205], v240 offset:2056
    v_fma_f32 v101, v101, s20, v248
    v_mfma_f32_16x16x32_bf16 a[44:47], a[212:215], v[136:139], a[44:47]
    ds_read_b64_tr_b16 a[206:207], v240 offset:2568
    v_fma_f32 v102, v102, s20, v248
    v_mfma_f32_16x16x32_bf16 a[84:87], a[212:215], v[144:147], a[84:87]
    v_exp_f32 v107, v107
    v_mfma_f32_16x16x32_bf16 a[92:95], a[212:215], v[152:155], a[92:95]
    v_cvt_pk_bf16_f32 v105, v106, v107
    s_waitcnt lgkmcnt(4)
    v_mfma_f32_16x16x32_bf16 v[0:3], a[192:195], v[128:131], v[0:3]
    ds_read_b64_tr_b16 a[208:209], v240 offset:2112
    v_fma_f32 v103, v103, s20, v248
    v_mfma_f32_16x16x32_bf16 v[8:11], a[192:195], v[136:139], v[8:11]
    ds_read_b64_tr_b16 a[210:211], v240 offset:2624
    v_fma_f32 v108, v108, s20, v249
    v_mfma_f32_16x16x32_bf16 v[48:51], a[192:195], v[144:147], v[48:51]
    buffer_store_dwordx4 v[188:191], v243, s[16:19], s45 offen offset:512 nt
    v_mfma_f32_16x16x32_bf16 v[56:59], a[192:195], v[152:155], v[56:59]
    v_exp_f32 v114, v114
    v_mfma_f32_16x16x32_bf16 v[4:7], a[196:199], v[128:131], v[4:7]
    ds_read_b64_tr_b16 a[212:213], v240 offset:2120
    v_fma_f32 v109, v109, s20, v249
    v_mfma_f32_16x16x32_bf16 v[12:15], a[196:199], v[136:139], v[12:15]
    ds_read_b64_tr_b16 a[214:215], v240 offset:2632
    v_fma_f32 v110, v110, s20, v249
    v_mfma_f32_16x16x32_bf16 v[52:55], a[196:199], v[144:147], v[52:55]
    v_exp_f32 v115, v115
    v_mfma_f32_16x16x32_bf16 v[60:63], a[196:199], v[152:155], v[60:63]
    v_cvt_pk_bf16_f32 v113, v114, v115
    s_waitcnt lgkmcnt(4)
    v_mfma_f32_16x16x32_bf16 v[16:19], a[200:203], v[128:131], v[16:19]
    ds_read_b128 a[192:195], v236 offset:36864
    v_fma_f32 v111, v111, s20, v249
    v_mfma_f32_16x16x32_bf16 v[24:27], a[200:203], v[136:139], v[24:27]
    s_add_u32 m0, s28, 1792
    v_fma_f32 v116, v116, s20, v250
    v_mfma_f32_16x16x32_bf16 v[64:67], a[200:203], v[144:147], v[64:67]
    buffer_load_dwordx4 v242, s[48:51], s25 offen offset:256 nt lds
    v_mfma_f32_16x16x32_bf16 v[72:75], a[200:203], v[152:155], v[72:75]
    v_exp_f32 v122, v122
    v_mfma_f32_16x16x32_bf16 v[20:23], a[204:207], v[128:131], v[20:23]
    ds_read_b128 a[196:199], v237 offset:36864
    v_fma_f32 v117, v117, s20, v250
    v_mfma_f32_16x16x32_bf16 v[28:31], a[204:207], v[136:139], v[28:31]
    v_exp_f32 v123, v123
    v_mfma_f32_16x16x32_bf16 v[68:71], a[204:207], v[144:147], v[68:71]
    v_exp_f32 v100, v100
    v_mfma_f32_16x16x32_bf16 v[76:79], a[204:207], v[152:155], v[76:79]
    v_cvt_pk_bf16_f32 v121, v122, v123
    s_waitcnt lgkmcnt(2)
    v_mfma_f32_16x16x32_bf16 v[32:35], a[208:211], v[128:131], v[32:35]
    ds_read_b128 a[200:203], v236 offset:37888
    v_fma_f32 v118, v118, s20, v250
    v_mfma_f32_16x16x32_bf16 v[40:43], a[208:211], v[136:139], v[40:43]
    v_exp_f32 v101, v101
    v_mfma_f32_16x16x32_bf16 v[80:83], a[208:211], v[144:147], v[80:83]
    s_waitcnt vmcnt(20)
    ds_read_b128 v[184:187], v238 offset:2048
    v_cvt_pk_bf16_f32 v98, v100, v101
    v_mfma_f32_16x16x32_bf16 v[88:91], a[208:211], v[152:155], v[88:91]
    s_add_u32 s25, s26, 12288
    ds_read_b128 v[188:191], v239 offset:2048
    v_mfma_f32_16x16x32_bf16 v[36:39], a[212:215], v[128:131], v[36:39]
    ds_read_b128 a[204:207], v237 offset:37888
    v_fma_f32 v119, v119, s20, v250
    v_mfma_f32_16x16x32_bf16 v[44:47], a[212:215], v[136:139], v[44:47]
    v_exp_f32 v102, v102
    v_mfma_f32_16x16x32_bf16 v[84:87], a[212:215], v[144:147], v[84:87]
    v_exp_f32 v103, v103
    v_mfma_f32_16x16x32_bf16 v[92:95], a[212:215], v[152:155], v[92:95]
    v_cvt_pk_bf16_f32 v99, v102, v103
    s_waitcnt lgkmcnt(4)
    v_mfma_f32_16x16x32_bf16 v[128:131], a[192:195], a[96:99], 0
    ds_read_b128 a[208:211], v236 offset:38912
    v_fma_f32 v124, v124, s20, v251
    v_mfma_f32_16x16x32_bf16 a[232:235], a[224:227], v[96:99], a[232:235]
    v_exp_f32 v108, v108
    v_mfma_f32_16x16x32_bf16 v[136:139], a[192:195], a[104:107], 0
    s_add_u32 m0, s27, 24576
    v_fma_f32 v125, v125, s20, v251
    v_mfma_f32_16x16x32_bf16 v[144:147], a[192:195], a[144:147], 0
    buffer_load_dwordx4 v241, s[8:11], s26 offen nt lds
    v_mfma_f32_16x16x32_bf16 v[152:155], a[192:195], a[152:155], 0
    v_exp_f32 v109, v109
    v_mfma_f32_16x16x32_bf16 v[128:131], a[196:199], a[100:103], v[128:131]
    ds_read_b128 a[212:215], v237 offset:38912
    v_cvt_pk_bf16_f32 v106, v108, v109
    v_mfma_f32_16x16x32_bf16 v[136:139], a[196:199], a[108:111], v[136:139]
    v_exp_f32 v110, v110
    v_mfma_f32_16x16x32_bf16 v[144:147], a[196:199], a[148:151], v[144:147]
    v_exp_f32 v111, v111
    v_mfma_f32_16x16x32_bf16 v[152:155], a[196:199], a[156:159], v[152:155]
    v_cvt_pk_bf16_f32 v107, v110, v111
    s_waitcnt lgkmcnt(2)
    v_mfma_f32_16x16x32_bf16 v[128:131], a[200:203], a[112:115], v[128:131]
    ds_read_b128 a[192:195], v236 offset:43008
    v_fma_f32 v126, v126, s20, v251
    v_mfma_f32_16x16x32_bf16 a[232:235], a[228:231], v[104:107], a[232:235]
    v_exp_f32 v116, v116
    v_mfma_f32_16x16x32_bf16 v[136:139], a[200:203], a[120:123], v[136:139]
    v_exp_f32 v117, v117
    v_mfma_f32_16x16x32_bf16 v[144:147], a[200:203], a[160:163], v[144:147]
    buffer_store_dwordx4 v[220:223], v243, s[16:19], s47 offen offset:512 nt
    v_mfma_f32_16x16x32_bf16 v[152:155], a[200:203], a[168:171], v[152:155]
    v_exp_f32 v118, v118
    v_mfma_f32_16x16x32_bf16 v[128:131], a[204:207], a[116:119], v[128:131]
    ds_read_b128 a[196:199], v237 offset:43008
    v_cvt_pk_bf16_f32 v114, v116, v117
    v_mfma_f32_16x16x32_bf16 v[136:139], a[204:207], a[124:127], v[136:139]
    v_exp_f32 v119, v119
    v_mfma_f32_16x16x32_bf16 v[144:147], a[204:207], a[164:167], v[144:147]
    v_exp_f32 v124, v124
    v_mfma_f32_16x16x32_bf16 v[152:155], a[204:207], a[172:175], v[152:155]
    v_fma_f32 v127, v127, s20, v251
    s_waitcnt lgkmcnt(2)
    v_mfma_f32_16x16x32_bf16 v[128:131], a[208:211], a[128:131], v[128:131]
    ds_read_b128 a[200:203], v236 offset:44032
    v_cvt_pk_bf16_f32 v115, v118, v119
    v_mfma_f32_16x16x32_bf16 v[136:139], a[208:211], a[136:139], v[136:139]
    s_add_u32 m0, s27, 25472
    v_mfma_f32_16x16x32_bf16 v[144:147], a[208:211], a[176:179], v[144:147]
    buffer_load_dwordx4 v241, s[8:11], s26 offen offset:128 nt lds
    v_mfma_f32_16x16x32_bf16 a[236:239], a[224:227], v[112:115], a[236:239]
    v_exp_f32 v125, v125
    v_mfma_f32_16x16x32_bf16 v[152:155], a[208:211], a[184:187], v[152:155]
    v_exp_f32 v126, v126
    v_mfma_f32_16x16x32_bf16 v[128:131], a[212:215], a[132:135], v[128:131]
    ds_read_b128 a[204:207], v237 offset:44032
    v_cvt_pk_bf16_f32 v122, v124, v125
    v_mfma_f32_16x16x32_bf16 v[136:139], a[212:215], a[140:143], v[136:139]
    s_cmp_eq_u32 s29, s30
    s_cselect_b32 s35, -49664, s37
    v_mfma_f32_16x16x32_bf16 v[144:147], a[212:215], a[180:183], v[144:147]
    v_exp_f32 v127, v127
    v_mfma_f32_16x16x32_bf16 v[152:155], a[212:215], a[188:191], v[152:155]
    s_add_u32 s28, s29, s35
    s_waitcnt lgkmcnt(2)
    v_mfma_f32_16x16x32_bf16 v[132:135], a[192:195], a[96:99], 0
    ds_read_b128 a[208:211], v236 offset:45056
    v_add_u32 v240, s35, v240
    v_mfma_f32_16x16x32_bf16 v[140:143], a[192:195], a[104:107], 0
    v_cvt_pk_bf16_f32 v123, v126, v127
    v_mfma_f32_16x16x32_bf16 v[148:151], a[192:195], a[144:147], 0
    s_waitcnt vmcnt(20)
    ds_read_b128 v[216:219], v238 offset:6144
    v_mfma_f32_16x16x32_bf16 v[156:159], a[192:195], a[152:155], 0
    ds_read_b128 v[220:223], v239 offset:6144
    v_fma_f32 v128, v128, s20, v248
    v_mfma_f32_16x16x32_bf16 v[132:135], a[196:199], a[100:103], v[132:135]
    ds_read_b128 a[212:215], v237 offset:45056
    v_fma_f32 v129, v129, s20, v248
    v_mfma_f32_16x16x32_bf16 v[140:143], a[196:199], a[108:111], v[140:143]
    v_exp_f32 v128, v128
    v_mfma_f32_16x16x32_bf16 v[148:151], a[196:199], a[148:151], v[148:151]
    v_exp_f32 v129, v129
    v_mfma_f32_16x16x32_bf16 v[156:159], a[196:199], a[156:159], v[156:159]
    v_fma_f32 v136, v136, s20, v249
    s_waitcnt lgkmcnt(4)
    v_mfma_f32_16x16x32_bf16 v[132:135], a[200:203], a[112:115], v[132:135]
    ds_read_b64_tr_b16 a[192:193], v240
    v_fma_f32 v137, v137, s20, v249
    v_mfma_f32_16x16x32_bf16 v[140:143], a[200:203], a[120:123], v[140:143]
    ds_read_b64_tr_b16 a[194:195], v240 offset:512
    s_add_u32 m0, s27, 26368
    v_mfma_f32_16x16x32_bf16 a[236:239], a[228:231], v[120:123], a[236:239]
    v_exp_f32 v136, v136
    v_mfma_f32_16x16x32_bf16 v[148:151], a[200:203], a[160:163], v[148:151]
    buffer_load_dwordx4 v241, s[8:11], s26 offen offset:256 nt lds
    v_mfma_f32_16x16x32_bf16 v[156:159], a[200:203], a[168:171], v[156:159]
    v_exp_f32 v137, v137
    v_mfma_f32_16x16x32_bf16 v[132:135], a[204:207], a[116:119], v[132:135]
    ds_read_b64_tr_b16 a[196:197], v240 offset:8
    v_fma_f32 v144, v144, s20, v250
    v_mfma_f32_16x16x32_bf16 v[140:143], a[204:207], a[124:127], v[140:143]
    ds_read_b64_tr_b16 a[198:199], v240 offset:520
    v_fma_f32 v145, v145, s20, v250
    v_mfma_f32_16x16x32_bf16 v[148:151], a[204:207], a[164:167], v[148:151]
    v_exp_f32 v144, v144
    v_mfma_f32_16x16x32_bf16 v[156:159], a[204:207], a[172:175], v[156:159]
    v_fma_f32 v152, v152, s20, v251
    s_waitcnt lgkmcnt(4)
    v_mfma_f32_16x16x32_bf16 v[132:135], a[208:211], a[128:131], v[132:135]
    ds_read_b64_tr_b16 a[200:201], v240 offset:64
    v_fma_f32 v153, v153, s20, v251
    v_mfma_f32_16x16x32_bf16 v[140:143], a[208:211], a[136:139], v[140:143]
    ds_read_b64_tr_b16 a[202:203], v240 offset:576
    s_add_u32 m0, s38, -2304
    v_mfma_f32_16x16x32_bf16 v[148:151], a[208:211], a[176:179], v[148:151]
    buffer_load_dwordx4 v245, s[4:7], s40 offen offset:3328 nt lds
    v_mfma_f32_16x16x32_bf16 v[156:159], a[208:211], a[184:187], v[156:159]
    v_exp_f32 v145, v145
    v_mfma_f32_16x16x32_bf16 v[132:135], a[212:215], a[132:135], v[132:135]
    ds_read_b64_tr_b16 a[204:205], v240 offset:72
    v_fma_f32 v130, v130, s20, v248
    v_mfma_f32_16x16x32_bf16 v[140:143], a[212:215], a[140:143], v[140:143]
    ds_read_b64_tr_b16 a[206:207], v240 offset:584
    v_cvt_pk_bf16_f32 v128, v128, v129
    v_mfma_f32_16x16x32_bf16 v[148:151], a[212:215], a[180:183], v[148:151]
    s_waitcnt vmcnt(20)
    s_barrier
    v_mfma_f32_16x16x32_bf16 v[156:159], a[212:215], a[188:191], v[156:159]
    v_cvt_pk_bf16_f32 v136, v136, v137
    s_waitcnt lgkmcnt(4)
    v_mfma_f32_16x16x32_bf16 a[0:3], a[192:195], v[96:99], a[0:3]
    ds_read_b64_tr_b16 a[208:209], v240 offset:1024
    v_cvt_pk_bf16_f32 v144, v144, v145
    v_mfma_f32_16x16x32_bf16 a[8:11], a[192:195], v[104:107], a[8:11]
    ds_read_b64_tr_b16 a[210:211], v240 offset:1536
    s_add_u32 m0, s29, 0
    v_mfma_f32_16x16x32_bf16 a[48:51], a[192:195], v[112:115], a[48:51]
    buffer_load_dwordx4 v242, s[48:51], s26 offen nt lds
    v_mfma_f32_16x16x32_bf16 a[56:59], a[192:195], v[120:123], a[56:59]
    v_exp_f32 v152, v152
    v_mfma_f32_16x16x32_bf16 a[4:7], a[196:199], v[96:99], a[4:7]
    ds_read_b64_tr_b16 a[212:213], v240 offset:1032
    v_fma_f32 v131, v131, s20, v248
    v_mfma_f32_16x16x32_bf16 a[12:15], a[196:199], v[104:107], a[12:15]
    ds_read_b64_tr_b16 a[214:215], v240 offset:1544
    v_fma_f32 v138, v138, s20, v249
    v_mfma_f32_16x16x32_bf16 a[52:55], a[196:199], v[112:115], a[52:55]
    v_exp_f32 v153, v153
    v_mfma_f32_16x16x32_bf16 a[60:63], a[196:199], v[120:123], a[60:63]
    v_cvt_pk_bf16_f32 v152, v152, v153
    s_waitcnt lgkmcnt(4)
    v_mfma_f32_16x16x32_bf16 a[16:19], a[200:203], v[96:99], a[16:19]
    ds_read_b64_tr_b16 a[192:193], v240 offset:1088
    v_fma_f32 v139, v139, s20, v249
    v_mfma_f32_16x16x32_bf16 a[24:27], a[200:203], v[104:107], a[24:27]
    ds_read_b64_tr_b16 a[194:195], v240 offset:1600
    v_fma_f32 v146, v146, s20, v250
    v_mfma_f32_16x16x32_bf16 a[64:67], a[200:203], v[112:115], a[64:67]
    v_exp_f32 v130, v130
    v_mfma_f32_16x16x32_bf16 a[72:75], a[200:203], v[120:123], a[72:75]
    v_exp_f32 v131, v131
    v_mfma_f32_16x16x32_bf16 a[20:23], a[204:207], v[96:99], a[20:23]
    ds_read_b64_tr_b16 a[196:197], v240 offset:1096
    v_cvt_pk_bf16_f32 v129, v130, v131
    v_mfma_f32_16x16x32_bf16 a[28:31], a[204:207], v[104:107], a[28:31]
    ds_read_b64_tr_b16 a[198:199], v240 offset:1608
    v_fma_f32 v147, v147, s20, v250
    v_mfma_f32_16x16x32_bf16 a[68:71], a[204:207], v[112:115], a[68:71]
    v_exp_f32 v138, v138
    v_mfma_f32_16x16x32_bf16 a[76:79], a[204:207], v[120:123], a[76:79]
    v_fma_f32 v154, v154, s20, v251
    s_waitcnt lgkmcnt(4)
    v_mfma_f32_16x16x32_bf16 a[32:35], a[208:211], v[96:99], a[32:35]
    ds_read_b64_tr_b16 a[200:201], v240 offset:2048
    v_fma_f32 v155, v155, s20, v251
    v_mfma_f32_16x16x32_bf16 a[40:43], a[208:211], v[104:107], a[40:43]
    ds_read_b64_tr_b16 a[202:203], v240 offset:2560
    s_add_u32 m0, s29, 896
    v_mfma_f32_16x16x32_bf16 a[80:83], a[208:211], v[112:115], a[80:83]
    buffer_load_dwordx4 v242, s[48:51], s26 offen offset:128 nt lds
    v_mfma_f32_16x16x32_bf16 a[88:91], a[208:211], v[120:123], a[88:91]
    v_exp_f32 v139, v139
    v_mfma_f32_16x16x32_bf16 a[36:39], a[212:215], v[96:99], a[36:39]
    ds_read_b64_tr_b16 a[204:205], v240 offset:2056
    v_cvt_pk_bf16_f32 v137, v138, v139
    v_mfma_f32_16x16x32_bf16 a[44:47], a[212:215], v[104:107], a[44:47]
    ds_read_b64_tr_b16 a[206:207], v240 offset:2568
    v_fma_f32 v132, v132, s20, v248
    v_mfma_f32_16x16x32_bf16 a[84:87], a[212:215], v[112:115], a[84:87]
    v_exp_f32 v146, v146
    v_mfma_f32_16x16x32_bf16 a[92:95], a[212:215], v[120:123], a[92:95]
    v_fma_f32 v133, v133, s20, v248
    s_waitcnt lgkmcnt(4)
    v_mfma_f32_16x16x32_bf16 v[0:3], a[192:195], v[96:99], v[0:3]
    ds_read_b64_tr_b16 a[208:209], v240 offset:2112
    v_fma_f32 v134, v134, s20, v248
    v_mfma_f32_16x16x32_bf16 v[8:11], a[192:195], v[104:107], v[8:11]
    ds_read_b64_tr_b16 a[210:211], v240 offset:2624
    s_add_u32 m0, s38, 1792
    v_mfma_f32_16x16x32_bf16 v[48:51], a[192:195], v[112:115], v[48:51]
    buffer_load_dwordx4 v245, s[4:7], s42 offen offset:3328 nt lds
    v_mfma_f32_16x16x32_bf16 v[56:59], a[192:195], v[120:123], v[56:59]
    v_exp_f32 v147, v147
    v_mfma_f32_16x16x32_bf16 v[4:7], a[196:199], v[96:99], v[4:7]
    ds_read_b64_tr_b16 a[212:213], v240 offset:2120
    v_cvt_pk_bf16_f32 v145, v146, v147
    v_mfma_f32_16x16x32_bf16 v[12:15], a[196:199], v[104:107], v[12:15]
    ds_read_b64_tr_b16 a[214:215], v240 offset:2632
    v_fma_f32 v135, v135, s20, v248
    v_mfma_f32_16x16x32_bf16 v[52:55], a[196:199], v[112:115], v[52:55]
    v_exp_f32 v154, v154
    v_mfma_f32_16x16x32_bf16 v[60:63], a[196:199], v[120:123], v[60:63]
    v_fma_f32 v140, v140, s20, v249
    s_waitcnt lgkmcnt(4)
    v_mfma_f32_16x16x32_bf16 v[16:19], a[200:203], v[96:99], v[16:19]
    ds_read_b128 a[192:195], v236
    v_fma_f32 v141, v141, s20, v249
    v_mfma_f32_16x16x32_bf16 v[24:27], a[200:203], v[104:107], v[24:27]
    s_add_u32 m0, s29, 1792
    v_fma_f32 v142, v142, s20, v249
    v_mfma_f32_16x16x32_bf16 v[64:67], a[200:203], v[112:115], v[64:67]
    buffer_load_dwordx4 v242, s[48:51], s26 offen offset:256 nt lds
    v_mfma_f32_16x16x32_bf16 v[72:75], a[200:203], v[120:123], v[72:75]
    v_exp_f32 v155, v155
    v_mfma_f32_16x16x32_bf16 v[20:23], a[204:207], v[96:99], v[20:23]
    ds_read_b128 a[196:199], v237
    v_cvt_pk_bf16_f32 v153, v154, v155
    v_mfma_f32_16x16x32_bf16 v[28:31], a[204:207], v[104:107], v[28:31]
    v_exp_f32 v132, v132
    v_mfma_f32_16x16x32_bf16 v[68:71], a[204:207], v[112:115], v[68:71]
    v_exp_f32 v133, v133
    v_mfma_f32_16x16x32_bf16 v[76:79], a[204:207], v[120:123], v[76:79]
    v_cvt_pk_bf16_f32 v130, v132, v133
    s_waitcnt lgkmcnt(2)
    v_mfma_f32_16x16x32_bf16 v[32:35], a[208:211], v[96:99], v[32:35]
    ds_read_b128 a[200:203], v236 offset:1024
    v_fma_f32 v143, v143, s20, v249
    v_mfma_f32_16x16x32_bf16 v[40:43], a[208:211], v[104:107], v[40:43]
    v_exp_f32 v134, v134
    v_mfma_f32_16x16x32_bf16 v[80:83], a[208:211], v[112:115], v[80:83]
    v_exp_f32 v135, v135
    v_mfma_f32_16x16x32_bf16 v[88:91], a[208:211], v[120:123], v[88:91]
    s_add_u32 s26, s25, 24981504
    v_cvt_pk_bf16_f32 v131, v134, v135
    v_mfma_f32_16x16x32_bf16 v[36:39], a[212:215], v[96:99], v[36:39]
    ds_read_b128 a[204:207], v237 offset:1024
    v_fma_f32 v148, v148, s20, v250
    v_mfma_f32_16x16x32_bf16 a[232:235], a[224:227], v[128:131], a[232:235]
    v_exp_f32 v140, v140
    v_mfma_f32_16x16x32_bf16 v[44:47], a[212:215], v[104:107], v[44:47]
    v_exp_f32 v141, v141
    v_mfma_f32_16x16x32_bf16 v[84:87], a[212:215], v[112:115], v[84:87]
    v_exp_f32 v142, v142
    v_mfma_f32_16x16x32_bf16 v[92:95], a[212:215], v[120:123], v[92:95]
    v_fma_f32 v149, v149, s20, v250
    s_waitcnt lgkmcnt(2)
    v_mfma_f32_16x16x32_bf16 v[96:99], a[192:195], a[96:99], 0
    ds_read_b128 a[208:211], v236 offset:2048
    v_cvt_pk_bf16_f32 v138, v140, v141
    v_mfma_f32_16x16x32_bf16 v[104:107], a[192:195], a[104:107], 0
    s_add_u32 m0, s27, 36864
    v_fma_f32 v150, v150, s20, v250
    v_mfma_f32_16x16x32_bf16 v[112:115], a[192:195], a[144:147], 0
    buffer_load_dwordx4 v241, s[8:11], s25 offen nt lds
    v_mfma_f32_16x16x32_bf16 v[120:123], a[192:195], a[152:155], 0
    v_exp_f32 v143, v143
    v_mfma_f32_16x16x32_bf16 v[96:99], a[196:199], a[100:103], v[96:99]
    ds_read_b128 a[212:215], v237 offset:2048
    v_cvt_pk_bf16_f32 v139, v142, v143
    v_mfma_f32_16x16x32_bf16 v[104:107], a[196:199], a[108:111], v[104:107]
    v_exp_f32 v148, v148
    v_mfma_f32_16x16x32_bf16 a[232:235], a[228:231], v[136:139], a[232:235]
    v_exp_f32 v149, v149
    v_mfma_f32_16x16x32_bf16 v[112:115], a[196:199], a[148:151], v[112:115]
    v_exp_f32 v150, v150
    v_mfma_f32_16x16x32_bf16 v[120:123], a[196:199], a[156:159], v[120:123]
    v_fma_f32 v151, v151, s20, v250
    s_waitcnt lgkmcnt(2)
    v_mfma_f32_16x16x32_bf16 v[96:99], a[200:203], a[112:115], v[96:99]
    ds_read_b128 a[192:195], v236 offset:6144
    v_fma_f32 v156, v156, s20, v251
    v_mfma_f32_16x16x32_bf16 v[104:107], a[200:203], a[120:123], v[104:107]
    s_add_u32 m0, s38, 1792
    v_fma_f32 v157, v157, s20, v251
    v_mfma_f32_16x16x32_bf16 v[112:115], a[200:203], a[160:163], v[112:115]
    buffer_load_dwordx4 v244, s[4:7], s41 offen offset:256 nt lds
    v_mfma_f32_16x16x32_bf16 v[120:123], a[200:203], a[168:171], v[120:123]
    v_exp_f32 v151, v151
    v_mfma_f32_16x16x32_bf16 v[96:99], a[204:207], a[116:119], v[96:99]
    ds_read_b128 a[196:199], v237 offset:6144
    v_fma_f32 v158, v158, s20, v251
    v_mfma_f32_16x16x32_bf16 v[104:107], a[204:207], a[124:127], v[104:107]
    v_exp_f32 v156, v156
    v_mfma_f32_16x16x32_bf16 v[112:115], a[204:207], a[164:167], v[112:115]
    v_exp_f32 v157, v157
    v_mfma_f32_16x16x32_bf16 v[120:123], a[204:207], a[172:175], v[120:123]
    v_fma_f32 v159, v159, s20, v251
    s_waitcnt lgkmcnt(2)
    v_mfma_f32_16x16x32_bf16 v[96:99], a[208:211], a[128:131], v[96:99]
    ds_read_b128 a[200:203], v236 offset:7168
    v_cvt_pk_bf16_f32 v146, v148, v149
    v_mfma_f32_16x16x32_bf16 v[104:107], a[208:211], a[136:139], v[104:107]
    s_add_u32 m0, s27, 37760
    v_cvt_pk_bf16_f32 v147, v150, v151
    v_mfma_f32_16x16x32_bf16 v[112:115], a[208:211], a[176:179], v[112:115]
    buffer_load_dwordx4 v241, s[8:11], s25 offen offset:128 nt lds
    v_mfma_f32_16x16x32_bf16 a[236:239], a[224:227], v[144:147], a[236:239]
    v_exp_f32 v158, v158
    v_mfma_f32_16x16x32_bf16 v[120:123], a[208:211], a[184:187], v[120:123]
    v_exp_f32 v159, v159
    v_mfma_f32_16x16x32_bf16 v[96:99], a[212:215], a[132:135], v[96:99]
    ds_read_b128 a[204:207], v237 offset:7168
    v_cvt_pk_bf16_f32 v154, v156, v157
    v_mfma_f32_16x16x32_bf16 v[104:107], a[212:215], a[140:143], v[104:107]
    s_cmp_eq_u32 s28, s30
    s_cselect_b32 s35, -49664, s37
    v_mfma_f32_16x16x32_bf16 v[112:115], a[212:215], a[180:183], v[112:115]
    v_cvt_pk_bf16_f32 v155, v158, v159
    v_mfma_f32_16x16x32_bf16 v[120:123], a[212:215], a[188:191], v[120:123]
    s_add_u32 s29, s28, s35
    s_waitcnt lgkmcnt(2)
    v_mfma_f32_16x16x32_bf16 v[100:103], a[192:195], a[96:99], 0
    ds_read_b128 a[208:211], v236 offset:8192
    v_add_u32 v240, s35, v240
    v_mfma_f32_16x16x32_bf16 a[236:239], a[228:231], v[152:155], a[236:239]
    v_mfma_f32_16x16x32_bf16 v[108:111], a[192:195], a[104:107], 0
    v_mfma_f32_16x16x32_bf16 v[116:119], a[192:195], a[144:147], 0
    v_mfma_f32_16x16x32_bf16 v[124:127], a[192:195], a[152:155], 0
    v_fma_f32 v96, v96, s20, v248
    v_fma_f32 v97, v97, s20, v248
    v_mfma_f32_16x16x32_bf16 v[100:103], a[196:199], a[100:103], v[100:103]
    ds_read_b128 a[212:215], v237 offset:8192
    v_fma_f32 v104, v104, s20, v249
    v_mfma_f32_16x16x32_bf16 v[108:111], a[196:199], a[108:111], v[108:111]
    v_exp_f32 v96, v96
    v_mfma_f32_16x16x32_bf16 v[116:119], a[196:199], a[148:151], v[116:119]
    v_exp_f32 v97, v97
    v_mfma_f32_16x16x32_bf16 v[124:127], a[196:199], a[156:159], v[124:127]
    v_fma_f32 v105, v105, s20, v249
    s_waitcnt lgkmcnt(2)
    v_mfma_f32_16x16x32_bf16 v[100:103], a[200:203], a[112:115], v[100:103]
    ds_read_b64_tr_b16 a[192:193], v240
    v_fma_f32 v112, v112, s20, v250
    v_mfma_f32_16x16x32_bf16 v[108:111], a[200:203], a[120:123], v[108:111]
    ds_read_b64_tr_b16 a[194:195], v240 offset:512
    s_add_u32 m0, s27, 38656
    v_mfma_f32_16x16x32_bf16 v[116:119], a[200:203], a[160:163], v[116:119]
    buffer_load_dwordx4 v241, s[8:11], s25 offen offset:256 nt lds
    v_mfma_f32_16x16x32_bf16 v[124:127], a[200:203], a[168:171], v[124:127]
    v_exp_f32 v104, v104
    v_mfma_f32_16x16x32_bf16 v[100:103], a[204:207], a[116:119], v[100:103]
    ds_read_b64_tr_b16 a[196:197], v240 offset:8
    v_fma_f32 v113, v113, s20, v250
    v_mfma_f32_16x16x32_bf16 v[108:111], a[204:207], a[124:127], v[108:111]
    ds_read_b64_tr_b16 a[198:199], v240 offset:520
    v_cvt_pk_bf16_f32 v96, v96, v97
    v_mfma_f32_16x16x32_bf16 v[116:119], a[204:207], a[164:167], v[116:119]
    v_exp_f32 v105, v105
    v_mfma_f32_16x16x32_bf16 v[124:127], a[204:207], a[172:175], v[124:127]
    v_fma_f32 v120, v120, s20, v251
    s_waitcnt lgkmcnt(4)
    v_mfma_f32_16x16x32_bf16 v[100:103], a[208:211], a[128:131], v[100:103]
    ds_read_b64_tr_b16 a[200:201], v240 offset:64
    v_cvt_pk_bf16_f32 v104, v104, v105
    v_mfma_f32_16x16x32_bf16 v[108:111], a[208:211], a[136:139], v[108:111]
    ds_read_b64_tr_b16 a[202:203], v240 offset:576
    s_add_u32 m0, s38, 5888
    v_mfma_f32_16x16x32_bf16 v[116:119], a[208:211], a[176:179], v[116:119]
    buffer_load_dwordx4 v244, s[4:7], s43 offen offset:256 nt lds
    v_mfma_f32_16x16x32_bf16 v[124:127], a[208:211], a[184:187], v[124:127]
    v_exp_f32 v112, v112
    v_mfma_f32_16x16x32_bf16 v[100:103], a[212:215], a[132:135], v[100:103]
    ds_read_b64_tr_b16 a[204:205], v240 offset:72
    v_fma_f32 v121, v121, s20, v251
    v_mfma_f32_16x16x32_bf16 v[108:111], a[212:215], a[140:143], v[108:111]
    ds_read_b64_tr_b16 a[206:207], v240 offset:584
    v_fma_f32 v98, v98, s20, v248
    v_mfma_f32_16x16x32_bf16 v[116:119], a[212:215], a[180:183], v[116:119]
    s_waitcnt vmcnt(19)
    s_barrier
    v_mfma_f32_16x16x32_bf16 v[124:127], a[212:215], a[188:191], v[124:127]
    v_fma_f32 v99, v99, s20, v248
    s_waitcnt lgkmcnt(4)
    v_mfma_f32_16x16x32_bf16 a[0:3], a[192:195], v[128:131], a[0:3]
    ds_read_b64_tr_b16 a[208:209], v240 offset:1024
    v_fma_f32 v106, v106, s20, v249
    v_mfma_f32_16x16x32_bf16 a[8:11], a[192:195], v[136:139], a[8:11]
    ds_read_b64_tr_b16 a[210:211], v240 offset:1536
    s_add_u32 m0, s28, 0
    v_mfma_f32_16x16x32_bf16 a[48:51], a[192:195], v[144:147], a[48:51]
    buffer_load_dwordx4 v242, s[48:51], s25 offen nt lds
    v_mfma_f32_16x16x32_bf16 a[56:59], a[192:195], v[152:155], a[56:59]
    v_exp_f32 v113, v113
    v_mfma_f32_16x16x32_bf16 a[4:7], a[196:199], v[128:131], a[4:7]
    ds_read_b64_tr_b16 a[212:213], v240 offset:1032
    v_cvt_pk_bf16_f32 v112, v112, v113
    v_mfma_f32_16x16x32_bf16 a[12:15], a[196:199], v[136:139], a[12:15]
    ds_read_b64_tr_b16 a[214:215], v240 offset:1544
    v_fma_f32 v107, v107, s20, v249
    v_mfma_f32_16x16x32_bf16 a[52:55], a[196:199], v[144:147], a[52:55]
    v_exp_f32 v120, v120
    v_mfma_f32_16x16x32_bf16 a[60:63], a[196:199], v[152:155], a[60:63]
    v_fma_f32 v114, v114, s20, v250
    s_waitcnt lgkmcnt(4)
    v_mfma_f32_16x16x32_bf16 a[16:19], a[200:203], v[128:131], a[16:19]
    ds_read_b64_tr_b16 a[192:193], v240 offset:1088
    v_fma_f32 v115, v115, s20, v250
    v_mfma_f32_16x16x32_bf16 a[24:27], a[200:203], v[136:139], a[24:27]
    ds_read_b64_tr_b16 a[194:195], v240 offset:1600
    v_fma_f32 v122, v122, s20, v251
    v_mfma_f32_16x16x32_bf16 a[64:67], a[200:203], v[144:147], a[64:67]
    v_exp_f32 v121, v121
    v_mfma_f32_16x16x32_bf16 a[72:75], a[200:203], v[152:155], a[72:75]
    v_exp_f32 v98, v98
    v_mfma_f32_16x16x32_bf16 a[20:23], a[204:207], v[128:131], a[20:23]
    ds_read_b64_tr_b16 a[196:197], v240 offset:1096
    v_cvt_pk_bf16_f32 v120, v120, v121
    v_mfma_f32_16x16x32_bf16 a[28:31], a[204:207], v[136:139], a[28:31]
    ds_read_b64_tr_b16 a[198:199], v240 offset:1608
    v_fma_f32 v123, v123, s20, v251
    v_mfma_f32_16x16x32_bf16 a[68:71], a[204:207], v[144:147], a[68:71]
    v_exp_f32 v99, v99
    v_mfma_f32_16x16x32_bf16 a[76:79], a[204:207], v[152:155], a[76:79]
    v_cvt_pk_bf16_f32 v97, v98, v99
    s_waitcnt lgkmcnt(4)
    v_mfma_f32_16x16x32_bf16 a[32:35], a[208:211], v[128:131], a[32:35]
    ds_read_b64_tr_b16 a[200:201], v240 offset:2048
    v_fma_f32 v100, v100, s20, v248
    v_mfma_f32_16x16x32_bf16 a[40:43], a[208:211], v[136:139], a[40:43]
    ds_read_b64_tr_b16 a[202:203], v240 offset:2560
    s_add_u32 m0, s28, 896
    v_mfma_f32_16x16x32_bf16 a[80:83], a[208:211], v[144:147], a[80:83]
    buffer_load_dwordx4 v242, s[48:51], s25 offen offset:128 nt lds
    v_mfma_f32_16x16x32_bf16 a[88:91], a[208:211], v[152:155], a[88:91]
    v_exp_f32 v106, v106
    v_mfma_f32_16x16x32_bf16 a[36:39], a[212:215], v[128:131], a[36:39]
    ds_read_b64_tr_b16 a[204:205], v240 offset:2056
    v_fma_f32 v101, v101, s20, v248
    v_mfma_f32_16x16x32_bf16 a[44:47], a[212:215], v[136:139], a[44:47]
    ds_read_b64_tr_b16 a[206:207], v240 offset:2568
    v_fma_f32 v102, v102, s20, v248
    v_mfma_f32_16x16x32_bf16 a[84:87], a[212:215], v[144:147], a[84:87]
    v_exp_f32 v107, v107
    v_mfma_f32_16x16x32_bf16 a[92:95], a[212:215], v[152:155], a[92:95]
    v_cvt_pk_bf16_f32 v105, v106, v107
    s_waitcnt lgkmcnt(4)
    v_mfma_f32_16x16x32_bf16 v[0:3], a[192:195], v[128:131], v[0:3]
    ds_read_b64_tr_b16 a[208:209], v240 offset:2112
    v_fma_f32 v103, v103, s20, v248
    v_mfma_f32_16x16x32_bf16 v[8:11], a[192:195], v[136:139], v[8:11]
    ds_read_b64_tr_b16 a[210:211], v240 offset:2624
    v_fma_f32 v108, v108, s20, v249
    v_mfma_f32_16x16x32_bf16 v[48:51], a[192:195], v[144:147], v[48:51]
    buffer_store_dwordx4 v[224:227], v243, s[16:19], s44 offen offset:128 nt
    v_mfma_f32_16x16x32_bf16 v[56:59], a[192:195], v[152:155], v[56:59]
    v_exp_f32 v114, v114
    v_mfma_f32_16x16x32_bf16 v[4:7], a[196:199], v[128:131], v[4:7]
    ds_read_b64_tr_b16 a[212:213], v240 offset:2120
    v_fma_f32 v109, v109, s20, v249
    v_mfma_f32_16x16x32_bf16 v[12:15], a[196:199], v[136:139], v[12:15]
    ds_read_b64_tr_b16 a[214:215], v240 offset:2632
    v_fma_f32 v110, v110, s20, v249
    v_mfma_f32_16x16x32_bf16 v[52:55], a[196:199], v[144:147], v[52:55]
    v_exp_f32 v115, v115
    v_mfma_f32_16x16x32_bf16 v[60:63], a[196:199], v[152:155], v[60:63]
    v_cvt_pk_bf16_f32 v113, v114, v115
    s_waitcnt lgkmcnt(4)
    v_mfma_f32_16x16x32_bf16 v[16:19], a[200:203], v[128:131], v[16:19]
    ds_read_b128 a[192:195], v236 offset:12288
    v_fma_f32 v111, v111, s20, v249
    v_mfma_f32_16x16x32_bf16 v[24:27], a[200:203], v[136:139], v[24:27]
    s_add_u32 m0, s28, 1792
    v_fma_f32 v116, v116, s20, v250
    v_mfma_f32_16x16x32_bf16 v[64:67], a[200:203], v[144:147], v[64:67]
    buffer_load_dwordx4 v242, s[48:51], s25 offen offset:256 nt lds
    v_mfma_f32_16x16x32_bf16 v[72:75], a[200:203], v[152:155], v[72:75]
    v_exp_f32 v122, v122
    v_mfma_f32_16x16x32_bf16 v[20:23], a[204:207], v[128:131], v[20:23]
    ds_read_b128 a[196:199], v237 offset:12288
    v_fma_f32 v117, v117, s20, v250
    v_mfma_f32_16x16x32_bf16 v[28:31], a[204:207], v[136:139], v[28:31]
    v_exp_f32 v123, v123
    v_mfma_f32_16x16x32_bf16 v[68:71], a[204:207], v[144:147], v[68:71]
    v_exp_f32 v100, v100
    v_mfma_f32_16x16x32_bf16 v[76:79], a[204:207], v[152:155], v[76:79]
    v_cvt_pk_bf16_f32 v121, v122, v123
    s_waitcnt lgkmcnt(2)
    v_mfma_f32_16x16x32_bf16 v[32:35], a[208:211], v[128:131], v[32:35]
    ds_read_b128 a[200:203], v236 offset:13312
    v_fma_f32 v118, v118, s20, v250
    v_mfma_f32_16x16x32_bf16 v[40:43], a[208:211], v[136:139], v[40:43]
    v_exp_f32 v101, v101
    v_mfma_f32_16x16x32_bf16 v[80:83], a[208:211], v[144:147], v[80:83]
    v_exp_f32 v102, v102
    v_mfma_f32_16x16x32_bf16 v[88:91], a[208:211], v[152:155], v[88:91]
    s_add_u32 s25, s26, 12288
    v_cvt_pk_bf16_f32 v98, v100, v101
    v_mfma_f32_16x16x32_bf16 v[36:39], a[212:215], v[128:131], v[36:39]
    ds_read_b128 a[204:207], v237 offset:13312
    v_fma_f32 v119, v119, s20, v250
    v_mfma_f32_16x16x32_bf16 v[44:47], a[212:215], v[136:139], v[44:47]
    v_exp_f32 v103, v103
    v_mfma_f32_16x16x32_bf16 v[84:87], a[212:215], v[144:147], v[84:87]
    v_exp_f32 v108, v108
    v_mfma_f32_16x16x32_bf16 v[92:95], a[212:215], v[152:155], v[92:95]
    v_cvt_pk_bf16_f32 v99, v102, v103
    s_waitcnt lgkmcnt(2)
    v_mfma_f32_16x16x32_bf16 v[128:131], a[192:195], a[96:99], 0
    ds_read_b128 a[208:211], v236 offset:14336
    v_fma_f32 v124, v124, s20, v251
    v_mfma_f32_16x16x32_bf16 a[232:235], a[224:227], v[96:99], a[232:235]
    v_exp_f32 v109, v109
    v_mfma_f32_16x16x32_bf16 v[136:139], a[192:195], a[104:107], 0
    s_add_u32 m0, s27, 0
    v_cvt_pk_bf16_f32 v106, v108, v109
    v_mfma_f32_16x16x32_bf16 v[144:147], a[192:195], a[144:147], 0
    buffer_load_dwordx4 v241, s[8:11], s26 offen nt lds
    v_mfma_f32_16x16x32_bf16 v[152:155], a[192:195], a[152:155], 0
    v_exp_f32 v110, v110
    v_mfma_f32_16x16x32_bf16 v[128:131], a[196:199], a[100:103], v[128:131]
    ds_read_b128 a[212:215], v237 offset:14336
    v_fma_f32 v125, v125, s20, v251
    v_mfma_f32_16x16x32_bf16 v[136:139], a[196:199], a[108:111], v[136:139]
    v_exp_f32 v111, v111
    v_mfma_f32_16x16x32_bf16 v[144:147], a[196:199], a[148:151], v[144:147]
    v_exp_f32 v116, v116
    v_mfma_f32_16x16x32_bf16 v[152:155], a[196:199], a[156:159], v[152:155]
    v_cvt_pk_bf16_f32 v107, v110, v111
    s_waitcnt lgkmcnt(2)
    v_mfma_f32_16x16x32_bf16 v[128:131], a[200:203], a[112:115], v[128:131]
    ds_read_b128 a[192:195], v236 offset:18432
    v_fma_f32 v126, v126, s20, v251
    v_mfma_f32_16x16x32_bf16 a[232:235], a[228:231], v[104:107], a[232:235]
    v_exp_f32 v117, v117
    v_mfma_f32_16x16x32_bf16 v[136:139], a[200:203], a[120:123], v[136:139]
    v_exp_f32 v118, v118
    v_mfma_f32_16x16x32_bf16 v[144:147], a[200:203], a[160:163], v[144:147]
    buffer_store_dwordx4 v[228:231], v243, s[16:19], s46 offen offset:128 nt
    v_mfma_f32_16x16x32_bf16 v[152:155], a[200:203], a[168:171], v[152:155]
    v_exp_f32 v119, v119
    v_mfma_f32_16x16x32_bf16 v[128:131], a[204:207], a[116:119], v[128:131]
    ds_read_b128 a[196:199], v237 offset:18432
    v_cvt_pk_bf16_f32 v114, v116, v117
    v_mfma_f32_16x16x32_bf16 v[136:139], a[204:207], a[124:127], v[136:139]
    v_exp_f32 v124, v124
    v_mfma_f32_16x16x32_bf16 v[144:147], a[204:207], a[164:167], v[144:147]
    v_exp_f32 v125, v125
    v_mfma_f32_16x16x32_bf16 v[152:155], a[204:207], a[172:175], v[152:155]
    v_fma_f32 v127, v127, s20, v251
    s_waitcnt lgkmcnt(2)
    v_mfma_f32_16x16x32_bf16 v[128:131], a[208:211], a[128:131], v[128:131]
    ds_read_b128 a[200:203], v236 offset:19456
    v_cvt_pk_bf16_f32 v115, v118, v119
    v_mfma_f32_16x16x32_bf16 v[136:139], a[208:211], a[136:139], v[136:139]
    s_add_u32 m0, s27, 896
    v_cvt_pk_bf16_f32 v122, v124, v125
    v_mfma_f32_16x16x32_bf16 a[236:239], a[224:227], v[112:115], a[236:239]
    v_exp_f32 v126, v126
    v_mfma_f32_16x16x32_bf16 v[144:147], a[208:211], a[176:179], v[144:147]
    buffer_load_dwordx4 v241, s[8:11], s26 offen offset:128 nt lds
    v_mfma_f32_16x16x32_bf16 v[152:155], a[208:211], a[184:187], v[152:155]
    v_exp_f32 v127, v127
    v_mfma_f32_16x16x32_bf16 v[128:131], a[212:215], a[132:135], v[128:131]
    ds_read_b128 a[204:207], v237 offset:19456
    v_cvt_pk_bf16_f32 v123, v126, v127
    v_mfma_f32_16x16x32_bf16 v[136:139], a[212:215], a[140:143], v[136:139]
    s_cmp_eq_u32 s29, s30
    s_cselect_b32 s35, -49664, s37
    v_mfma_f32_16x16x32_bf16 a[236:239], a[228:231], v[120:123], a[236:239]
    v_mfma_f32_16x16x32_bf16 v[144:147], a[212:215], a[180:183], v[144:147]
    v_mfma_f32_16x16x32_bf16 v[152:155], a[212:215], a[188:191], v[152:155]
    s_add_u32 s28, s29, s35
    s_waitcnt lgkmcnt(2)
    v_mfma_f32_16x16x32_bf16 v[132:135], a[192:195], a[96:99], 0
    ds_read_b128 a[208:211], v236 offset:20480
    v_add_u32 v240, s35, v240
    v_mfma_f32_16x16x32_bf16 v[140:143], a[192:195], a[104:107], 0
    v_mfma_f32_16x16x32_bf16 v[148:151], a[192:195], a[144:147], 0
    v_mfma_f32_16x16x32_bf16 v[156:159], a[192:195], a[152:155], 0
    v_fma_f32 v128, v128, s20, v248
    v_fma_f32 v129, v129, s20, v248
    v_mfma_f32_16x16x32_bf16 v[132:135], a[196:199], a[100:103], v[132:135]
    ds_read_b128 a[212:215], v237 offset:20480
    v_fma_f32 v136, v136, s20, v249
    v_mfma_f32_16x16x32_bf16 v[140:143], a[196:199], a[108:111], v[140:143]
    v_exp_f32 v128, v128
    v_mfma_f32_16x16x32_bf16 v[148:151], a[196:199], a[148:151], v[148:151]
    v_exp_f32 v129, v129
    v_mfma_f32_16x16x32_bf16 v[156:159], a[196:199], a[156:159], v[156:159]
    v_fma_f32 v137, v137, s20, v249
    s_waitcnt lgkmcnt(2)
    v_mfma_f32_16x16x32_bf16 v[132:135], a[200:203], a[112:115], v[132:135]
    ds_read_b64_tr_b16 a[192:193], v240
    v_fma_f32 v144, v144, s20, v250
    v_mfma_f32_16x16x32_bf16 v[140:143], a[200:203], a[120:123], v[140:143]
    ds_read_b64_tr_b16 a[194:195], v240 offset:512
    s_add_u32 m0, s27, 1792
    v_mfma_f32_16x16x32_bf16 v[148:151], a[200:203], a[160:163], v[148:151]
    buffer_load_dwordx4 v241, s[8:11], s26 offen offset:256 nt lds
    v_mfma_f32_16x16x32_bf16 v[156:159], a[200:203], a[168:171], v[156:159]
    v_exp_f32 v136, v136
    v_mfma_f32_16x16x32_bf16 v[132:135], a[204:207], a[116:119], v[132:135]
    ds_read_b64_tr_b16 a[196:197], v240 offset:8
    v_fma_f32 v145, v145, s20, v250
    v_mfma_f32_16x16x32_bf16 v[140:143], a[204:207], a[124:127], v[140:143]
    ds_read_b64_tr_b16 a[198:199], v240 offset:520
    v_cvt_pk_bf16_f32 v128, v128, v129
    v_mfma_f32_16x16x32_bf16 v[148:151], a[204:207], a[164:167], v[148:151]
    v_exp_f32 v137, v137
    v_mfma_f32_16x16x32_bf16 v[156:159], a[204:207], a[172:175], v[156:159]
    v_fma_f32 v152, v152, s20, v251
    s_waitcnt lgkmcnt(4)
    v_mfma_f32_16x16x32_bf16 v[132:135], a[208:211], a[128:131], v[132:135]
    ds_read_b64_tr_b16 a[200:201], v240 offset:64
    v_cvt_pk_bf16_f32 v136, v136, v137
    v_mfma_f32_16x16x32_bf16 v[140:143], a[208:211], a[136:139], v[140:143]
    ds_read_b64_tr_b16 a[202:203], v240 offset:576
    s_add_u32 m0, s38, -256
    v_mfma_f32_16x16x32_bf16 v[148:151], a[208:211], a[176:179], v[148:151]
    buffer_load_dwordx4 v245, s[4:7], s41 offen offset:3328 nt lds
    v_mfma_f32_16x16x32_bf16 v[156:159], a[208:211], a[184:187], v[156:159]
    v_exp_f32 v144, v144
    v_mfma_f32_16x16x32_bf16 v[132:135], a[212:215], a[132:135], v[132:135]
    ds_read_b64_tr_b16 a[204:205], v240 offset:72
    v_fma_f32 v153, v153, s20, v251
    v_mfma_f32_16x16x32_bf16 v[140:143], a[212:215], a[140:143], v[140:143]
    ds_read_b64_tr_b16 a[206:207], v240 offset:584
    v_fma_f32 v130, v130, s20, v248
    v_mfma_f32_16x16x32_bf16 v[148:151], a[212:215], a[180:183], v[148:151]
    s_waitcnt vmcnt(19)
    s_barrier
    v_mfma_f32_16x16x32_bf16 v[156:159], a[212:215], a[188:191], v[156:159]
    v_fma_f32 v131, v131, s20, v248
    s_waitcnt lgkmcnt(4)
    v_mfma_f32_16x16x32_bf16 a[0:3], a[192:195], v[96:99], a[0:3]
    ds_read_b64_tr_b16 a[208:209], v240 offset:1024
    v_fma_f32 v138, v138, s20, v249
    v_mfma_f32_16x16x32_bf16 a[8:11], a[192:195], v[104:107], a[8:11]
    ds_read_b64_tr_b16 a[210:211], v240 offset:1536
    s_add_u32 m0, s29, 0
    v_mfma_f32_16x16x32_bf16 a[48:51], a[192:195], v[112:115], a[48:51]
    buffer_load_dwordx4 v242, s[48:51], s26 offen nt lds
    v_mfma_f32_16x16x32_bf16 a[56:59], a[192:195], v[120:123], a[56:59]
    v_exp_f32 v145, v145
    v_mfma_f32_16x16x32_bf16 a[4:7], a[196:199], v[96:99], a[4:7]
    ds_read_b64_tr_b16 a[212:213], v240 offset:1032
    v_cvt_pk_bf16_f32 v144, v144, v145
    v_mfma_f32_16x16x32_bf16 a[12:15], a[196:199], v[104:107], a[12:15]
    ds_read_b64_tr_b16 a[214:215], v240 offset:1544
    v_fma_f32 v139, v139, s20, v249
    v_mfma_f32_16x16x32_bf16 a[52:55], a[196:199], v[112:115], a[52:55]
    v_exp_f32 v152, v152
    v_mfma_f32_16x16x32_bf16 a[60:63], a[196:199], v[120:123], a[60:63]
    v_fma_f32 v146, v146, s20, v250
    s_waitcnt lgkmcnt(4)
    v_mfma_f32_16x16x32_bf16 a[16:19], a[200:203], v[96:99], a[16:19]
    ds_read_b64_tr_b16 a[192:193], v240 offset:1088
    v_fma_f32 v147, v147, s20, v250
    v_mfma_f32_16x16x32_bf16 a[24:27], a[200:203], v[104:107], a[24:27]
    ds_read_b64_tr_b16 a[194:195], v240 offset:1600
    v_fma_f32 v154, v154, s20, v251
    v_mfma_f32_16x16x32_bf16 a[64:67], a[200:203], v[112:115], a[64:67]
    v_exp_f32 v153, v153
    v_mfma_f32_16x16x32_bf16 a[72:75], a[200:203], v[120:123], a[72:75]
    v_exp_f32 v130, v130
    v_mfma_f32_16x16x32_bf16 a[20:23], a[204:207], v[96:99], a[20:23]
    ds_read_b64_tr_b16 a[196:197], v240 offset:1096
    v_cvt_pk_bf16_f32 v152, v152, v153
    v_mfma_f32_16x16x32_bf16 a[28:31], a[204:207], v[104:107], a[28:31]
    ds_read_b64_tr_b16 a[198:199], v240 offset:1608
    v_fma_f32 v155, v155, s20, v251
    v_mfma_f32_16x16x32_bf16 a[68:71], a[204:207], v[112:115], a[68:71]
    v_exp_f32 v131, v131
    v_mfma_f32_16x16x32_bf16 a[76:79], a[204:207], v[120:123], a[76:79]
    v_cvt_pk_bf16_f32 v129, v130, v131
    s_waitcnt lgkmcnt(4)
    v_mfma_f32_16x16x32_bf16 a[32:35], a[208:211], v[96:99], a[32:35]
    ds_read_b64_tr_b16 a[200:201], v240 offset:2048
    v_fma_f32 v132, v132, s20, v248
    v_mfma_f32_16x16x32_bf16 a[40:43], a[208:211], v[104:107], a[40:43]
    ds_read_b64_tr_b16 a[202:203], v240 offset:2560
    s_add_u32 m0, s29, 896
    v_mfma_f32_16x16x32_bf16 a[80:83], a[208:211], v[112:115], a[80:83]
    buffer_load_dwordx4 v242, s[48:51], s26 offen offset:128 nt lds
    v_mfma_f32_16x16x32_bf16 a[88:91], a[208:211], v[120:123], a[88:91]
    v_exp_f32 v138, v138
    v_mfma_f32_16x16x32_bf16 a[36:39], a[212:215], v[96:99], a[36:39]
    ds_read_b64_tr_b16 a[204:205], v240 offset:2056
    v_fma_f32 v133, v133, s20, v248
    v_mfma_f32_16x16x32_bf16 a[44:47], a[212:215], v[104:107], a[44:47]
    ds_read_b64_tr_b16 a[206:207], v240 offset:2568
    v_fma_f32 v134, v134, s20, v248
    v_mfma_f32_16x16x32_bf16 a[84:87], a[212:215], v[112:115], a[84:87]
    v_exp_f32 v139, v139
    v_mfma_f32_16x16x32_bf16 a[92:95], a[212:215], v[120:123], a[92:95]
    v_cvt_pk_bf16_f32 v137, v138, v139
    s_waitcnt lgkmcnt(4)
    v_mfma_f32_16x16x32_bf16 v[0:3], a[192:195], v[96:99], v[0:3]
    ds_read_b64_tr_b16 a[208:209], v240 offset:2112
    v_fma_f32 v135, v135, s20, v248
    v_mfma_f32_16x16x32_bf16 v[8:11], a[192:195], v[104:107], v[8:11]
    ds_read_b64_tr_b16 a[210:211], v240 offset:2624
    s_add_u32 m0, s38, 3840
    v_mfma_f32_16x16x32_bf16 v[48:51], a[192:195], v[112:115], v[48:51]
    buffer_load_dwordx4 v245, s[4:7], s43 offen offset:3328 nt lds
    v_mfma_f32_16x16x32_bf16 v[56:59], a[192:195], v[120:123], v[56:59]
    v_exp_f32 v146, v146
    v_mfma_f32_16x16x32_bf16 v[4:7], a[196:199], v[96:99], v[4:7]
    ds_read_b64_tr_b16 a[212:213], v240 offset:2120
    v_fma_f32 v140, v140, s20, v249
    v_mfma_f32_16x16x32_bf16 v[12:15], a[196:199], v[104:107], v[12:15]
    ds_read_b64_tr_b16 a[214:215], v240 offset:2632
    v_fma_f32 v141, v141, s20, v249
    v_mfma_f32_16x16x32_bf16 v[52:55], a[196:199], v[112:115], v[52:55]
    v_exp_f32 v147, v147
    v_mfma_f32_16x16x32_bf16 v[60:63], a[196:199], v[120:123], v[60:63]
    v_cvt_pk_bf16_f32 v145, v146, v147
    s_waitcnt lgkmcnt(4)
    v_mfma_f32_16x16x32_bf16 v[16:19], a[200:203], v[96:99], v[16:19]
    ds_read_b128 a[192:195], v236 offset:24576
    v_fma_f32 v142, v142, s20, v249
    v_mfma_f32_16x16x32_bf16 v[24:27], a[200:203], v[104:107], v[24:27]
    s_add_u32 m0, s29, 1792
    v_fma_f32 v143, v143, s20, v249
    v_mfma_f32_16x16x32_bf16 v[64:67], a[200:203], v[112:115], v[64:67]
    buffer_load_dwordx4 v242, s[48:51], s26 offen offset:256 nt lds
    v_mfma_f32_16x16x32_bf16 v[72:75], a[200:203], v[120:123], v[72:75]
    v_exp_f32 v154, v154
    v_mfma_f32_16x16x32_bf16 v[20:23], a[204:207], v[96:99], v[20:23]
    ds_read_b128 a[196:199], v237 offset:24576
    v_fma_f32 v148, v148, s20, v250
    v_mfma_f32_16x16x32_bf16 v[28:31], a[204:207], v[104:107], v[28:31]
    v_exp_f32 v155, v155
    v_mfma_f32_16x16x32_bf16 v[68:71], a[204:207], v[112:115], v[68:71]
    v_exp_f32 v132, v132
    v_mfma_f32_16x16x32_bf16 v[76:79], a[204:207], v[120:123], v[76:79]
    v_cvt_pk_bf16_f32 v153, v154, v155
    s_waitcnt lgkmcnt(2)
    v_mfma_f32_16x16x32_bf16 v[32:35], a[208:211], v[96:99], v[32:35]
    ds_read_b128 a[200:203], v236 offset:25600
    v_fma_f32 v149, v149, s20, v250
    v_mfma_f32_16x16x32_bf16 v[40:43], a[208:211], v[104:107], v[40:43]
    v_exp_f32 v133, v133
    v_mfma_f32_16x16x32_bf16 v[80:83], a[208:211], v[112:115], v[80:83]
    v_exp_f32 v134, v134
    v_mfma_f32_16x16x32_bf16 v[88:91], a[208:211], v[120:123], v[88:91]
    s_add_u32 s26, s25, 12288
    v_cvt_pk_bf16_f32 v130, v132, v133
    v_mfma_f32_16x16x32_bf16 v[36:39], a[212:215], v[96:99], v[36:39]
    ds_read_b128 a[204:207], v237 offset:25600
    v_fma_f32 v150, v150, s20, v250
    v_mfma_f32_16x16x32_bf16 v[44:47], a[212:215], v[104:107], v[44:47]
    v_exp_f32 v135, v135
    v_mfma_f32_16x16x32_bf16 v[84:87], a[212:215], v[112:115], v[84:87]
    v_exp_f32 v140, v140
    v_mfma_f32_16x16x32_bf16 v[92:95], a[212:215], v[120:123], v[92:95]
    v_cvt_pk_bf16_f32 v131, v134, v135
    s_waitcnt lgkmcnt(2)
    v_mfma_f32_16x16x32_bf16 v[96:99], a[192:195], a[96:99], 0
    ds_read_b128 a[208:211], v236 offset:26624
    v_fma_f32 v151, v151, s20, v250
    v_mfma_f32_16x16x32_bf16 a[232:235], a[224:227], v[128:131], a[232:235]
    v_exp_f32 v141, v141
    v_mfma_f32_16x16x32_bf16 v[104:107], a[192:195], a[104:107], 0
    s_add_u32 m0, s27, 12288
    v_cvt_pk_bf16_f32 v138, v140, v141
    v_mfma_f32_16x16x32_bf16 v[112:115], a[192:195], a[144:147], 0
    buffer_load_dwordx4 v241, s[8:11], s25 offen nt lds
    v_mfma_f32_16x16x32_bf16 v[120:123], a[192:195], a[152:155], 0
    v_exp_f32 v142, v142
    v_mfma_f32_16x16x32_bf16 v[96:99], a[196:199], a[100:103], v[96:99]
    ds_read_b128 a[212:215], v237 offset:26624
    v_fma_f32 v156, v156, s20, v251
    v_mfma_f32_16x16x32_bf16 v[104:107], a[196:199], a[108:111], v[104:107]
    v_exp_f32 v143, v143
    v_mfma_f32_16x16x32_bf16 v[112:115], a[196:199], a[148:151], v[112:115]
    v_exp_f32 v148, v148
    v_mfma_f32_16x16x32_bf16 v[120:123], a[196:199], a[156:159], v[120:123]
    v_cvt_pk_bf16_f32 v139, v142, v143
    s_waitcnt lgkmcnt(2)
    v_mfma_f32_16x16x32_bf16 v[96:99], a[200:203], a[112:115], v[96:99]
    ds_read_b128 a[192:195], v236 offset:30720
    v_fma_f32 v157, v157, s20, v251
    v_mfma_f32_16x16x32_bf16 a[232:235], a[228:231], v[136:139], a[232:235]
    v_exp_f32 v149, v149
    v_mfma_f32_16x16x32_bf16 v[104:107], a[200:203], a[120:123], v[104:107]
    v_exp_f32 v150, v150
    v_mfma_f32_16x16x32_bf16 v[112:115], a[200:203], a[160:163], v[112:115]
    buffer_store_dwordx4 a[252:255], v243, s[16:19], s44 offen offset:640 nt
    v_mfma_f32_16x16x32_bf16 v[120:123], a[200:203], a[168:171], v[120:123]
    v_exp_f32 v151, v151
    v_mfma_f32_16x16x32_bf16 v[96:99], a[204:207], a[116:119], v[96:99]
    ds_read_b128 a[196:199], v237 offset:30720
    v_fma_f32 v158, v158, s20, v251
    v_mfma_f32_16x16x32_bf16 v[104:107], a[204:207], a[124:127], v[104:107]
    v_exp_f32 v156, v156
    v_mfma_f32_16x16x32_bf16 v[112:115], a[204:207], a[164:167], v[112:115]
    v_exp_f32 v157, v157
    v_mfma_f32_16x16x32_bf16 v[120:123], a[204:207], a[172:175], v[120:123]
    v_fma_f32 v159, v159, s20, v251
    s_waitcnt lgkmcnt(2)
    v_mfma_f32_16x16x32_bf16 v[96:99], a[208:211], a[128:131], v[96:99]
    ds_read_b128 a[200:203], v236 offset:31744
    v_cvt_pk_bf16_f32 v146, v148, v149
    v_mfma_f32_16x16x32_bf16 v[104:107], a[208:211], a[136:139], v[104:107]
    s_add_u32 m0, s27, 13184
    v_cvt_pk_bf16_f32 v147, v150, v151
    v_mfma_f32_16x16x32_bf16 v[112:115], a[208:211], a[176:179], v[112:115]
    buffer_load_dwordx4 v241, s[8:11], s25 offen offset:128 nt lds
    v_mfma_f32_16x16x32_bf16 a[236:239], a[224:227], v[144:147], a[236:239]
    v_exp_f32 v158, v158
    v_mfma_f32_16x16x32_bf16 v[120:123], a[208:211], a[184:187], v[120:123]
    v_exp_f32 v159, v159
    v_mfma_f32_16x16x32_bf16 v[96:99], a[212:215], a[132:135], v[96:99]
    ds_read_b128 a[204:207], v237 offset:31744
    v_cvt_pk_bf16_f32 v154, v156, v157
    v_mfma_f32_16x16x32_bf16 v[104:107], a[212:215], a[140:143], v[104:107]
    s_cmp_eq_u32 s28, s30
    s_cselect_b32 s35, -49664, s37
    v_mfma_f32_16x16x32_bf16 v[112:115], a[212:215], a[180:183], v[112:115]
    v_cvt_pk_bf16_f32 v155, v158, v159
    v_mfma_f32_16x16x32_bf16 v[120:123], a[212:215], a[188:191], v[120:123]
    s_add_u32 s29, s28, s35
    s_waitcnt lgkmcnt(2)
    v_mfma_f32_16x16x32_bf16 v[100:103], a[192:195], a[96:99], 0
    ds_read_b128 a[208:211], v236 offset:32768
    v_add_u32 v240, s35, v240
    v_mfma_f32_16x16x32_bf16 a[236:239], a[228:231], v[152:155], a[236:239]
    v_mfma_f32_16x16x32_bf16 v[108:111], a[192:195], a[104:107], 0
    v_mfma_f32_16x16x32_bf16 v[116:119], a[192:195], a[144:147], 0
    buffer_load_dword v233, v232, s[4:7], s58 offen
    v_mfma_f32_16x16x32_bf16 v[124:127], a[192:195], a[152:155], 0
    s_add_u32 s58, s58, 4096
    v_fma_f32 v96, v96, s20, v248
    v_mfma_f32_16x16x32_bf16 v[100:103], a[196:199], a[100:103], v[100:103]
    ds_read_b128 a[212:215], v237 offset:32768
    v_fma_f32 v97, v97, s20, v248
    v_mfma_f32_16x16x32_bf16 v[108:111], a[196:199], a[108:111], v[108:111]
    v_exp_f32 v96, v96
    v_mfma_f32_16x16x32_bf16 v[116:119], a[196:199], a[148:151], v[116:119]
    v_exp_f32 v97, v97
    v_mfma_f32_16x16x32_bf16 v[124:127], a[196:199], a[156:159], v[124:127]
    v_fma_f32 v104, v104, s20, v249
    s_waitcnt lgkmcnt(2)
    v_mfma_f32_16x16x32_bf16 v[100:103], a[200:203], a[112:115], v[100:103]
    ds_read_b64_tr_b16 a[192:193], v240
    v_fma_f32 v105, v105, s20, v249
    v_mfma_f32_16x16x32_bf16 v[108:111], a[200:203], a[120:123], v[108:111]
    ds_read_b64_tr_b16 a[194:195], v240 offset:512
    s_add_u32 m0, s27, 14080
    v_mfma_f32_16x16x32_bf16 v[116:119], a[200:203], a[160:163], v[116:119]
    buffer_load_dwordx4 v241, s[8:11], s25 offen offset:256 nt lds
    v_mfma_f32_16x16x32_bf16 v[124:127], a[200:203], a[168:171], v[124:127]
    v_exp_f32 v104, v104
    v_mfma_f32_16x16x32_bf16 v[100:103], a[204:207], a[116:119], v[100:103]
    ds_read_b64_tr_b16 a[196:197], v240 offset:8
    v_fma_f32 v112, v112, s20, v250
    v_mfma_f32_16x16x32_bf16 v[108:111], a[204:207], a[124:127], v[108:111]
    ds_read_b64_tr_b16 a[198:199], v240 offset:520
    v_fma_f32 v113, v113, s20, v250
    v_mfma_f32_16x16x32_bf16 v[116:119], a[204:207], a[164:167], v[116:119]
    v_exp_f32 v105, v105
    v_mfma_f32_16x16x32_bf16 v[124:127], a[204:207], a[172:175], v[124:127]
    v_fma_f32 v120, v120, s20, v251
    s_waitcnt lgkmcnt(4)
    v_mfma_f32_16x16x32_bf16 v[100:103], a[208:211], a[128:131], v[100:103]
    ds_read_b64_tr_b16 a[200:201], v240 offset:64
    v_cvt_pk_bf16_f32 v96, v96, v97
    v_mfma_f32_16x16x32_bf16 v[108:111], a[208:211], a[136:139], v[108:111]
    ds_read_b64_tr_b16 a[202:203], v240 offset:576
    v_cvt_pk_bf16_f32 v104, v104, v105
    v_mfma_f32_16x16x32_bf16 v[116:119], a[208:211], a[176:179], v[116:119]
    buffer_store_dwordx4 a[244:247], v243, s[16:19], s46 offen offset:640 nt
    v_mfma_f32_16x16x32_bf16 v[124:127], a[208:211], a[184:187], v[124:127]
    v_exp_f32 v112, v112
    v_mfma_f32_16x16x32_bf16 v[100:103], a[212:215], a[132:135], v[100:103]
    ds_read_b64_tr_b16 a[204:205], v240 offset:72
    v_fma_f32 v121, v121, s20, v251
    v_mfma_f32_16x16x32_bf16 v[108:111], a[212:215], a[140:143], v[108:111]
    ds_read_b64_tr_b16 a[206:207], v240 offset:584
    v_fma_f32 v98, v98, s20, v248
    v_mfma_f32_16x16x32_bf16 v[116:119], a[212:215], a[180:183], v[116:119]
    s_waitcnt vmcnt(20)
    s_barrier
    v_mfma_f32_16x16x32_bf16 v[124:127], a[212:215], a[188:191], v[124:127]
    v_fma_f32 v99, v99, s20, v248
    s_cmp_eq_u32 s24, 1
    s_cbranch_scc1 L_tail
    s_waitcnt lgkmcnt(4)
    v_mfma_f32_16x16x32_bf16 a[0:3], a[192:195], v[128:131], a[0:3]
    ds_read_b64_tr_b16 a[208:209], v240 offset:1024
    v_fma_f32 v106, v106, s20, v249
    v_mfma_f32_16x16x32_bf16 a[8:11], a[192:195], v[136:139], a[8:11]
    ds_read_b64_tr_b16 a[210:211], v240 offset:1536
    s_add_u32 m0, s28, 0
    v_mfma_f32_16x16x32_bf16 a[48:51], a[192:195], v[144:147], a[48:51]
    buffer_load_dwordx4 v242, s[48:51], s25 offen nt lds
    v_mfma_f32_16x16x32_bf16 a[56:59], a[192:195], v[152:155], a[56:59]
    v_exp_f32 v113, v113
    v_mfma_f32_16x16x32_bf16 a[4:7], a[196:199], v[128:131], a[4:7]
    ds_read_b64_tr_b16 a[212:213], v240 offset:1032
    v_cvt_pk_bf16_f32 v112, v112, v113
    v_mfma_f32_16x16x32_bf16 a[12:15], a[196:199], v[136:139], a[12:15]
    ds_read_b64_tr_b16 a[214:215], v240 offset:1544
    v_fma_f32 v107, v107, s20, v249
    v_mfma_f32_16x16x32_bf16 a[52:55], a[196:199], v[144:147], a[52:55]
    v_exp_f32 v120, v120
    v_mfma_f32_16x16x32_bf16 a[60:63], a[196:199], v[152:155], a[60:63]
    v_fma_f32 v114, v114, s20, v250
    s_waitcnt lgkmcnt(4)
    v_mfma_f32_16x16x32_bf16 a[16:19], a[200:203], v[128:131], a[16:19]
    ds_read_b64_tr_b16 a[192:193], v240 offset:1088
    v_fma_f32 v115, v115, s20, v250
    v_mfma_f32_16x16x32_bf16 a[24:27], a[200:203], v[136:139], a[24:27]
    ds_read_b64_tr_b16 a[194:195], v240 offset:1600
    v_fma_f32 v122, v122, s20, v251
    v_mfma_f32_16x16x32_bf16 a[64:67], a[200:203], v[144:147], a[64:67]
    v_exp_f32 v121, v121
    v_mfma_f32_16x16x32_bf16 a[72:75], a[200:203], v[152:155], a[72:75]
    v_exp_f32 v98, v98
    v_mfma_f32_16x16x32_bf16 a[20:23], a[204:207], v[128:131], a[20:23]
    ds_read_b64_tr_b16 a[196:197], v240 offset:1096
    v_cvt_pk_bf16_f32 v120, v120, v121
    v_mfma_f32_16x16x32_bf16 a[28:31], a[204:207], v[136:139], a[28:31]
    ds_read_b64_tr_b16 a[198:199], v240 offset:1608
    v_fma_f32 v123, v123, s20, v251
    v_mfma_f32_16x16x32_bf16 a[68:71], a[204:207], v[144:147], a[68:71]
    v_exp_f32 v99, v99
    v_mfma_f32_16x16x32_bf16 a[76:79], a[204:207], v[152:155], a[76:79]
    v_cvt_pk_bf16_f32 v97, v98, v99
    s_waitcnt lgkmcnt(4)
    v_mfma_f32_16x16x32_bf16 a[32:35], a[208:211], v[128:131], a[32:35]
    ds_read_b64_tr_b16 a[200:201], v240 offset:2048
    v_fma_f32 v100, v100, s20, v248
    v_mfma_f32_16x16x32_bf16 a[40:43], a[208:211], v[136:139], a[40:43]
    ds_read_b64_tr_b16 a[202:203], v240 offset:2560
    s_add_u32 m0, s28, 896
    v_mfma_f32_16x16x32_bf16 a[80:83], a[208:211], v[144:147], a[80:83]
    buffer_load_dwordx4 v242, s[48:51], s25 offen offset:128 nt lds
    v_mfma_f32_16x16x32_bf16 a[88:91], a[208:211], v[152:155], a[88:91]
    v_exp_f32 v106, v106
    v_mfma_f32_16x16x32_bf16 a[36:39], a[212:215], v[128:131], a[36:39]
    ds_read_b64_tr_b16 a[204:205], v240 offset:2056
    v_fma_f32 v101, v101, s20, v248
    v_mfma_f32_16x16x32_bf16 a[44:47], a[212:215], v[136:139], a[44:47]
    ds_read_b64_tr_b16 a[206:207], v240 offset:2568
    v_fma_f32 v102, v102, s20, v248
    v_mfma_f32_16x16x32_bf16 a[84:87], a[212:215], v[144:147], a[84:87]
    v_exp_f32 v107, v107
    v_mfma_f32_16x16x32_bf16 a[92:95], a[212:215], v[152:155], a[92:95]
    v_cvt_pk_bf16_f32 v105, v106, v107
    s_waitcnt lgkmcnt(4)
    v_mfma_f32_16x16x32_bf16 v[0:3], a[192:195], v[128:131], v[0:3]
    ds_read_b64_tr_b16 a[208:209], v240 offset:2112
    v_fma_f32 v103, v103, s20, v248
    v_mfma_f32_16x16x32_bf16 v[8:11], a[192:195], v[136:139], v[8:11]
    ds_read_b64_tr_b16 a[210:211], v240 offset:2624
    v_fma_f32 v108, v108, s20, v249
    v_mfma_f32_16x16x32_bf16 v[48:51], a[192:195], v[144:147], v[48:51]
    buffer_store_dwordx4 a[248:251], v243, s[16:19], s45 offen offset:256 nt
    v_mfma_f32_16x16x32_bf16 v[56:59], a[192:195], v[152:155], v[56:59]
    v_exp_f32 v114, v114
    v_mfma_f32_16x16x32_bf16 v[4:7], a[196:199], v[128:131], v[4:7]
    ds_read_b64_tr_b16 a[212:213], v240 offset:2120
    v_fma_f32 v109, v109, s20, v249
    v_mfma_f32_16x16x32_bf16 v[12:15], a[196:199], v[136:139], v[12:15]
    ds_read_b64_tr_b16 a[214:215], v240 offset:2632
    v_fma_f32 v110, v110, s20, v249
    v_mfma_f32_16x16x32_bf16 v[52:55], a[196:199], v[144:147], v[52:55]
    v_exp_f32 v115, v115
    v_mfma_f32_16x16x32_bf16 v[60:63], a[196:199], v[152:155], v[60:63]
    v_cvt_pk_bf16_f32 v113, v114, v115
    s_waitcnt lgkmcnt(4)
    v_mfma_f32_16x16x32_bf16 v[16:19], a[200:203], v[128:131], v[16:19]
    ds_read_b128 a[192:195], v236 offset:36864
    v_fma_f32 v111, v111, s20, v249
    v_mfma_f32_16x16x32_bf16 v[24:27], a[200:203], v[136:139], v[24:27]
    s_add_u32 m0, s28, 1792
    v_fma_f32 v116, v116, s20, v250
    v_mfma_f32_16x16x32_bf16 v[64:67], a[200:203], v[144:147], v[64:67]
    buffer_load_dwordx4 v242, s[48:51], s25 offen offset:256 nt lds
    v_mfma_f32_16x16x32_bf16 v[72:75], a[200:203], v[152:155], v[72:75]
    v_exp_f32 v122, v122
    v_mfma_f32_16x16x32_bf16 v[20:23], a[204:207], v[128:131], v[20:23]
    ds_read_b128 a[196:199], v237 offset:36864
    v_fma_f32 v117, v117, s20, v250
    v_mfma_f32_16x16x32_bf16 v[28:31], a[204:207], v[136:139], v[28:31]
    v_exp_f32 v123, v123
    v_mfma_f32_16x16x32_bf16 v[68:71], a[204:207], v[144:147], v[68:71]
    v_exp_f32 v100, v100
    v_mfma_f32_16x16x32_bf16 v[76:79], a[204:207], v[152:155], v[76:79]
    v_cvt_pk_bf16_f32 v121, v122, v123
    s_waitcnt lgkmcnt(2)
    v_mfma_f32_16x16x32_bf16 v[32:35], a[208:211], v[128:131], v[32:35]
    ds_read_b128 a[200:203], v236 offset:37888
    v_fma_f32 v118, v118, s20, v250
    v_mfma_f32_16x16x32_bf16 v[40:43], a[208:211], v[136:139], v[40:43]
    v_exp_f32 v101, v101
    v_mfma_f32_16x16x32_bf16 v[80:83], a[208:211], v[144:147], v[80:83]
    v_exp_f32 v102, v102
    v_mfma_f32_16x16x32_bf16 v[88:91], a[208:211], v[152:155], v[88:91]
    s_add_u32 s25, s26, 12288
    v_cvt_pk_bf16_f32 v98, v100, v101
    v_mfma_f32_16x16x32_bf16 v[36:39], a[212:215], v[128:131], v[36:39]
    ds_read_b128 a[204:207], v237 offset:37888
    v_fma_f32 v119, v119, s20, v250
    v_mfma_f32_16x16x32_bf16 v[44:47], a[212:215], v[136:139], v[44:47]
    v_exp_f32 v103, v103
    v_mfma_f32_16x16x32_bf16 v[84:87], a[212:215], v[144:147], v[84:87]
    v_exp_f32 v108, v108
    v_mfma_f32_16x16x32_bf16 v[92:95], a[212:215], v[152:155], v[92:95]
    v_cvt_pk_bf16_f32 v99, v102, v103
    s_waitcnt lgkmcnt(2)
    v_mfma_f32_16x16x32_bf16 v[128:131], a[192:195], a[96:99], 0
    ds_read_b128 a[208:211], v236 offset:38912
    v_fma_f32 v124, v124, s20, v251
    v_mfma_f32_16x16x32_bf16 a[232:235], a[224:227], v[96:99], a[232:235]
    v_exp_f32 v109, v109
    v_mfma_f32_16x16x32_bf16 v[136:139], a[192:195], a[104:107], 0
    s_add_u32 m0, s27, 24576
    v_cvt_pk_bf16_f32 v106, v108, v109
    v_mfma_f32_16x16x32_bf16 v[144:147], a[192:195], a[144:147], 0
    buffer_load_dwordx4 v241, s[8:11], s26 offen nt lds
    v_mfma_f32_16x16x32_bf16 v[152:155], a[192:195], a[152:155], 0
    v_exp_f32 v110, v110
    v_mfma_f32_16x16x32_bf16 v[128:131], a[196:199], a[100:103], v[128:131]
    ds_read_b128 a[212:215], v237 offset:38912
    v_fma_f32 v125, v125, s20, v251
    v_mfma_f32_16x16x32_bf16 v[136:139], a[196:199], a[108:111], v[136:139]
    v_exp_f32 v111, v111
    v_mfma_f32_16x16x32_bf16 v[144:147], a[196:199], a[148:151], v[144:147]
    v_exp_f32 v116, v116
    v_mfma_f32_16x16x32_bf16 v[152:155], a[196:199], a[156:159], v[152:155]
    v_cvt_pk_bf16_f32 v107, v110, v111
    s_waitcnt lgkmcnt(2)
    v_mfma_f32_16x16x32_bf16 v[128:131], a[200:203], a[112:115], v[128:131]
    ds_read_b128 a[192:195], v236 offset:43008
    v_fma_f32 v126, v126, s20, v251
    v_mfma_f32_16x16x32_bf16 a[232:235], a[228:231], v[104:107], a[232:235]
    v_exp_f32 v117, v117
    v_mfma_f32_16x16x32_bf16 v[136:139], a[200:203], a[120:123], v[136:139]
    v_exp_f32 v118, v118
    v_mfma_f32_16x16x32_bf16 v[144:147], a[200:203], a[160:163], v[144:147]
    buffer_store_dwordx4 a[240:243], v243, s[16:19], s47 offen offset:256 nt
    v_mfma_f32_16x16x32_bf16 v[152:155], a[200:203], a[168:171], v[152:155]
    v_exp_f32 v119, v119
    v_mfma_f32_16x16x32_bf16 v[128:131], a[204:207], a[116:119], v[128:131]
    ds_read_b128 a[196:199], v237 offset:43008
    v_cvt_pk_bf16_f32 v114, v116, v117
    v_mfma_f32_16x16x32_bf16 v[136:139], a[204:207], a[124:127], v[136:139]
    v_exp_f32 v124, v124
    v_mfma_f32_16x16x32_bf16 v[144:147], a[204:207], a[164:167], v[144:147]
    v_exp_f32 v125, v125
    v_mfma_f32_16x16x32_bf16 v[152:155], a[204:207], a[172:175], v[152:155]
    v_fma_f32 v127, v127, s20, v251
    s_waitcnt lgkmcnt(2)
    v_mfma_f32_16x16x32_bf16 v[128:131], a[208:211], a[128:131], v[128:131]
    ds_read_b128 a[200:203], v236 offset:44032
    v_cvt_pk_bf16_f32 v115, v118, v119
    v_mfma_f32_16x16x32_bf16 v[136:139], a[208:211], a[136:139], v[136:139]
    s_add_u32 m0, s27, 25472
    v_cvt_pk_bf16_f32 v122, v124, v125
    v_mfma_f32_16x16x32_bf16 a[236:239], a[224:227], v[112:115], a[236:239]
    v_exp_f32 v126, v126
    v_mfma_f32_16x16x32_bf16 v[144:147], a[208:211], a[176:179], v[144:147]
    buffer_load_dwordx4 v241, s[8:11], s26 offen offset:128 nt lds
    v_mfma_f32_16x16x32_bf16 v[152:155], a[208:211], a[184:187], v[152:155]
    v_exp_f32 v127, v127
    v_mfma_f32_16x16x32_bf16 v[128:131], a[212:215], a[132:135], v[128:131]
    ds_read_b128 a[204:207], v237 offset:44032
    v_cvt_pk_bf16_f32 v123, v126, v127
    v_mfma_f32_16x16x32_bf16 v[136:139], a[212:215], a[140:143], v[136:139]
    s_cmp_eq_u32 s29, s30
    s_cselect_b32 s35, -49664, s37
    v_mfma_f32_16x16x32_bf16 a[236:239], a[228:231], v[120:123], a[236:239]
    v_mfma_f32_16x16x32_bf16 v[144:147], a[212:215], a[180:183], v[144:147]
    v_mfma_f32_16x16x32_bf16 v[152:155], a[212:215], a[188:191], v[152:155]
    s_add_u32 s28, s29, s35
    s_waitcnt lgkmcnt(2)
    v_mfma_f32_16x16x32_bf16 v[132:135], a[192:195], a[96:99], 0
    ds_read_b128 a[208:211], v236 offset:45056
    v_add_u32 v240, s35, v240
    v_mfma_f32_16x16x32_bf16 v[140:143], a[192:195], a[104:107], 0
    v_mfma_f32_16x16x32_bf16 v[148:151], a[192:195], a[144:147], 0
    v_mfma_f32_16x16x32_bf16 v[156:159], a[192:195], a[152:155], 0
    v_fma_f32 v128, v128, s20, v248
    v_fma_f32 v129, v129, s20, v248
    v_mfma_f32_16x16x32_bf16 v[132:135], a[196:199], a[100:103], v[132:135]
    ds_read_b128 a[212:215], v237 offset:45056
    v_fma_f32 v136, v136, s20, v249
    v_accvgpr_write_b32 a96, v160
    v_mfma_f32_16x16x32_bf16 v[140:143], a[196:199], a[108:111], v[140:143]
    v_exp_f32 v128, v128
    v_accvgpr_write_b32 a97, v161
    v_mfma_f32_16x16x32_bf16 v[148:151], a[196:199], a[148:151], v[148:151]
    v_exp_f32 v129, v129
    v_accvgpr_write_b32 a98, v162
    v_mfma_f32_16x16x32_bf16 v[156:159], a[196:199], a[156:159], v[156:159]
    v_fma_f32 v137, v137, s20, v249
    s_waitcnt lgkmcnt(2)
    v_mfma_f32_16x16x32_bf16 v[132:135], a[200:203], a[112:115], v[132:135]
    ds_read_b64_tr_b16 a[192:193], v240
    v_fma_f32 v144, v144, s20, v250
    v_accvgpr_write_b32 a99, v163
    v_mfma_f32_16x16x32_bf16 v[140:143], a[200:203], a[120:123], v[140:143]
    ds_read_b64_tr_b16 a[194:195], v240 offset:512
    s_add_u32 m0, s27, 26368
    v_accvgpr_write_b32 a104, v168
    v_mfma_f32_16x16x32_bf16 v[148:151], a[200:203], a[160:163], v[148:151]
    buffer_load_dwordx4 v241, s[8:11], s26 offen offset:256 nt lds
    v_mfma_f32_16x16x32_bf16 v[156:159], a[200:203], a[168:171], v[156:159]
    v_exp_f32 v136, v136
    v_accvgpr_write_b32 a105, v169
    v_mfma_f32_16x16x32_bf16 v[132:135], a[204:207], a[116:119], v[132:135]
    ds_read_b64_tr_b16 a[196:197], v240 offset:8
    v_fma_f32 v145, v145, s20, v250
    v_accvgpr_write_b32 a106, v170
    v_mfma_f32_16x16x32_bf16 v[140:143], a[204:207], a[124:127], v[140:143]
    ds_read_b64_tr_b16 a[198:199], v240 offset:520
    v_cvt_pk_bf16_f32 v128, v128, v129
    v_accvgpr_write_b32 a107, v171
    v_mfma_f32_16x16x32_bf16 v[148:151], a[204:207], a[164:167], v[148:151]
    s_add_u32 s40, s40, 25165824
    v_exp_f32 v137, v137
    v_mfma_f32_16x16x32_bf16 v[156:159], a[204:207], a[172:175], v[156:159]
    s_add_u32 s41, s41, 25165824
    v_accvgpr_write_b32 a144, v192
    s_waitcnt lgkmcnt(4)
    v_mfma_f32_16x16x32_bf16 v[132:135], a[208:211], a[128:131], v[132:135]
    ds_read_b64_tr_b16 a[200:201], v240 offset:64
    v_fma_f32 v152, v152, s20, v251
    v_accvgpr_write_b32 a145, v193
    v_mfma_f32_16x16x32_bf16 v[140:143], a[208:211], a[136:139], v[140:143]
    ds_read_b64_tr_b16 a[202:203], v240 offset:576
    v_cvt_pk_bf16_f32 v136, v136, v137
    v_mfma_f32_16x16x32_bf16 v[148:151], a[208:211], a[176:179], v[148:151]
    s_add_u32 s42, s42, 25165824
    v_fma_f32 v153, v153, s20, v251
    v_accvgpr_write_b32 a146, v194
    v_mfma_f32_16x16x32_bf16 v[156:159], a[208:211], a[184:187], v[156:159]
    s_add_u32 s43, s43, 25165824
    v_fma_f32 v130, v130, s20, v248
    v_accvgpr_write_b32 a147, v195
    v_mfma_f32_16x16x32_bf16 v[132:135], a[212:215], a[132:135], v[132:135]
    ds_read_b64_tr_b16 a[204:205], v240 offset:72
    v_fma_f32 v131, v131, s20, v248
    v_accvgpr_write_b32 a152, v200
    v_mfma_f32_16x16x32_bf16 v[140:143], a[212:215], a[140:143], v[140:143]
    ds_read_b64_tr_b16 a[206:207], v240 offset:584
    v_fma_f32 v138, v138, s20, v249
    v_accvgpr_write_b32 a153, v201
    v_mfma_f32_16x16x32_bf16 v[148:151], a[212:215], a[180:183], v[148:151]
    s_waitcnt vmcnt(19)
    s_barrier
    v_accvgpr_write_b32 a154, v202
    v_mfma_f32_16x16x32_bf16 v[156:159], a[212:215], a[188:191], v[156:159]
    v_fma_f32 v139, v139, s20, v249
    v_accvgpr_write_b32 a155, v203
    s_waitcnt lgkmcnt(4)
    v_mfma_f32_16x16x32_bf16 a[0:3], a[192:195], v[96:99], a[0:3]
    ds_read_b64_tr_b16 a[208:209], v240 offset:1024
    v_fma_f32 v146, v146, s20, v250
    v_accvgpr_write_b32 a100, v164
    v_mfma_f32_16x16x32_bf16 a[8:11], a[192:195], v[104:107], a[8:11]
    ds_read_b64_tr_b16 a[210:211], v240 offset:1536
    s_add_u32 m0, s29, 0
    v_mfma_f32_16x16x32_bf16 a[48:51], a[192:195], v[112:115], a[48:51]
    buffer_load_dwordx4 v242, s[48:51], s26 offen nt lds
    ds_read_b128 a[128:131], v238
    v_mfma_f32_16x16x32_bf16 a[56:59], a[192:195], v[120:123], a[56:59]
    ds_read_b128 a[132:135], v239
    v_fma_f32 v147, v147, s20, v250
    v_accvgpr_write_b32 a101, v165
    v_mfma_f32_16x16x32_bf16 a[4:7], a[196:199], v[96:99], a[4:7]
    ds_read_b64_tr_b16 a[212:213], v240 offset:1032
    v_fma_f32 v154, v154, s20, v251
    v_accvgpr_write_b32 a102, v166
    v_mfma_f32_16x16x32_bf16 a[12:15], a[196:199], v[104:107], a[12:15]
    ds_read_b64_tr_b16 a[214:215], v240 offset:1544
    v_fma_f32 v155, v155, s20, v251
    v_accvgpr_write_b32 a103, v167
    v_mfma_f32_16x16x32_bf16 a[52:55], a[196:199], v[112:115], a[52:55]
    s_waitcnt vmcnt(19)
    ds_read_b128 a[136:139], v238 offset:2048
    v_exp_f32 v144, v144
    v_mfma_f32_16x16x32_bf16 a[60:63], a[196:199], v[120:123], a[60:63]
    ds_read_b128 a[140:143], v239 offset:2048
    v_accvgpr_write_b32 a108, v172
    s_waitcnt lgkmcnt(8)
    v_mfma_f32_16x16x32_bf16 a[16:19], a[200:203], v[96:99], a[16:19]
    ds_read_b64_tr_b16 a[192:193], v240 offset:1088
    v_fma_f32 v132, v132, s20, v248
    v_accvgpr_write_b32 a109, v173
    v_mfma_f32_16x16x32_bf16 a[24:27], a[200:203], v[104:107], a[24:27]
    ds_read_b64_tr_b16 a[194:195], v240 offset:1600
    v_fma_f32 v133, v133, s20, v248
    v_accvgpr_write_b32 a110, v174
    v_mfma_f32_16x16x32_bf16 a[64:67], a[200:203], v[112:115], a[64:67]
    ds_read_b128 a[176:179], v238 offset:4096
    v_fma_f32 v134, v134, s20, v248
    v_accvgpr_write_b32 a111, v175
    v_mfma_f32_16x16x32_bf16 a[72:75], a[200:203], v[120:123], a[72:75]
    ds_read_b128 a[180:183], v239 offset:4096
    v_fma_f32 v135, v135, s20, v248
    v_mfma_f32_16x16x32_bf16 a[20:23], a[204:207], v[96:99], a[20:23]
    ds_read_b64_tr_b16 a[196:197], v240 offset:1096
    v_fma_f32 v140, v140, s20, v249
    v_accvgpr_write_b32 a148, v196
    v_mfma_f32_16x16x32_bf16 a[28:31], a[204:207], v[104:107], a[28:31]
    ds_read_b64_tr_b16 a[198:199], v240 offset:1608
    v_fma_f32 v141, v141, s20, v249
    v_accvgpr_write_b32 a149, v197
    v_mfma_f32_16x16x32_bf16 a[68:71], a[204:207], v[112:115], a[68:71]
    s_waitcnt vmcnt(16)
    ds_read_b128 a[184:187], v238 offset:6144
    v_fma_f32 v142, v142, s20, v249
    v_accvgpr_write_b32 a150, v198
    v_mfma_f32_16x16x32_bf16 a[76:79], a[204:207], v[120:123], a[76:79]
    ds_read_b128 a[188:191], v239 offset:6144
    v_accvgpr_write_b32 a151, v199
    s_waitcnt lgkmcnt(10)
    v_mfma_f32_16x16x32_bf16 a[32:35], a[208:211], v[96:99], a[32:35]
    ds_read_b64_tr_b16 a[200:201], v240 offset:2048
    v_fma_f32 v143, v143, s20, v249
    v_accvgpr_write_b32 a156, v204
    v_mfma_f32_16x16x32_bf16 a[40:43], a[208:211], v[104:107], a[40:43]
    ds_read_b64_tr_b16 a[202:203], v240 offset:2560
    s_add_u32 m0, s29, 896
    v_accvgpr_write_b32 a157, v205
    v_mfma_f32_16x16x32_bf16 a[80:83], a[208:211], v[112:115], a[80:83]
    buffer_load_dwordx4 v242, s[48:51], s26 offen offset:128 nt lds
    v_mfma_f32_16x16x32_bf16 a[88:91], a[208:211], v[120:123], a[88:91]
    v_exp_f32 v145, v145
    v_mfma_f32_16x16x32_bf16 a[36:39], a[212:215], v[96:99], a[36:39]
    ds_read_b64_tr_b16 a[204:205], v240 offset:2056
    v_cvt_pk_bf16_f32 v144, v144, v145
    v_accvgpr_write_b32 a158, v206
    v_mfma_f32_16x16x32_bf16 a[44:47], a[212:215], v[104:107], a[44:47]
    ds_read_b64_tr_b16 a[206:207], v240 offset:2568
    v_fma_f32 v148, v148, s20, v250
    v_accvgpr_write_b32 a159, v207
    v_mfma_f32_16x16x32_bf16 a[84:87], a[212:215], v[112:115], a[84:87]
    v_exp_f32 v152, v152
    v_accvgpr_write_b32 a112, v176
    v_mfma_f32_16x16x32_bf16 a[92:95], a[212:215], v[120:123], a[92:95]
    v_fma_f32 v149, v149, s20, v250
    v_accvgpr_write_b32 a113, v177
    s_waitcnt lgkmcnt(6)
    v_mfma_f32_16x16x32_bf16 v[0:3], a[192:195], v[96:99], v[0:3]
    ds_read_b64_tr_b16 a[208:209], v240 offset:2112
    v_exp_f32 v153, v153
    v_mfma_f32_16x16x32_bf16 v[8:11], a[192:195], v[104:107], v[8:11]
    ds_read_b64_tr_b16 a[210:211], v240 offset:2624
    v_cvt_pk_bf16_f32 v152, v152, v153
    v_accvgpr_write_b32 a114, v178
    v_mfma_f32_16x16x32_bf16 v[48:51], a[192:195], v[112:115], v[48:51]
    v_exp_f32 v130, v130
    v_accvgpr_write_b32 a115, v179
    v_mfma_f32_16x16x32_bf16 v[56:59], a[192:195], v[120:123], v[56:59]
    v_exp_f32 v131, v131
    v_accvgpr_write_b32 a120, v184
    v_mfma_f32_16x16x32_bf16 v[4:7], a[196:199], v[96:99], v[4:7]
    ds_read_b64_tr_b16 a[212:213], v240 offset:2120
    v_cvt_pk_bf16_f32 v129, v130, v131
    v_mfma_f32_16x16x32_bf16 v[12:15], a[196:199], v[104:107], v[12:15]
    ds_read_b64_tr_b16 a[214:215], v240 offset:2632
    v_fma_f32 v150, v150, s20, v250
    v_accvgpr_write_b32 a121, v185
    v_mfma_f32_16x16x32_bf16 v[52:55], a[196:199], v[112:115], v[52:55]
    v_exp_f32 v138, v138
    v_accvgpr_write_b32 a122, v186
    v_mfma_f32_16x16x32_bf16 v[60:63], a[196:199], v[120:123], v[60:63]
    v_fma_f32 v151, v151, s20, v250
    v_accvgpr_write_b32 a123, v187
    s_waitcnt lgkmcnt(4)
    v_mfma_f32_16x16x32_bf16 v[16:19], a[200:203], v[96:99], v[16:19]
    ds_read_b128 a[192:195], v236
    v_fma_f32 v156, v156, s20, v251
    v_accvgpr_write_b32 a160, v208
    v_mfma_f32_16x16x32_bf16 v[24:27], a[200:203], v[104:107], v[24:27]
    s_add_u32 m0, s29, 1792
    v_fma_f32 v157, v157, s20, v251
    v_accvgpr_write_b32 a161, v209
    v_mfma_f32_16x16x32_bf16 v[64:67], a[200:203], v[112:115], v[64:67]
    buffer_load_dwordx4 v242, s[48:51], s26 offen offset:256 nt lds
    v_mfma_f32_16x16x32_bf16 v[72:75], a[200:203], v[120:123], v[72:75]
    v_exp_f32 v139, v139
    v_accvgpr_write_b32 a162, v210
    v_mfma_f32_16x16x32_bf16 v[20:23], a[204:207], v[96:99], v[20:23]
    ds_read_b128 a[196:199], v237
    v_cvt_pk_bf16_f32 v137, v138, v139
    v_accvgpr_write_b32 a163, v211
    v_mfma_f32_16x16x32_bf16 v[28:31], a[204:207], v[104:107], v[28:31]
    v_exp_f32 v146, v146
    v_mfma_f32_16x16x32_bf16 v[68:71], a[204:207], v[112:115], v[68:71]
    v_exp_f32 v147, v147
    v_accvgpr_write_b32 a168, v216
    v_mfma_f32_16x16x32_bf16 v[76:79], a[204:207], v[120:123], v[76:79]
    v_cvt_pk_bf16_f32 v145, v146, v147
    v_accvgpr_write_b32 a169, v217
    s_waitcnt lgkmcnt(2)
    v_mfma_f32_16x16x32_bf16 v[32:35], a[208:211], v[96:99], v[32:35]
    ds_read_b128 a[200:203], v236 offset:1024
    v_fma_f32 v158, v158, s20, v251
    v_accvgpr_write_b32 a170, v218
    v_mfma_f32_16x16x32_bf16 v[40:43], a[208:211], v[104:107], v[40:43]
    v_exp_f32 v154, v154
    v_accvgpr_write_b32 a171, v219
    v_mfma_f32_16x16x32_bf16 v[80:83], a[208:211], v[112:115], v[80:83]
    v_exp_f32 v155, v155
    v_accvgpr_write_b32 a116, v180
    v_mfma_f32_16x16x32_bf16 v[88:91], a[208:211], v[120:123], v[88:91]
    s_add_u32 s26, s25, 12288
    v_cvt_pk_bf16_f32 v153, v154, v155
    v_accvgpr_write_b32 a117, v181
    v_mfma_f32_16x16x32_bf16 v[36:39], a[212:215], v[96:99], v[36:39]
    ds_read_b128 a[204:207], v237 offset:1024
    v_fma_f32 v159, v159, s20, v251
    v_accvgpr_write_b32 a118, v182
    v_mfma_f32_16x16x32_bf16 v[44:47], a[212:215], v[104:107], v[44:47]
    v_exp_f32 v132, v132
    v_mfma_f32_16x16x32_bf16 v[84:87], a[212:215], v[112:115], v[84:87]
    v_exp_f32 v133, v133
    v_accvgpr_write_b32 a119, v183
    v_mfma_f32_16x16x32_bf16 v[92:95], a[212:215], v[120:123], v[92:95]
    v_exp_f32 v134, v134
    s_waitcnt lgkmcnt(2)
    v_mfma_f32_16x16x32_bf16 v[96:99], a[192:195], a[96:99], 0
    ds_read_b128 a[208:211], v236 offset:2048
    v_cvt_pk_bf16_f32 v130, v132, v133
    v_accvgpr_write_b32 a124, v188
    v_mfma_f32_16x16x32_bf16 v[104:107], a[192:195], a[104:107], 0
    s_add_u32 m0, s27, 36864
    v_accvgpr_write_b32 a125, v189
    v_accvgpr_write_b32 a126, v190
    v_mfma_f32_16x16x32_bf16 v[112:115], a[192:195], a[144:147], 0
    buffer_load_dwordx4 v241, s[8:11], s25 offen nt lds
    v_mfma_f32_16x16x32_bf16 v[120:123], a[192:195], a[152:155], 0
    v_exp_f32 v135, v135
    v_accvgpr_write_b32 a127, v191
    v_mfma_f32_16x16x32_bf16 v[96:99], a[196:199], a[100:103], v[96:99]
    ds_read_b128 a[212:215], v237 offset:2048
    v_cvt_pk_bf16_f32 v131, v134, v135
    v_accvgpr_write_b32 a164, v212
    v_mfma_f32_16x16x32_bf16 v[104:107], a[196:199], a[108:111], v[104:107]
    v_exp_f32 v140, v140
    v_mfma_f32_16x16x32_bf16 a[232:235], a[224:227], v[128:131], a[232:235]
    v_exp_f32 v141, v141
    v_accvgpr_write_b32 a165, v213
    v_mfma_f32_16x16x32_bf16 v[112:115], a[196:199], a[148:151], v[112:115]
    v_exp_f32 v142, v142
    v_accvgpr_write_b32 a166, v214
    v_mfma_f32_16x16x32_bf16 v[120:123], a[196:199], a[156:159], v[120:123]
    v_cvt_pk_bf16_f32 v138, v140, v141
    s_waitcnt lgkmcnt(2)
    v_mfma_f32_16x16x32_bf16 v[96:99], a[200:203], a[112:115], v[96:99]
    ds_read_b128 a[192:195], v236 offset:6144
    v_accvgpr_write_b32 a167, v215
    v_accvgpr_write_b32 a172, v220
    v_mfma_f32_16x16x32_bf16 v[104:107], a[200:203], a[120:123], v[104:107]
    s_add_u32 m0, s38, 0
    v_accvgpr_write_b32 a173, v221
    v_accvgpr_write_b32 a174, v222
    v_mfma_f32_16x16x32_bf16 v[112:115], a[200:203], a[160:163], v[112:115]
    buffer_load_dwordx4 v244, s[4:7], s40 offen nt lds
    v_mfma_f32_16x16x32_bf16 v[120:123], a[200:203], a[168:171], v[120:123]
    v_exp_f32 v143, v143
    v_accvgpr_write_b32 a175, v223
    v_mfma_f32_16x16x32_bf16 v[96:99], a[204:207], a[116:119], v[96:99]
    ds_read_b128 a[196:199], v237 offset:6144
    v_cvt_pk_bf16_f32 v139, v142, v143
    v_mfma_f32_16x16x32_bf16 v[104:107], a[204:207], a[124:127], v[104:107]
    v_exp_f32 v148, v148
    v_mfma_f32_16x16x32_bf16 a[232:235], a[228:231], v[136:139], a[232:235]
    v_exp_f32 v149, v149
    v_mfma_f32_16x16x32_bf16 v[112:115], a[204:207], a[164:167], v[112:115]
    v_exp_f32 v150, v150
    v_mfma_f32_16x16x32_bf16 v[120:123], a[204:207], a[172:175], v[120:123]
    v_cvt_pk_bf16_f32 v146, v148, v149
    s_waitcnt lgkmcnt(2)
    v_mfma_f32_16x16x32_bf16 v[96:99], a[208:211], a[128:131], v[96:99]
    ds_read_b128 a[200:203], v236 offset:7168
    v_mfma_f32_16x16x32_bf16 v[104:107], a[208:211], a[136:139], v[104:107]
    s_add_u32 m0, s27, 37760
    v_mfma_f32_16x16x32_bf16 v[112:115], a[208:211], a[176:179], v[112:115]
    buffer_load_dwordx4 v241, s[8:11], s25 offen offset:128 nt lds
    v_mfma_f32_16x16x32_bf16 v[120:123], a[208:211], a[184:187], v[120:123]
    v_exp_f32 v151, v151
    v_mfma_f32_16x16x32_bf16 v[96:99], a[212:215], a[132:135], v[96:99]
    ds_read_b128 a[204:207], v237 offset:7168
    v_cvt_pk_bf16_f32 v147, v150, v151
    v_mfma_f32_16x16x32_bf16 v[104:107], a[212:215], a[140:143], v[104:107]
    s_cmp_eq_u32 s28, s30
    s_cselect_b32 s35, -49664, s37
    v_mfma_f32_16x16x32_bf16 a[236:239], a[224:227], v[144:147], a[236:239]
    v_exp_f32 v156, v156
    v_mfma_f32_16x16x32_bf16 v[112:115], a[212:215], a[180:183], v[112:115]
    s_mov_b32 s58, 0x80000000
    v_exp_f32 v157, v157
    v_mfma_f32_16x16x32_bf16 v[120:123], a[212:215], a[188:191], v[120:123]
    s_add_u32 s29, s28, s35
    s_waitcnt lgkmcnt(2)
    v_mfma_f32_16x16x32_bf16 v[100:103], a[192:195], a[96:99], 0
    ds_read_b128 a[208:211], v236 offset:8192
    v_add_u32 v240, s35, v240
    v_mfma_f32_16x16x32_bf16 v[108:111], a[192:195], a[104:107], 0
    v_exp_f32 v158, v158
    v_mfma_f32_16x16x32_bf16 v[116:119], a[192:195], a[144:147], 0
    s_add_u32 s44, s40, -50331648
    v_cvt_pk_bf16_f32 v154, v156, v157
    v_mfma_f32_16x16x32_bf16 v[124:127], a[192:195], a[152:155], 0
    s_add_u32 s45, s41, -50331648
    v_mfma_f32_16x16x32_bf16 v[100:103], a[196:199], a[100:103], v[100:103]
    ds_read_b128 a[212:215], v237 offset:8192
    v_mfma_f32_16x16x32_bf16 v[108:111], a[196:199], a[108:111], v[108:111]
    v_exp_f32 v159, v159
    v_mfma_f32_16x16x32_bf16 v[116:119], a[196:199], a[148:151], v[116:119]
    s_add_u32 s46, s42, -50331648
    v_cvt_pk_bf16_f32 v155, v158, v159
    v_mfma_f32_16x16x32_bf16 v[124:127], a[196:199], a[156:159], v[124:127]
    s_add_u32 s47, s43, -50331648
    s_waitcnt lgkmcnt(2)
    v_mfma_f32_16x16x32_bf16 v[100:103], a[200:203], a[112:115], v[100:103]
    ds_read_b64_tr_b16 a[192:193], v240
    v_mfma_f32_16x16x32_bf16 v[108:111], a[200:203], a[120:123], v[108:111]
    ds_read_b64_tr_b16 a[194:195], v240 offset:512
    s_add_u32 m0, s27, 38656
    v_mfma_f32_16x16x32_bf16 a[236:239], a[228:231], v[152:155], a[236:239]
    v_mfma_f32_16x16x32_bf16 v[116:119], a[200:203], a[160:163], v[116:119]
    buffer_load_dwordx4 v241, s[8:11], s25 offen offset:256 nt lds
    s_add_u32 s36, s36, 25165824
    v_mfma_f32_16x16x32_bf16 v[124:127], a[200:203], a[168:171], v[124:127]
    v_mfma_f32_16x16x32_bf16 v[100:103], a[204:207], a[116:119], v[100:103]
    ds_read_b64_tr_b16 a[196:197], v240 offset:8
    v_mfma_f32_16x16x32_bf16 v[108:111], a[204:207], a[124:127], v[108:111]
    ds_read_b64_tr_b16 a[198:199], v240 offset:520
    v_mfma_f32_16x16x32_bf16 v[116:119], a[204:207], a[164:167], v[116:119]
    v_mfma_f32_16x16x32_bf16 v[124:127], a[204:207], a[172:175], v[124:127]
    s_waitcnt lgkmcnt(4)
    v_mfma_f32_16x16x32_bf16 v[100:103], a[208:211], a[128:131], v[100:103]
    ds_read_b64_tr_b16 a[200:201], v240 offset:64
    v_accvgpr_read_b32 v252, a232
    v_accvgpr_read_b32 v253, a233
    v_mfma_f32_16x16x32_bf16 v[108:111], a[208:211], a[136:139], v[108:111]
    ds_read_b64_tr_b16 a[202:203], v240 offset:576
    s_add_u32 m0, s38, 4096
    v_mfma_f32_16x16x32_bf16 v[116:119], a[208:211], a[176:179], v[116:119]
    buffer_load_dwordx4 v244, s[4:7], s42 offen nt lds
    v_mfma_f32_16x16x32_bf16 v[124:127], a[208:211], a[184:187], v[124:127]
    v_accvgpr_read_b32 v254, a236
    v_accvgpr_read_b32 v255, a237
    v_add_f32 v247, v252, v253
    v_mfma_f32_16x16x32_bf16 v[100:103], a[212:215], a[132:135], v[100:103]
    ds_read_b64_tr_b16 a[204:205], v240 offset:72
    v_add_f32 v246, v254, v255
    v_mfma_f32_16x16x32_bf16 v[108:111], a[212:215], a[140:143], v[108:111]
    ds_read_b64_tr_b16 a[206:207], v240 offset:584
    v_rcp_f32 v252, v252
    v_mfma_f32_16x16x32_bf16 v[116:119], a[212:215], a[180:183], v[116:119]
    s_waitcnt vmcnt(17)
    s_barrier
    v_add_f32 v247, v247, v246
    v_mfma_f32_16x16x32_bf16 v[124:127], a[212:215], a[188:191], v[124:127]
    v_rcp_f32 v253, v253
    s_waitcnt lgkmcnt(4)
    v_mfma_f32_16x16x32_bf16 a[0:3], a[192:195], v[128:131], a[0:3]
    ds_read_b64_tr_b16 a[208:209], v240 offset:1024
    v_cmp_ngt_f32 vcc, s22, v247
    s_cbranch_vccnz L_rare_1
L_back_2:
    v_mfma_f32_16x16x32_bf16 a[8:11], a[192:195], v[136:139], a[8:11]
    ds_read_b64_tr_b16 a[210:211], v240 offset:1536
    s_add_u32 m0, s28, 0
    v_mfma_f32_16x16x32_bf16 a[48:51], a[192:195], v[144:147], a[48:51]
    buffer_load_dwordx4 v242, s[48:51], s25 offen nt lds
    v_mfma_f32_16x16x32_bf16 a[56:59], a[192:195], v[152:155], a[56:59]
    v_rcp_f32 v254, v254
    v_mfma_f32_16x16x32_bf16 a[4:7], a[196:199], v[128:131], a[4:7]
    ds_read_b64_tr_b16 a[212:213], v240 offset:1032
    v_rcp_f32 v255, v255
    v_mfma_f32_16x16x32_bf16 a[12:15], a[196:199], v[136:139], a[12:15]
    ds_read_b64_tr_b16 a[214:215], v240 offset:1544
    v_max3_f32 v248, v96, v97, v98
    v_mfma_f32_16x16x32_bf16 a[52:55], a[196:199], v[144:147], a[52:55]
    v_max3_f32 v250, v112, v113, v114
    v_max3_f32 v249, v104, v105, v106
    v_max3_f32 v251, v120, v121, v122
    v_mfma_f32_16x16x32_bf16 a[60:63], a[196:199], v[152:155], a[60:63]
    v_max_f32 v248, v248, v99
    s_waitcnt lgkmcnt(4)
    v_mfma_f32_16x16x32_bf16 a[16:19], a[200:203], v[128:131], a[16:19]
    ds_read_b64_tr_b16 a[192:193], v240 offset:1088
    v_max_f32 v250, v250, v115
    v_max_f32 v249, v249, v107
    v_accvgpr_read_b32 v184, a0
    v_accvgpr_read_b32 v185, a1
    v_accvgpr_read_b32 v186, a2
    v_mfma_f32_16x16x32_bf16 a[24:27], a[200:203], v[136:139], a[24:27]
    ds_read_b64_tr_b16 a[194:195], v240 offset:1600
    v_max_f32 v251, v251, v123
    v_accvgpr_read_b32 v187, a3
    v_mul_f32 v184, v184, v252
    v_mul_f32 v185, v185, v252
    v_mul_f32 v186, v186, v252
    v_mfma_f32_16x16x32_bf16 a[64:67], a[200:203], v[144:147], a[64:67]
    v_permlane32_swap_b32 v248, v249
    v_permlane32_swap_b32 v250, v251
    v_max_f32 v248, v248, v249
    v_mul_f32 v187, v187, v252
    v_cvt_pk_bf16_f32 v160, v184, v185
    v_cvt_pk_bf16_f32 v161, v186, v187
    v_mfma_f32_16x16x32_bf16 a[72:75], a[200:203], v[152:155], a[72:75]
    v_max_f32 v250, v250, v251
    v_mov_b32 v249, v248
    v_mov_b32 v251, v250
    v_accvgpr_read_b32 v188, a4
    v_accvgpr_read_b32 v189, a5
    v_accvgpr_read_b32 v190, a6
    v_accvgpr_read_b32 v191, a7
    v_mfma_f32_16x16x32_bf16 a[20:23], a[204:207], v[128:131], a[20:23]
    ds_read_b64_tr_b16 a[196:197], v240 offset:1096
    v_permlane16_swap_b32 v248, v249
    v_mul_f32 v188, v188, v252
    v_mul_f32 v189, v189, v252
    v_mul_f32 v190, v190, v252
    v_mul_f32 v191, v191, v252
    v_mfma_f32_16x16x32_bf16 a[28:31], a[204:207], v[136:139], a[28:31]
    ds_read_b64_tr_b16 a[198:199], v240 offset:1608
    v_permlane16_swap_b32 v250, v251
    v_max_f32 v248, v248, v249
    v_cvt_pk_bf16_f32 v162, v188, v189
    v_cvt_pk_bf16_f32 v163, v190, v191
    v_accvgpr_read_b32 v184, a8
    v_mfma_f32_16x16x32_bf16 a[68:71], a[204:207], v[144:147], a[68:71]
    v_max_f32 v250, v250, v251
    v_mul_f32 v249, s21, v248
    v_accvgpr_read_b32 v185, a9
    v_accvgpr_read_b32 v186, a10
    v_accvgpr_read_b32 v187, a11
    v_mul_f32 v184, v184, v253
    v_mfma_f32_16x16x32_bf16 a[76:79], a[204:207], v[152:155], a[76:79]
    v_mul_f32 v251, s21, v250
    v_mul_f32 v248, s21, v248
    v_mul_f32 v185, v185, v253
    v_mul_f32 v186, v186, v253
    v_mul_f32 v187, v187, v253
    s_waitcnt lgkmcnt(4)
    v_mfma_f32_16x16x32_bf16 a[32:35], a[208:211], v[128:131], a[32:35]
    ds_read_b64_tr_b16 a[200:201], v240 offset:2048
    v_mul_f32 v250, s21, v250
    v_cvt_pk_bf16_f32 v164, v184, v185
    v_cvt_pk_bf16_f32 v165, v186, v187
    v_accvgpr_read_b32 v188, a12
    v_accvgpr_read_b32 v189, a13
    v_mfma_f32_16x16x32_bf16 a[40:43], a[208:211], v[136:139], a[40:43]
    ds_read_b64_tr_b16 a[202:203], v240 offset:2560
    s_add_u32 m0, s28, 896
    v_permlane32_swap_b32 v248, v249
    v_accvgpr_read_b32 v190, a14
    v_accvgpr_read_b32 v191, a15
    v_mul_f32 v188, v188, v253
    v_mfma_f32_16x16x32_bf16 a[80:83], a[208:211], v[144:147], a[80:83]
    buffer_load_dwordx4 v242, s[48:51], s25 offen offset:128 nt lds
    v_mul_f32 v189, v189, v253
    v_mul_f32 v190, v190, v253
    v_mfma_f32_16x16x32_bf16 a[88:91], a[208:211], v[152:155], a[88:91]
    v_permlane32_swap_b32 v250, v251
    v_fma_f32 v96, v96, s20, v248
    v_fma_f32 v97, v97, s20, v248
    v_mul_f32 v191, v191, v253
    v_cvt_pk_bf16_f32 v166, v188, v189
    v_cvt_pk_bf16_f32 v167, v190, v191
    v_accvgpr_read_b32 v216, a48
    v_mfma_f32_16x16x32_bf16 a[36:39], a[212:215], v[128:131], a[36:39]
    ds_read_b64_tr_b16 a[204:205], v240 offset:2056
    v_fma_f32 v104, v104, s20, v249
    v_accvgpr_read_b32 v217, a49
    v_accvgpr_read_b32 v218, a50
    v_accvgpr_read_b32 v219, a51
    v_mul_f32 v216, v216, v254
    v_mfma_f32_16x16x32_bf16 a[44:47], a[212:215], v[136:139], a[44:47]
    ds_read_b64_tr_b16 a[206:207], v240 offset:2568
    v_exp_f32 v96, v96
    v_mul_f32 v217, v217, v254
    v_mul_f32 v218, v218, v254
    v_mul_f32 v219, v219, v254
    v_mfma_f32_16x16x32_bf16 a[84:87], a[212:215], v[144:147], a[84:87]
    v_fma_f32 v105, v105, s20, v249
    v_exp_f32 v97, v97
    v_cvt_pk_bf16_f32 v192, v216, v217
    v_cvt_pk_bf16_f32 v193, v218, v219
    v_accvgpr_read_b32 v220, a52
    v_mfma_f32_16x16x32_bf16 a[92:95], a[212:215], v[152:155], a[92:95]
    v_fma_f32 v112, v112, s20, v250
    v_accvgpr_read_b32 v221, a53
    v_accvgpr_read_b32 v222, a54
    v_accvgpr_read_b32 v223, a55
    v_mul_f32 v220, v220, v254
    s_waitcnt lgkmcnt(4)
    v_mfma_f32_16x16x32_bf16 v[0:3], a[192:195], v[128:131], v[0:3]
    ds_read_b64_tr_b16 a[208:209], v240 offset:2112
    v_exp_f32 v104, v104
    v_mul_f32 v221, v221, v254
    v_mul_f32 v222, v222, v254
    v_mul_f32 v223, v223, v254
    v_mfma_f32_16x16x32_bf16 v[8:11], a[192:195], v[136:139], v[8:11]
    ds_read_b64_tr_b16 a[210:211], v240 offset:2624
    s_add_u32 m0, s38, -2048
    v_cvt_pk_bf16_f32 v194, v220, v221
    v_cvt_pk_bf16_f32 v195, v222, v223
    v_accvgpr_read_b32 v216, a56
    v_accvgpr_read_b32 v217, a57
    v_mfma_f32_16x16x32_bf16 v[48:51], a[192:195], v[144:147], v[48:51]
    buffer_load_dwordx4 v245, s[4:7], s40 offen offset:3072 nt lds
    v_accvgpr_read_b32 v218, a58
    v_accvgpr_read_b32 v219, a59
    v_mfma_f32_16x16x32_bf16 v[56:59], a[192:195], v[152:155], v[56:59]
    v_fma_f32 v113, v113, s20, v250
    v_cvt_pk_bf16_f32 v96, v96, v97
    v_mul_f32 v216, v216, v255
    v_mul_f32 v217, v217, v255
    v_mul_f32 v218, v218, v255
    v_mul_f32 v219, v219, v255
    v_cvt_pk_bf16_f32 v196, v216, v217
    v_mfma_f32_16x16x32_bf16 v[4:7], a[196:199], v[128:131], v[4:7]
    ds_read_b64_tr_b16 a[212:213], v240 offset:2120
    v_exp_f32 v105, v105
    v_cvt_pk_bf16_f32 v197, v218, v219
    v_accvgpr_read_b32 v220, a60
    v_accvgpr_read_b32 v221, a61
    v_mfma_f32_16x16x32_bf16 v[12:15], a[196:199], v[136:139], v[12:15]
    ds_read_b64_tr_b16 a[214:215], v240 offset:2632
    v_fma_f32 v120, v120, s20, v251
    v_accvgpr_read_b32 v222, a62
    v_accvgpr_read_b32 v223, a63
    v_mul_f32 v220, v220, v255
    v_mul_f32 v221, v221, v255
    v_mfma_f32_16x16x32_bf16 v[52:55], a[196:199], v[144:147], v[52:55]
    v_exp_f32 v112, v112
    v_fma_f32 v121, v121, s20, v251
    v_cvt_pk_bf16_f32 v104, v104, v105
    v_mul_f32 v222, v222, v255
    v_mul_f32 v223, v223, v255
    v_mfma_f32_16x16x32_bf16 v[60:63], a[196:199], v[152:155], v[60:63]
    v_exp_f32 v113, v113
    v_cvt_pk_bf16_f32 v198, v220, v221
    v_cvt_pk_bf16_f32 v199, v222, v223
    v_accvgpr_read_b32 v184, a16
    s_waitcnt lgkmcnt(4)
    v_mfma_f32_16x16x32_bf16 v[16:19], a[200:203], v[128:131], v[16:19]
    ds_read_b128 a[192:195], v236 offset:12288
    v_fma_f32 v98, v98, s20, v248
    v_accvgpr_read_b32 v185, a17
    v_accvgpr_read_b32 v186, a18
    v_accvgpr_read_b32 v187, a19
    v_mul_f32 v184, v184, v252
    v_mfma_f32_16x16x32_bf16 v[24:27], a[200:203], v[136:139], v[24:27]
    s_add_u32 m0, s28, 1792
    v_exp_f32 v120, v120
    v_mul_f32 v185, v185, v252
    v_mul_f32 v186, v186, v252
    v_mul_f32 v187, v187, v252
    v_mfma_f32_16x16x32_bf16 v[64:67], a[200:203], v[144:147], v[64:67]
    buffer_load_dwordx4 v242, s[48:51], s25 offen offset:256 nt lds
    v_cvt_pk_bf16_f32 v168, v184, v185
    v_cvt_pk_bf16_f32 v169, v186, v187
    v_mfma_f32_16x16x32_bf16 v[72:75], a[200:203], v[152:155], v[72:75]
    v_fma_f32 v99, v99, s20, v248
    v_cvt_pk_bf16_f32 v112, v112, v113
    v_accvgpr_read_b32 v188, a20
    v_accvgpr_read_b32 v189, a21
    v_accvgpr_read_b32 v190, a22
    v_accvgpr_read_b32 v191, a23
    v_mul_f32 v188, v188, v252
    v_mfma_f32_16x16x32_bf16 v[20:23], a[204:207], v[128:131], v[20:23]
    ds_read_b128 a[196:199], v237 offset:12288
    v_exp_f32 v121, v121
    v_mul_f32 v189, v189, v252
    v_mul_f32 v190, v190, v252
    v_mul_f32 v191, v191, v252
    v_mfma_f32_16x16x32_bf16 v[28:31], a[204:207], v[136:139], v[28:31]
    v_fma_f32 v106, v106, s20, v249
    v_exp_f32 v98, v98
    v_cvt_pk_bf16_f32 v170, v188, v189
    v_cvt_pk_bf16_f32 v171, v190, v191
    v_accvgpr_read_b32 v184, a24
    v_mfma_f32_16x16x32_bf16 v[68:71], a[204:207], v[144:147], v[68:71]
    v_fma_f32 v107, v107, s20, v249
    v_cvt_pk_bf16_f32 v120, v120, v121
    v_accvgpr_read_b32 v185, a25
    v_accvgpr_read_b32 v186, a26
    v_accvgpr_read_b32 v187, a27
    v_mul_f32 v184, v184, v253
    v_mfma_f32_16x16x32_bf16 v[76:79], a[204:207], v[152:155], v[76:79]
    v_exp_f32 v99, v99
    v_mul_f32 v185, v185, v253
    v_mul_f32 v186, v186, v253
    v_mul_f32 v187, v187, v253
    s_waitcnt lgkmcnt(2)
    v_mfma_f32_16x16x32_bf16 v[32:35], a[208:211], v[128:131], v[32:35]
    ds_read_b128 a[200:203], v236 offset:13312
    v_fma_f32 v114, v114, s20, v250
    v_cvt_pk_bf16_f32 v172, v184, v185
    v_cvt_pk_bf16_f32 v173, v186, v187
    v_accvgpr_read_b32 v188, a28
    v_accvgpr_read_b32 v189, a29
    v_mfma_f32_16x16x32_bf16 v[40:43], a[208:211], v[136:139], v[40:43]
    v_exp_f32 v106, v106
    v_accvgpr_read_b32 v190, a30
    v_accvgpr_read_b32 v191, a31
    v_mul_f32 v188, v188, v253
    v_mul_f32 v189, v189, v253
    v_mfma_f32_16x16x32_bf16 v[80:83], a[208:211], v[144:147], v[80:83]
    v_fma_f32 v115, v115, s20, v250
    v_cvt_pk_bf16_f32 v97, v98, v99
    v_mul_f32 v190, v190, v253
    v_mul_f32 v191, v191, v253
    v_cvt_pk_bf16_f32 v174, v188, v189
    v_cvt_pk_bf16_f32 v175, v190, v191
    v_mfma_f32_16x16x32_bf16 v[88:91], a[208:211], v[152:155], v[88:91]
    s_add_u32 s25, s26, 12288
    v_exp_f32 v107, v107
    v_fma_f32 v122, v122, s20, v251
    v_accvgpr_read_b32 v216, a64
    v_accvgpr_read_b32 v217, a65
    v_accvgpr_read_b32 v218, a66
    v_mfma_f32_16x16x32_bf16 v[36:39], a[212:215], v[128:131], v[36:39]
    ds_read_b128 a[204:207], v237 offset:13312
    v_exp_f32 v114, v114
    v_accvgpr_read_b32 v219, a67
    v_mul_f32 v216, v216, v254
    v_mul_f32 v217, v217, v254
    v_mfma_f32_16x16x32_bf16 v[44:47], a[212:215], v[136:139], v[44:47]
    v_fma_f32 v123, v123, s20, v251
    v_cvt_pk_bf16_f32 v105, v106, v107
    v_mul_f32 v218, v218, v254
    v_mul_f32 v219, v219, v254
    v_cvt_pk_bf16_f32 v200, v216, v217
    v_cvt_pk_bf16_f32 v201, v218, v219
    v_mfma_f32_16x16x32_bf16 v[84:87], a[212:215], v[144:147], v[84:87]
    v_exp_f32 v115, v115
    v_accvgpr_read_b32 v220, a68
    v_accvgpr_read_b32 v221, a69
    v_accvgpr_read_b32 v222, a70
    v_accvgpr_read_b32 v223, a71
    v_mfma_f32_16x16x32_bf16 v[92:95], a[212:215], v[152:155], v[92:95]
    v_fma_f32 v100, v100, s20, v248
    v_mul_f32 v220, v220, v254
    v_mul_f32 v221, v221, v254
    v_mul_f32 v222, v222, v254
    v_mul_f32 v223, v223, v254
    s_sub_u32 s24, s24, 1
    s_branch L_body
L_tail:
    s_waitcnt lgkmcnt(4)
    v_mfma_f32_16x16x32_bf16 a[0:3], a[192:195], v[128:131], a[0:3]
    ds_read_b128 a[208:211], v236 offset:36864
    v_fma_f32 v106, v106, s20, v249
    v_exp_f32 v113, v113
    v_mfma_f32_16x16x32_bf16 a[8:11], a[192:195], v[136:139], a[8:11]
    v_cvt_pk_bf16_f32 v112, v112, v113
    v_fma_f32 v107, v107, s20, v249
    v_mfma_f32_16x16x32_bf16 a[48:51], a[192:195], v[144:147], a[48:51]
    v_exp_f32 v120, v120
    v_mfma_f32_16x16x32_bf16 a[56:59], a[192:195], v[152:155], a[56:59]
    v_fma_f32 v114, v114, s20, v250
    v_fma_f32 v115, v115, s20, v250
    v_mfma_f32_16x16x32_bf16 a[4:7], a[196:199], v[128:131], a[4:7]
    ds_read_b128 a[212:215], v237 offset:36864
    v_fma_f32 v122, v122, s20, v251
    v_exp_f32 v121, v121
    v_mfma_f32_16x16x32_bf16 a[12:15], a[196:199], v[136:139], a[12:15]
    v_exp_f32 v98, v98
    v_mfma_f32_16x16x32_bf16 a[52:55], a[196:199], v[144:147], a[52:55]
    buffer_store_dwordx4 a[248:251], v243, s[16:19], s45 offen offset:256 nt
    v_cvt_pk_bf16_f32 v120, v120, v121
    v_fma_f32 v123, v123, s20, v251
    v_mfma_f32_16x16x32_bf16 a[60:63], a[196:199], v[152:155], a[60:63]
    v_exp_f32 v99, v99
    s_waitcnt lgkmcnt(2)
    v_mfma_f32_16x16x32_bf16 a[16:19], a[200:203], v[128:131], a[16:19]
    ds_read_b128 a[192:195], v236 offset:37888
    v_cvt_pk_bf16_f32 v97, v98, v99
    v_fma_f32 v100, v100, s20, v248
    v_mfma_f32_16x16x32_bf16 a[24:27], a[200:203], v[136:139], a[24:27]
    v_exp_f32 v106, v106
    v_mfma_f32_16x16x32_bf16 a[64:67], a[200:203], v[144:147], a[64:67]
    v_fma_f32 v101, v101, s20, v248
    v_fma_f32 v102, v102, s20, v248
    v_mfma_f32_16x16x32_bf16 a[72:75], a[200:203], v[152:155], a[72:75]
    v_exp_f32 v107, v107
    v_mfma_f32_16x16x32_bf16 a[20:23], a[204:207], v[128:131], a[20:23]
    ds_read_b128 a[196:199], v237 offset:37888
    v_cvt_pk_bf16_f32 v105, v106, v107
    v_fma_f32 v103, v103, s20, v248
    v_mfma_f32_16x16x32_bf16 a[28:31], a[204:207], v[136:139], a[28:31]
    v_fma_f32 v108, v108, s20, v249
    v_exp_f32 v114, v114
    v_mfma_f32_16x16x32_bf16 a[68:71], a[204:207], v[144:147], a[68:71]
    buffer_store_dwordx4 a[240:243], v243, s[16:19], s47 offen offset:256 nt
    v_fma_f32 v109, v109, s20, v249
    v_fma_f32 v110, v110, s20, v249
    v_mfma_f32_16x16x32_bf16 a[76:79], a[204:207], v[152:155], a[76:79]
    v_exp_f32 v115, v115
    s_waitcnt lgkmcnt(2)
    v_mfma_f32_16x16x32_bf16 v[192:195], a[208:211], a[96:99], 0
    ds_read_b128 a[200:203], v236 offset:38912
    v_cvt_pk_bf16_f32 v113, v114, v115
    v_fma_f32 v111, v111, s20, v249
    v_mfma_f32_16x16x32_bf16 v[200:203], a[208:211], a[104:107], 0
    v_fma_f32 v116, v116, s20, v250
    v_mfma_f32_16x16x32_bf16 v[208:211], a[208:211], a[144:147], 0
    s_add_u32 s44, s40, -25165824
    s_add_u32 s45, s41, -25165824
    s_add_u32 s46, s42, -25165824
    s_add_u32 s47, s43, -25165824
    v_exp_f32 v122, v122
    v_mfma_f32_16x16x32_bf16 v[216:219], a[208:211], a[152:155], 0
    v_fma_f32 v117, v117, s20, v250
    v_exp_f32 v123, v123
    v_mfma_f32_16x16x32_bf16 v[192:195], a[212:215], a[100:103], v[192:195]
    ds_read_b128 a[204:207], v237 offset:38912
    v_exp_f32 v100, v100
    v_mfma_f32_16x16x32_bf16 v[200:203], a[212:215], a[108:111], v[200:203]
    v_cvt_pk_bf16_f32 v121, v122, v123
    v_fma_f32 v118, v118, s20, v250
    v_mfma_f32_16x16x32_bf16 v[208:211], a[212:215], a[148:151], v[208:211]
    v_exp_f32 v101, v101
    v_mfma_f32_16x16x32_bf16 v[216:219], a[212:215], a[156:159], v[216:219]
    v_exp_f32 v102, v102
    s_waitcnt lgkmcnt(2)
    v_mfma_f32_16x16x32_bf16 v[192:195], a[192:195], a[112:115], v[192:195]
    ds_read_b128 a[208:211], v236 offset:43008
    v_cvt_pk_bf16_f32 v98, v100, v101
    v_fma_f32 v119, v119, s20, v250
    v_mfma_f32_16x16x32_bf16 v[200:203], a[192:195], a[120:123], v[200:203]
    v_exp_f32 v103, v103
    v_mfma_f32_16x16x32_bf16 v[208:211], a[192:195], a[160:163], v[208:211]
    v_exp_f32 v108, v108
    v_mfma_f32_16x16x32_bf16 v[216:219], a[192:195], a[168:171], v[216:219]
    v_cvt_pk_bf16_f32 v99, v102, v103
    v_fma_f32 v124, v124, s20, v251
    v_mfma_f32_16x16x32_bf16 v[192:195], a[196:199], a[116:119], v[192:195]
    ds_read_b128 a[212:215], v237 offset:43008
    v_mfma_f32_16x16x32_bf16 a[232:235], a[224:227], v[96:99], a[232:235]
    v_mfma_f32_16x16x32_bf16 v[200:203], a[196:199], a[124:127], v[200:203]
    v_exp_f32 v109, v109
    v_mfma_f32_16x16x32_bf16 v[208:211], a[196:199], a[164:167], v[208:211]
    v_cvt_pk_bf16_f32 v106, v108, v109
    v_mfma_f32_16x16x32_bf16 v[216:219], a[196:199], a[172:175], v[216:219]
    v_exp_f32 v110, v110
    s_waitcnt lgkmcnt(2)
    v_mfma_f32_16x16x32_bf16 v[192:195], a[200:203], a[128:131], v[192:195]
    ds_read_b128 a[192:195], v236 offset:44032
    v_fma_f32 v125, v125, s20, v251
    v_exp_f32 v111, v111
    v_mfma_f32_16x16x32_bf16 v[200:203], a[200:203], a[136:139], v[200:203]
    v_exp_f32 v116, v116
    v_mfma_f32_16x16x32_bf16 v[208:211], a[200:203], a[176:179], v[208:211]
    v_cvt_pk_bf16_f32 v107, v110, v111
    v_fma_f32 v126, v126, s20, v251
    v_mfma_f32_16x16x32_bf16 v[216:219], a[200:203], a[184:187], v[216:219]
    v_mfma_f32_16x16x32_bf16 a[232:235], a[228:231], v[104:107], a[232:235]
    v_mfma_f32_16x16x32_bf16 v[192:195], a[204:207], a[132:135], v[192:195]
    ds_read_b128 a[196:199], v237 offset:44032
    v_exp_f32 v117, v117
    v_mfma_f32_16x16x32_bf16 v[200:203], a[204:207], a[140:143], v[200:203]
    v_exp_f32 v118, v118
    v_mfma_f32_16x16x32_bf16 v[208:211], a[204:207], a[180:183], v[208:211]
    v_exp_f32 v119, v119
    v_mfma_f32_16x16x32_bf16 v[216:219], a[204:207], a[188:191], v[216:219]
    v_cvt_pk_bf16_f32 v114, v116, v117
    s_waitcnt lgkmcnt(2)
    v_mfma_f32_16x16x32_bf16 v[196:199], a[208:211], a[96:99], 0
    ds_read_b128 a[200:203], v236 offset:45056
    v_exp_f32 v124, v124
    v_mfma_f32_16x16x32_bf16 v[204:207], a[208:211], a[104:107], 0
    v_exp_f32 v125, v125
    v_mfma_f32_16x16x32_bf16 v[212:215], a[208:211], a[144:147], 0
    v_fma_f32 v127, v127, s20, v251
    v_cvt_pk_bf16_f32 v115, v118, v119
    v_mfma_f32_16x16x32_bf16 v[220:223], a[208:211], a[152:155], 0
    v_cvt_pk_bf16_f32 v122, v124, v125
    v_mfma_f32_16x16x32_bf16 a[236:239], a[224:227], v[112:115], a[236:239]
    v_mfma_f32_16x16x32_bf16 v[196:199], a[212:215], a[100:103], v[196:199]
    ds_read_b128 a[204:207], v237 offset:45056
    v_exp_f32 v126, v126
    v_fma_f32 v192, v192, s20, v248
    v_fma_f32 v193, v193, s20, v248
    v_fma_f32 v200, v200, s20, v249
    v_mfma_f32_16x16x32_bf16 v[204:207], a[212:215], a[108:111], v[204:207]
    v_exp_f32 v127, v127
    v_exp_f32 v192, v192
    v_fma_f32 v201, v201, s20, v249
    v_mfma_f32_16x16x32_bf16 v[212:215], a[212:215], a[148:151], v[212:215]
    v_cvt_pk_bf16_f32 v123, v126, v127
    v_exp_f32 v193, v193
    v_fma_f32 v208, v208, s20, v250
    v_mfma_f32_16x16x32_bf16 v[220:223], a[212:215], a[156:159], v[220:223]
    v_mfma_f32_16x16x32_bf16 a[236:239], a[228:231], v[120:123], a[236:239]
    v_exp_f32 v200, v200
    v_fma_f32 v209, v209, s20, v250
    s_waitcnt lgkmcnt(2)
    v_mfma_f32_16x16x32_bf16 v[196:199], a[192:195], a[112:115], v[196:199]
    ds_read_b64_tr_b16 a[208:209], v240 offset:12416
    v_cvt_pk_bf16_f32 v132, v192, v193
    v_exp_f32 v201, v201
    v_mfma_f32_16x16x32_bf16 v[204:207], a[192:195], a[120:123], v[204:207]
    ds_read_b64_tr_b16 a[210:211], v240 offset:12928
    v_fma_f32 v216, v216, s20, v251
    v_exp_f32 v208, v208
    v_mfma_f32_16x16x32_bf16 v[212:215], a[192:195], a[160:163], v[212:215]
    v_fma_f32 v217, v217, s20, v251
    v_cvt_pk_bf16_f32 v140, v200, v201
    v_mfma_f32_16x16x32_bf16 v[220:223], a[192:195], a[168:171], v[220:223]
    v_exp_f32 v209, v209
    v_fma_f32 v194, v194, s20, v248
    v_mfma_f32_16x16x32_bf16 v[196:199], a[196:199], a[116:119], v[196:199]
    ds_read_b64_tr_b16 a[212:213], v240 offset:12424
    v_exp_f32 v216, v216
    v_fma_f32 v195, v195, s20, v248
    v_mfma_f32_16x16x32_bf16 v[204:207], a[196:199], a[124:127], v[204:207]
    ds_read_b64_tr_b16 a[214:215], v240 offset:12936
    v_cvt_pk_bf16_f32 v148, v208, v209
    v_exp_f32 v217, v217
    v_mfma_f32_16x16x32_bf16 v[212:215], a[196:199], a[164:167], v[212:215]
    v_fma_f32 v202, v202, s20, v249
    v_exp_f32 v194, v194
    v_mfma_f32_16x16x32_bf16 v[220:223], a[196:199], a[172:175], v[220:223]
    v_fma_f32 v203, v203, s20, v249
    v_cvt_pk_bf16_f32 v156, v216, v217
    s_waitcnt lgkmcnt(4)
    v_mfma_f32_16x16x32_bf16 v[196:199], a[200:203], a[128:131], v[196:199]
    ds_read_b64_tr_b16 a[192:193], v240 offset:12480
    v_exp_f32 v195, v195
    v_fma_f32 v210, v210, s20, v250
    v_mfma_f32_16x16x32_bf16 v[204:207], a[200:203], a[136:139], v[204:207]
    ds_read_b64_tr_b16 a[194:195], v240 offset:12992
    v_exp_f32 v202, v202
    v_fma_f32 v211, v211, s20, v250
    v_mfma_f32_16x16x32_bf16 v[212:215], a[200:203], a[176:179], v[212:215]
    v_cvt_pk_bf16_f32 v133, v194, v195
    v_exp_f32 v203, v203
    v_mfma_f32_16x16x32_bf16 v[220:223], a[200:203], a[184:187], v[220:223]
    v_fma_f32 v218, v218, s20, v251
    v_exp_f32 v210, v210
    v_mfma_f32_16x16x32_bf16 v[196:199], a[204:207], a[132:135], v[196:199]
    ds_read_b64_tr_b16 a[196:197], v240 offset:12488
    v_fma_f32 v219, v219, s20, v251
    v_cvt_pk_bf16_f32 v141, v202, v203
    v_mfma_f32_16x16x32_bf16 v[204:207], a[204:207], a[140:143], v[204:207]
    ds_read_b64_tr_b16 a[198:199], v240 offset:13000
    v_exp_f32 v211, v211
    v_mfma_f32_16x16x32_bf16 v[212:215], a[204:207], a[180:183], v[212:215]
    v_mfma_f32_16x16x32_bf16 v[220:223], a[204:207], a[188:191], v[220:223]
    s_waitcnt lgkmcnt(4)
    v_mfma_f32_16x16x32_bf16 a[0:3], a[208:211], v[96:99], a[0:3]
    ds_read_b64_tr_b16 a[200:201], v240 offset:1024
    v_mfma_f32_16x16x32_bf16 a[8:11], a[208:211], v[104:107], a[8:11]
    ds_read_b64_tr_b16 a[202:203], v240 offset:1536
    v_mfma_f32_16x16x32_bf16 a[48:51], a[208:211], v[112:115], a[48:51]
    v_mfma_f32_16x16x32_bf16 a[56:59], a[208:211], v[120:123], a[56:59]
    v_mfma_f32_16x16x32_bf16 a[4:7], a[212:215], v[96:99], a[4:7]
    ds_read_b64_tr_b16 a[204:205], v240 offset:1032
    v_fma_f32 v196, v196, s20, v248
    v_exp_f32 v218, v218
    v_fma_f32 v197, v197, s20, v248
    v_mfma_f32_16x16x32_bf16 a[12:15], a[212:215], v[104:107], a[12:15]
    ds_read_b64_tr_b16 a[206:207], v240 offset:1544
    v_cvt_pk_bf16_f32 v149, v210, v211
    v_exp_f32 v219, v219
    v_fma_f32 v198, v198, s20, v248
    v_mfma_f32_16x16x32_bf16 a[52:55], a[212:215], v[112:115], a[52:55]
    s_waitcnt vmcnt(13)
    s_barrier
    v_exp_f32 v196, v196
    v_fma_f32 v199, v199, s20, v248
    v_cvt_pk_bf16_f32 v157, v218, v219
    v_mfma_f32_16x16x32_bf16 a[60:63], a[212:215], v[120:123], a[60:63]
    v_exp_f32 v197, v197
    v_fma_f32 v204, v204, s20, v249
    s_waitcnt lgkmcnt(4)
    v_mfma_f32_16x16x32_bf16 a[16:19], a[192:195], v[96:99], a[16:19]
    ds_read_b64_tr_b16 a[208:209], v240 offset:24832
    v_exp_f32 v198, v198
    v_fma_f32 v205, v205, s20, v249
    v_cvt_pk_bf16_f32 v134, v196, v197
    v_mfma_f32_16x16x32_bf16 a[24:27], a[192:195], v[104:107], a[24:27]
    ds_read_b64_tr_b16 a[210:211], v240 offset:25344
    v_exp_f32 v199, v199
    v_fma_f32 v206, v206, s20, v249
    v_mfma_f32_16x16x32_bf16 a[64:67], a[192:195], v[112:115], a[64:67]
    v_exp_f32 v204, v204
    v_fma_f32 v207, v207, s20, v249
    v_cvt_pk_bf16_f32 v135, v198, v199
    v_mfma_f32_16x16x32_bf16 a[72:75], a[192:195], v[120:123], a[72:75]
    v_exp_f32 v205, v205
    v_fma_f32 v212, v212, s20, v250
    v_exp_f32 v206, v206
    v_mfma_f32_16x16x32_bf16 a[20:23], a[196:199], v[96:99], a[20:23]
    ds_read_b64_tr_b16 a[212:213], v240 offset:24840
    v_fma_f32 v213, v213, s20, v250
    v_cvt_pk_bf16_f32 v142, v204, v205
    v_exp_f32 v207, v207
    v_mfma_f32_16x16x32_bf16 a[28:31], a[196:199], v[104:107], a[28:31]
    ds_read_b64_tr_b16 a[214:215], v240 offset:25352
    v_fma_f32 v214, v214, s20, v250
    v_exp_f32 v212, v212
    v_fma_f32 v215, v215, s20, v250
    v_mfma_f32_16x16x32_bf16 a[68:71], a[196:199], v[112:115], a[68:71]
    v_cvt_pk_bf16_f32 v143, v206, v207
    v_exp_f32 v213, v213
    v_mfma_f32_16x16x32_bf16 a[76:79], a[196:199], v[120:123], a[76:79]
    v_mfma_f32_16x16x32_bf16 a[232:235], a[224:227], v[132:135], a[232:235]
    v_fma_f32 v220, v220, s20, v251
    v_exp_f32 v214, v214
    s_waitcnt lgkmcnt(4)
    v_mfma_f32_16x16x32_bf16 a[32:35], a[200:203], v[128:131], a[32:35]
    ds_read_b64_tr_b16 a[192:193], v240 offset:24896
    v_fma_f32 v221, v221, s20, v251
    v_cvt_pk_bf16_f32 v150, v212, v213
    v_exp_f32 v215, v215
    v_mfma_f32_16x16x32_bf16 a[40:43], a[200:203], v[136:139], a[40:43]
    ds_read_b64_tr_b16 a[194:195], v240 offset:25408
    v_fma_f32 v222, v222, s20, v251
    v_exp_f32 v220, v220
    v_fma_f32 v223, v223, s20, v251
    v_mfma_f32_16x16x32_bf16 a[80:83], a[200:203], v[144:147], a[80:83]
    v_cvt_pk_bf16_f32 v151, v214, v215
    v_exp_f32 v221, v221
    v_mfma_f32_16x16x32_bf16 a[88:91], a[200:203], v[152:155], a[88:91]
    v_mfma_f32_16x16x32_bf16 a[232:235], a[228:231], v[140:143], a[232:235]
    v_exp_f32 v222, v222
    v_mfma_f32_16x16x32_bf16 a[36:39], a[204:207], v[128:131], a[36:39]
    ds_read_b64_tr_b16 a[196:197], v240 offset:24904
    v_cvt_pk_bf16_f32 v158, v220, v221
    v_exp_f32 v223, v223
    s_nop 0
    v_cvt_pk_bf16_f32 v159, v222, v223
    v_mfma_f32_16x16x32_bf16 a[44:47], a[204:207], v[136:139], a[44:47]
    ds_read_b64_tr_b16 a[198:199], v240 offset:25416
    v_mfma_f32_16x16x32_bf16 a[236:239], a[224:227], v[148:151], a[236:239]
    v_mfma_f32_16x16x32_bf16 a[236:239], a[228:231], v[156:159], a[236:239]
    v_mfma_f32_16x16x32_bf16 a[84:87], a[204:207], v[144:147], a[84:87]
    v_mfma_f32_16x16x32_bf16 a[92:95], a[204:207], v[152:155], a[92:95]
    s_waitcnt lgkmcnt(4)
    v_mfma_f32_16x16x32_bf16 a[0:3], a[208:211], v[132:135], a[0:3]
    ds_read_b64_tr_b16 a[200:201], v240 offset:13440
    v_mfma_f32_16x16x32_bf16 a[8:11], a[208:211], v[140:143], a[8:11]
    ds_read_b64_tr_b16 a[202:203], v240 offset:13952
    v_mfma_f32_16x16x32_bf16 a[48:51], a[208:211], v[148:151], a[48:51]
    v_mfma_f32_16x16x32_bf16 a[56:59], a[208:211], v[156:159], a[56:59]
    v_mfma_f32_16x16x32_bf16 a[4:7], a[212:215], v[132:135], a[4:7]
    ds_read_b64_tr_b16 a[204:205], v240 offset:13448
    v_accvgpr_read_b32 v252, a232
    v_accvgpr_read_b32 v253, a233
    v_accvgpr_read_b32 v254, a236
    v_accvgpr_read_b32 v255, a237
    v_add_f32 v247, v252, v253
    v_mfma_f32_16x16x32_bf16 a[12:15], a[212:215], v[140:143], a[12:15]
    ds_read_b64_tr_b16 a[206:207], v240 offset:13960
    v_add_f32 v246, v254, v255
    v_rcp_f32 v252, v252
    v_add_f32 v247, v247, v246
    v_rcp_f32 v253, v253
    v_cmp_ngt_f32 vcc, s22, v247
    s_cbranch_vccnz L_rare_3
L_back_4:
    v_mfma_f32_16x16x32_bf16 a[52:55], a[212:215], v[148:151], a[52:55]
    v_rcp_f32 v254, v254
    v_rcp_f32 v255, v255
    v_mfma_f32_16x16x32_bf16 a[60:63], a[212:215], v[156:159], a[60:63]
    s_waitcnt lgkmcnt(4)
    v_mfma_f32_16x16x32_bf16 a[16:19], a[192:195], v[132:135], a[16:19]
    ds_read_b64_tr_b16 a[208:209], v240 offset:25856
    v_accvgpr_read_b32 v184, a0
    v_accvgpr_read_b32 v185, a1
    v_accvgpr_read_b32 v186, a2
    v_accvgpr_read_b32 v187, a3
    v_mul_f32 v184, v184, v252
    v_mfma_f32_16x16x32_bf16 a[24:27], a[192:195], v[140:143], a[24:27]
    ds_read_b64_tr_b16 a[210:211], v240 offset:26368
    v_mul_f32 v185, v185, v252
    v_mul_f32 v186, v186, v252
    v_mul_f32 v187, v187, v252
    v_cvt_pk_bf16_f32 v160, v184, v185
    v_cvt_pk_bf16_f32 v161, v186, v187
    v_mfma_f32_16x16x32_bf16 a[64:67], a[192:195], v[148:151], a[64:67]
    v_accvgpr_read_b32 v188, a4
    v_accvgpr_read_b32 v189, a5
    v_accvgpr_read_b32 v190, a6
    v_accvgpr_read_b32 v191, a7
    v_mul_f32 v188, v188, v252
    v_mfma_f32_16x16x32_bf16 a[72:75], a[192:195], v[156:159], a[72:75]
    v_mul_f32 v189, v189, v252
    v_mul_f32 v190, v190, v252
    v_mul_f32 v191, v191, v252
    v_cvt_pk_bf16_f32 v162, v188, v189
    v_cvt_pk_bf16_f32 v163, v190, v191
    v_mfma_f32_16x16x32_bf16 a[20:23], a[196:199], v[132:135], a[20:23]
    ds_read_b64_tr_b16 a[212:213], v240 offset:25864
    v_accvgpr_read_b32 v184, a8
    v_accvgpr_read_b32 v185, a9
    v_accvgpr_read_b32 v186, a10
    v_accvgpr_read_b32 v187, a11
    v_mul_f32 v184, v184, v253
    v_mfma_f32_16x16x32_bf16 a[28:31], a[196:199], v[140:143], a[28:31]
    ds_read_b64_tr_b16 a[214:215], v240 offset:26376
    v_mul_f32 v185, v185, v253
    v_mul_f32 v186, v186, v253
    v_mul_f32 v187, v187, v253
    v_cvt_pk_bf16_f32 v164, v184, v185
    v_cvt_pk_bf16_f32 v165, v186, v187
    v_mfma_f32_16x16x32_bf16 a[68:71], a[196:199], v[148:151], a[68:71]
    v_accvgpr_read_b32 v188, a12
    v_accvgpr_read_b32 v189, a13
    v_accvgpr_read_b32 v190, a14
    v_accvgpr_read_b32 v191, a15
    v_mul_f32 v188, v188, v253
    v_mfma_f32_16x16x32_bf16 a[76:79], a[196:199], v[156:159], a[76:79]
    v_mul_f32 v189, v189, v253
    v_mul_f32 v190, v190, v253
    v_mul_f32 v191, v191, v253
    v_cvt_pk_bf16_f32 v166, v188, v189
    v_cvt_pk_bf16_f32 v167, v190, v191
    s_waitcnt lgkmcnt(4)
    v_mfma_f32_16x16x32_bf16 a[32:35], a[200:203], v[96:99], a[32:35]
    ds_read_b64_tr_b16 a[192:193], v240 offset:1088
    v_accvgpr_read_b32 v184, a16
    v_accvgpr_read_b32 v185, a17
    v_accvgpr_read_b32 v186, a18
    v_accvgpr_read_b32 v187, a19
    v_mul_f32 v184, v184, v252
    v_mfma_f32_16x16x32_bf16 a[40:43], a[200:203], v[104:107], a[40:43]
    ds_read_b64_tr_b16 a[194:195], v240 offset:1600
    v_mul_f32 v185, v185, v252
    v_mul_f32 v186, v186, v252
    v_mul_f32 v187, v187, v252
    v_cvt_pk_bf16_f32 v168, v184, v185
    v_cvt_pk_bf16_f32 v169, v186, v187
    v_mfma_f32_16x16x32_bf16 a[80:83], a[200:203], v[112:115], a[80:83]
    v_accvgpr_read_b32 v188, a20
    v_accvgpr_read_b32 v189, a21
    v_accvgpr_read_b32 v190, a22
    v_accvgpr_read_b32 v191, a23
    v_mul_f32 v188, v188, v252
    v_mfma_f32_16x16x32_bf16 a[88:91], a[200:203], v[120:123], a[88:91]
    v_mul_f32 v189, v189, v252
    v_mul_f32 v190, v190, v252
    v_mul_f32 v191, v191, v252
    v_cvt_pk_bf16_f32 v170, v188, v189
    v_cvt_pk_bf16_f32 v171, v190, v191
    v_mfma_f32_16x16x32_bf16 a[36:39], a[204:207], v[96:99], a[36:39]
    ds_read_b64_tr_b16 a[196:197], v240 offset:1096
    v_accvgpr_read_b32 v184, a24
    v_accvgpr_read_b32 v185, a25
    v_accvgpr_read_b32 v186, a26
    v_accvgpr_read_b32 v187, a27
    v_mul_f32 v184, v184, v253
    v_mfma_f32_16x16x32_bf16 a[44:47], a[204:207], v[104:107], a[44:47]
    ds_read_b64_tr_b16 a[198:199], v240 offset:1608
    v_mul_f32 v185, v185, v253
    v_mul_f32 v186, v186, v253
    v_mul_f32 v187, v187, v253
    v_cvt_pk_bf16_f32 v172, v184, v185
    v_cvt_pk_bf16_f32 v173, v186, v187
    v_mfma_f32_16x16x32_bf16 a[84:87], a[204:207], v[112:115], a[84:87]
    v_accvgpr_read_b32 v188, a28
    v_accvgpr_read_b32 v189, a29
    v_accvgpr_read_b32 v190, a30
    v_accvgpr_read_b32 v191, a31
    v_mul_f32 v188, v188, v253
    v_mfma_f32_16x16x32_bf16 a[92:95], a[204:207], v[120:123], a[92:95]
    v_mul_f32 v189, v189, v253
    v_mul_f32 v190, v190, v253
    v_mul_f32 v191, v191, v253
    v_cvt_pk_bf16_f32 v174, v188, v189
    v_cvt_pk_bf16_f32 v175, v190, v191
    s_waitcnt lgkmcnt(4)
    v_mfma_f32_16x16x32_bf16 a[32:35], a[208:211], v[132:135], a[32:35]
    ds_read_b64_tr_b16 a[200:201], v240 offset:13504
    s_mov_b64 vcc, s[12:13]
    v_cndmask_b32_dpp v224, v168, v160, vcc quad_perm:[1,0,3,2] row_mask:0xf bank_mask:0xf
    v_cndmask_b32_dpp v225, v169, v161, vcc quad_perm:[1,0,3,2] row_mask:0xf bank_mask:0xf
    v_cndmask_b32_dpp v226, v170, v162, vcc quad_perm:[1,0,3,2] row_mask:0xf bank_mask:0xf
    v_cndmask_b32_dpp v227, v171, v163, vcc quad_perm:[1,0,3,2] row_mask:0xf bank_mask:0xf
    v_mfma_f32_16x16x32_bf16 a[40:43], a[208:211], v[140:143], a[40:43]
    ds_read_b64_tr_b16 a[202:203], v240 offset:14016
    s_mov_b64 vcc, s[14:15]
    v_cndmask_b32_dpp v168, v160, v168, vcc quad_perm:[1,0,3,2] row_mask:0xf bank_mask:0xf
    v_cndmask_b32_dpp v169, v161, v169, vcc quad_perm:[1,0,3,2] row_mask:0xf bank_mask:0xf
    v_cndmask_b32_dpp v170, v162, v170, vcc quad_perm:[1,0,3,2] row_mask:0xf bank_mask:0xf
    v_cndmask_b32_dpp v171, v163, v171, vcc quad_perm:[1,0,3,2] row_mask:0xf bank_mask:0xf
    v_mfma_f32_16x16x32_bf16 a[80:83], a[208:211], v[148:151], a[80:83]
    s_mov_b64 vcc, s[12:13]
    v_cndmask_b32_dpp v160, v172, v164, vcc quad_perm:[1,0,3,2] row_mask:0xf bank_mask:0xf
    v_cndmask_b32_dpp v161, v173, v165, vcc quad_perm:[1,0,3,2] row_mask:0xf bank_mask:0xf
    v_cndmask_b32_dpp v162, v174, v166, vcc quad_perm:[1,0,3,2] row_mask:0xf bank_mask:0xf
    v_cndmask_b32_dpp v163, v175, v167, vcc quad_perm:[1,0,3,2] row_mask:0xf bank_mask:0xf
    v_mfma_f32_16x16x32_bf16 a[88:91], a[208:211], v[156:159], a[88:91]
    s_mov_b64 vcc, s[14:15]
    v_cndmask_b32_dpp v172, v164, v172, vcc quad_perm:[1,0,3,2] row_mask:0xf bank_mask:0xf
    v_cndmask_b32_dpp v173, v165, v173, vcc quad_perm:[1,0,3,2] row_mask:0xf bank_mask:0xf
    v_cndmask_b32_dpp v174, v166, v174, vcc quad_perm:[1,0,3,2] row_mask:0xf bank_mask:0xf
    v_cndmask_b32_dpp v175, v167, v175, vcc quad_perm:[1,0,3,2] row_mask:0xf bank_mask:0xf
    v_mfma_f32_16x16x32_bf16 a[36:39], a[212:215], v[132:135], a[36:39]
    ds_read_b64_tr_b16 a[204:205], v240 offset:13512
    buffer_store_dwordx4 v[224:227], v243, s[16:19], s44 offen nt
    v_accvgpr_read_b32 v216, a48
    v_accvgpr_read_b32 v217, a49
    v_accvgpr_read_b32 v218, a50
    v_accvgpr_read_b32 v219, a51
    v_mfma_f32_16x16x32_bf16 a[44:47], a[212:215], v[140:143], a[44:47]
    ds_read_b64_tr_b16 a[206:207], v240 offset:14024
    v_mul_f32 v216, v216, v254
    v_mul_f32 v217, v217, v254
    v_mul_f32 v218, v218, v254
    v_mul_f32 v219, v219, v254
    v_cvt_pk_bf16_f32 v192, v216, v217
    v_mfma_f32_16x16x32_bf16 a[84:87], a[212:215], v[148:151], a[84:87]
    v_cvt_pk_bf16_f32 v193, v218, v219
    v_accvgpr_read_b32 v220, a52
    v_accvgpr_read_b32 v221, a53
    v_accvgpr_read_b32 v222, a54
    v_accvgpr_read_b32 v223, a55
    v_mfma_f32_16x16x32_bf16 a[92:95], a[212:215], v[156:159], a[92:95]
    v_mul_f32 v220, v220, v254
    v_mul_f32 v221, v221, v254
    buffer_store_dwordx4 v[168:171], v243, s[16:19], s44 offen offset:384 nt
    v_mul_f32 v222, v222, v254
    v_mul_f32 v223, v223, v254
    s_waitcnt lgkmcnt(4)
    v_mfma_f32_16x16x32_bf16 v[0:3], a[192:195], v[128:131], v[0:3]
    ds_read_b64_tr_b16 a[208:209], v240 offset:25920
    v_cvt_pk_bf16_f32 v194, v220, v221
    v_cvt_pk_bf16_f32 v195, v222, v223
    v_accvgpr_read_b32 v216, a56
    v_accvgpr_read_b32 v217, a57
    v_accvgpr_read_b32 v218, a58
    v_mfma_f32_16x16x32_bf16 v[8:11], a[192:195], v[136:139], v[8:11]
    ds_read_b64_tr_b16 a[210:211], v240 offset:26432
    v_accvgpr_read_b32 v219, a59
    v_mul_f32 v216, v216, v255
    v_mul_f32 v217, v217, v255
    v_mul_f32 v218, v218, v255
    v_mul_f32 v219, v219, v255
    v_mfma_f32_16x16x32_bf16 v[48:51], a[192:195], v[144:147], v[48:51]
    v_cvt_pk_bf16_f32 v196, v216, v217
    v_cvt_pk_bf16_f32 v197, v218, v219
    v_accvgpr_read_b32 v220, a60
    v_accvgpr_read_b32 v221, a61
    buffer_store_dwordx4 v[160:163], v243, s[16:19], s45 offen nt
    v_mfma_f32_16x16x32_bf16 v[56:59], a[192:195], v[152:155], v[56:59]
    v_accvgpr_read_b32 v222, a62
    v_accvgpr_read_b32 v223, a63
    v_mul_f32 v220, v220, v255
    v_mul_f32 v221, v221, v255
    v_mul_f32 v222, v222, v255
    v_mfma_f32_16x16x32_bf16 v[4:7], a[196:199], v[128:131], v[4:7]
    ds_read_b64_tr_b16 a[212:213], v240 offset:25928
    v_mul_f32 v223, v223, v255
    v_cvt_pk_bf16_f32 v198, v220, v221
    v_cvt_pk_bf16_f32 v199, v222, v223
    v_accvgpr_read_b32 v216, a64
    v_accvgpr_read_b32 v217, a65
    v_mfma_f32_16x16x32_bf16 v[12:15], a[196:199], v[136:139], v[12:15]
    ds_read_b64_tr_b16 a[214:215], v240 offset:26440
    v_accvgpr_read_b32 v218, a66
    v_accvgpr_read_b32 v219, a67
    v_mul_f32 v216, v216, v254
    v_mul_f32 v217, v217, v254
    v_mul_f32 v218, v218, v254
    v_mfma_f32_16x16x32_bf16 v[52:55], a[196:199], v[144:147], v[52:55]
    v_mul_f32 v219, v219, v254
    buffer_store_dwordx4 v[172:175], v243, s[16:19], s45 offen offset:384 nt
    v_cvt_pk_bf16_f32 v200, v216, v217
    v_cvt_pk_bf16_f32 v201, v218, v219
    v_accvgpr_read_b32 v220, a68
    v_mfma_f32_16x16x32_bf16 v[60:63], a[196:199], v[152:155], v[60:63]
    v_accvgpr_read_b32 v221, a69
    v_accvgpr_read_b32 v222, a70
    v_accvgpr_read_b32 v223, a71
    v_mul_f32 v220, v220, v254
    v_mul_f32 v221, v221, v254
    s_waitcnt lgkmcnt(4)
    v_mfma_f32_16x16x32_bf16 v[0:3], a[200:203], v[96:99], v[0:3]
    ds_read_b64_tr_b16 a[192:193], v240 offset:2048
    v_mul_f32 v222, v222, v254
    v_mul_f32 v223, v223, v254
    v_cvt_pk_bf16_f32 v202, v220, v221
    v_cvt_pk_bf16_f32 v203, v222, v223
    v_accvgpr_read_b32 v216, a72
    v_mfma_f32_16x16x32_bf16 v[8:11], a[200:203], v[104:107], v[8:11]
    ds_read_b64_tr_b16 a[194:195], v240 offset:2560
    v_accvgpr_read_b32 v217, a73
    v_accvgpr_read_b32 v218, a74
    v_accvgpr_read_b32 v219, a75
    v_mul_f32 v216, v216, v255
    v_mul_f32 v217, v217, v255
    v_mfma_f32_16x16x32_bf16 v[48:51], a[200:203], v[112:115], v[48:51]
    v_mul_f32 v218, v218, v255
    v_mul_f32 v219, v219, v255
    v_cvt_pk_bf16_f32 v204, v216, v217
    v_cvt_pk_bf16_f32 v205, v218, v219
    v_accvgpr_read_b32 v220, a76
    v_mfma_f32_16x16x32_bf16 v[56:59], a[200:203], v[120:123], v[56:59]
    v_accvgpr_read_b32 v221, a77
    v_accvgpr_read_b32 v222, a78
    v_accvgpr_read_b32 v223, a79
    v_mul_f32 v220, v220, v255
    v_mul_f32 v221, v221, v255
    v_mfma_f32_16x16x32_bf16 v[4:7], a[204:207], v[96:99], v[4:7]
    ds_read_b64_tr_b16 a[196:197], v240 offset:2056
    v_mul_f32 v222, v222, v255
    v_mul_f32 v223, v223, v255
    v_cvt_pk_bf16_f32 v206, v220, v221
    v_cvt_pk_bf16_f32 v207, v222, v223
    s_mov_b64 vcc, s[12:13]
    v_mfma_f32_16x16x32_bf16 v[12:15], a[204:207], v[104:107], v[12:15]
    ds_read_b64_tr_b16 a[198:199], v240 offset:2568
    v_cndmask_b32_dpp v228, v200, v192, vcc quad_perm:[1,0,3,2] row_mask:0xf bank_mask:0xf
    v_cndmask_b32_dpp v229, v201, v193, vcc quad_perm:[1,0,3,2] row_mask:0xf bank_mask:0xf
    v_cndmask_b32_dpp v230, v202, v194, vcc quad_perm:[1,0,3,2] row_mask:0xf bank_mask:0xf
    v_cndmask_b32_dpp v231, v203, v195, vcc quad_perm:[1,0,3,2] row_mask:0xf bank_mask:0xf
    s_mov_b64 vcc, s[14:15]
    v_mfma_f32_16x16x32_bf16 v[52:55], a[204:207], v[112:115], v[52:55]
    v_cndmask_b32_dpp v200, v192, v200, vcc quad_perm:[1,0,3,2] row_mask:0xf bank_mask:0xf
    v_cndmask_b32_dpp v201, v193, v201, vcc quad_perm:[1,0,3,2] row_mask:0xf bank_mask:0xf
    v_cndmask_b32_dpp v202, v194, v202, vcc quad_perm:[1,0,3,2] row_mask:0xf bank_mask:0xf
    v_cndmask_b32_dpp v203, v195, v203, vcc quad_perm:[1,0,3,2] row_mask:0xf bank_mask:0xf
    s_mov_b64 vcc, s[12:13]
    v_mfma_f32_16x16x32_bf16 v[60:63], a[204:207], v[120:123], v[60:63]
    v_cndmask_b32_dpp v192, v204, v196, vcc quad_perm:[1,0,3,2] row_mask:0xf bank_mask:0xf
    v_cndmask_b32_dpp v193, v205, v197, vcc quad_perm:[1,0,3,2] row_mask:0xf bank_mask:0xf
    v_cndmask_b32_dpp v194, v206, v198, vcc quad_perm:[1,0,3,2] row_mask:0xf bank_mask:0xf
    v_cndmask_b32_dpp v195, v207, v199, vcc quad_perm:[1,0,3,2] row_mask:0xf bank_mask:0xf
    s_mov_b64 vcc, s[14:15]
    s_waitcnt lgkmcnt(4)
    v_mfma_f32_16x16x32_bf16 v[0:3], a[208:211], v[132:135], v[0:3]
    ds_read_b64_tr_b16 a[200:201], v240 offset:14464
    v_cndmask_b32_dpp v204, v196, v204, vcc quad_perm:[1,0,3,2] row_mask:0xf bank_mask:0xf
    v_cndmask_b32_dpp v205, v197, v205, vcc quad_perm:[1,0,3,2] row_mask:0xf bank_mask:0xf
    v_cndmask_b32_dpp v206, v198, v206, vcc quad_perm:[1,0,3,2] row_mask:0xf bank_mask:0xf
    v_cndmask_b32_dpp v207, v199, v207, vcc quad_perm:[1,0,3,2] row_mask:0xf bank_mask:0xf
    buffer_store_dwordx4 v[228:231], v243, s[16:19], s46 offen nt
    v_mfma_f32_16x16x32_bf16 v[8:11], a[208:211], v[140:143], v[8:11]
    ds_read_b64_tr_b16 a[202:203], v240 offset:14976
    v_accvgpr_read_b32 v184, a32
    v_accvgpr_read_b32 v185, a33
    v_accvgpr_read_b32 v186, a34
    v_accvgpr_read_b32 v187, a35
    v_mul_f32 v184, v184, v252
    v_mfma_f32_16x16x32_bf16 v[48:51], a[208:211], v[148:151], v[48:51]
    v_mul_f32 v185, v185, v252
    v_mul_f32 v186, v186, v252
    v_mul_f32 v187, v187, v252
    v_cvt_pk_bf16_f32 v176, v184, v185
    v_cvt_pk_bf16_f32 v177, v186, v187
    v_mfma_f32_16x16x32_bf16 v[56:59], a[208:211], v[156:159], v[56:59]
    v_accvgpr_read_b32 v188, a36
    v_accvgpr_read_b32 v189, a37
    v_accvgpr_read_b32 v190, a38
    v_accvgpr_read_b32 v191, a39
    v_mul_f32 v188, v188, v252
    v_mfma_f32_16x16x32_bf16 v[4:7], a[212:215], v[132:135], v[4:7]
    ds_read_b64_tr_b16 a[204:205], v240 offset:14472
    v_mul_f32 v189, v189, v252
    buffer_store_dwordx4 v[200:203], v243, s[16:19], s46 offen offset:384 nt
    v_mul_f32 v190, v190, v252
    v_mul_f32 v191, v191, v252
    v_cvt_pk_bf16_f32 v178, v188, v189
    v_mfma_f32_16x16x32_bf16 v[12:15], a[212:215], v[140:143], v[12:15]
    ds_read_b64_tr_b16 a[206:207], v240 offset:14984
    v_cvt_pk_bf16_f32 v179, v190, v191
    v_accvgpr_read_b32 v184, a40
    v_accvgpr_read_b32 v185, a41
    v_accvgpr_read_b32 v186, a42
    v_accvgpr_read_b32 v187, a43
    v_mfma_f32_16x16x32_bf16 v[52:55], a[212:215], v[148:151], v[52:55]
    v_mul_f32 v184, v184, v253
    v_mul_f32 v185, v185, v253
    v_mul_f32 v186, v186, v253
    v_mul_f32 v187, v187, v253
    v_cvt_pk_bf16_f32 v180, v184, v185
    v_mfma_f32_16x16x32_bf16 v[60:63], a[212:215], v[156:159], v[60:63]
    v_cvt_pk_bf16_f32 v181, v186, v187
    v_accvgpr_read_b32 v188, a44
    v_accvgpr_read_b32 v189, a45
    buffer_store_dwordx4 v[192:195], v243, s[16:19], s47 offen nt
    v_accvgpr_read_b32 v190, a46
    s_waitcnt lgkmcnt(4)
    v_mfma_f32_16x16x32_bf16 v[16:19], a[192:195], v[128:131], v[16:19]
    ds_read_b64_tr_b16 a[208:209], v240 offset:26880
    v_accvgpr_read_b32 v191, a47
    v_mul_f32 v188, v188, v253
    v_mul_f32 v189, v189, v253
    v_mul_f32 v190, v190, v253
    v_mul_f32 v191, v191, v253
    v_mfma_f32_16x16x32_bf16 v[24:27], a[192:195], v[136:139], v[24:27]
    ds_read_b64_tr_b16 a[210:211], v240 offset:27392
    v_cvt_pk_bf16_f32 v182, v188, v189
    v_cvt_pk_bf16_f32 v183, v190, v191
    v_mul_f32 v0, v0, v252
    v_mul_f32 v1, v1, v252
    v_mul_f32 v2, v2, v252
    v_mfma_f32_16x16x32_bf16 v[64:67], a[192:195], v[144:147], v[64:67]
    v_mul_f32 v3, v3, v252
    v_cvt_pk_bf16_f32 v184, v0, v1
    v_cvt_pk_bf16_f32 v185, v2, v3
    v_mul_f32 v4, v4, v252
    v_mul_f32 v5, v5, v252
    v_mfma_f32_16x16x32_bf16 v[72:75], a[192:195], v[152:155], v[72:75]
    buffer_store_dwordx4 v[204:207], v243, s[16:19], s47 offen offset:384 nt
    v_mul_f32 v6, v6, v252
    v_mul_f32 v7, v7, v252
    v_cvt_pk_bf16_f32 v186, v4, v5
    v_cvt_pk_bf16_f32 v187, v6, v7
    v_mfma_f32_16x16x32_bf16 v[20:23], a[196:199], v[128:131], v[20:23]
    ds_read_b64_tr_b16 a[212:213], v240 offset:26888
    v_mul_f32 v8, v8, v253
    v_mul_f32 v9, v9, v253
    v_mul_f32 v10, v10, v253
    v_mul_f32 v11, v11, v253
    v_cvt_pk_bf16_f32 v188, v8, v9
    v_mfma_f32_16x16x32_bf16 v[28:31], a[196:199], v[136:139], v[28:31]
    ds_read_b64_tr_b16 a[214:215], v240 offset:27400
    v_cvt_pk_bf16_f32 v189, v10, v11
    v_mul_f32 v12, v12, v253
    v_mul_f32 v13, v13, v253
    v_mul_f32 v14, v14, v253
    v_mul_f32 v15, v15, v253
    v_mfma_f32_16x16x32_bf16 v[68:71], a[196:199], v[144:147], v[68:71]
    v_cvt_pk_bf16_f32 v190, v12, v13
    v_cvt_pk_bf16_f32 v191, v14, v15
    s_mov_b64 vcc, s[12:13]
    v_cndmask_b32_dpp v224, v184, v176, vcc quad_perm:[1,0,3,2] row_mask:0xf bank_mask:0xf
    v_cndmask_b32_dpp v225, v185, v177, vcc quad_perm:[1,0,3,2] row_mask:0xf bank_mask:0xf
    v_mfma_f32_16x16x32_bf16 v[76:79], a[196:199], v[152:155], v[76:79]
    v_cndmask_b32_dpp v226, v186, v178, vcc quad_perm:[1,0,3,2] row_mask:0xf bank_mask:0xf
    v_cndmask_b32_dpp v227, v187, v179, vcc quad_perm:[1,0,3,2] row_mask:0xf bank_mask:0xf
    s_mov_b64 vcc, s[14:15]
    v_cndmask_b32_dpp v184, v176, v184, vcc quad_perm:[1,0,3,2] row_mask:0xf bank_mask:0xf
    v_cndmask_b32_dpp v185, v177, v185, vcc quad_perm:[1,0,3,2] row_mask:0xf bank_mask:0xf
    s_waitcnt lgkmcnt(4)
    v_mfma_f32_16x16x32_bf16 v[16:19], a[200:203], v[96:99], v[16:19]
    ds_read_b64_tr_b16 a[192:193], v240 offset:2112
    v_cndmask_b32_dpp v186, v178, v186, vcc quad_perm:[1,0,3,2] row_mask:0xf bank_mask:0xf
    v_cndmask_b32_dpp v187, v179, v187, vcc quad_perm:[1,0,3,2] row_mask:0xf bank_mask:0xf
    s_mov_b64 vcc, s[12:13]
    v_cndmask_b32_dpp v176, v188, v180, vcc quad_perm:[1,0,3,2] row_mask:0xf bank_mask:0xf
    v_cndmask_b32_dpp v177, v189, v181, vcc quad_perm:[1,0,3,2] row_mask:0xf bank_mask:0xf
    v_mfma_f32_16x16x32_bf16 v[24:27], a[200:203], v[104:107], v[24:27]
    ds_read_b64_tr_b16 a[194:195], v240 offset:2624
    v_cndmask_b32_dpp v178, v190, v182, vcc quad_perm:[1,0,3,2] row_mask:0xf bank_mask:0xf
    v_cndmask_b32_dpp v179, v191, v183, vcc quad_perm:[1,0,3,2] row_mask:0xf bank_mask:0xf
    s_mov_b64 vcc, s[14:15]
    v_cndmask_b32_dpp v188, v180, v188, vcc quad_perm:[1,0,3,2] row_mask:0xf bank_mask:0xf
    v_cndmask_b32_dpp v189, v181, v189, vcc quad_perm:[1,0,3,2] row_mask:0xf bank_mask:0xf
    v_mfma_f32_16x16x32_bf16 v[64:67], a[200:203], v[112:115], v[64:67]
    v_cndmask_b32_dpp v190, v182, v190, vcc quad_perm:[1,0,3,2] row_mask:0xf bank_mask:0xf
    v_cndmask_b32_dpp v191, v183, v191, vcc quad_perm:[1,0,3,2] row_mask:0xf bank_mask:0xf
    buffer_store_dwordx4 v[224:227], v243, s[16:19], s44 offen offset:128 nt
    v_accvgpr_read_b32 v216, a80
    v_accvgpr_read_b32 v217, a81
    v_mfma_f32_16x16x32_bf16 v[72:75], a[200:203], v[120:123], v[72:75]
    v_accvgpr_read_b32 v218, a82
    v_accvgpr_read_b32 v219, a83
    v_mul_f32 v216, v216, v254
    v_mul_f32 v217, v217, v254
    v_mul_f32 v218, v218, v254
    v_mfma_f32_16x16x32_bf16 v[20:23], a[204:207], v[96:99], v[20:23]
    ds_read_b64_tr_b16 a[196:197], v240 offset:2120
    v_mul_f32 v219, v219, v254
    v_cvt_pk_bf16_f32 v208, v216, v217
    v_cvt_pk_bf16_f32 v209, v218, v219
    v_accvgpr_read_b32 v220, a84
    v_accvgpr_read_b32 v221, a85
    v_mfma_f32_16x16x32_bf16 v[28:31], a[204:207], v[104:107], v[28:31]
    ds_read_b64_tr_b16 a[198:199], v240 offset:2632
    v_accvgpr_read_b32 v222, a86
    v_accvgpr_read_b32 v223, a87
    v_mul_f32 v220, v220, v254
    v_mul_f32 v221, v221, v254
    buffer_store_dwordx4 v[184:187], v243, s[16:19], s44 offen offset:512 nt
    v_mfma_f32_16x16x32_bf16 v[68:71], a[204:207], v[112:115], v[68:71]
    v_mul_f32 v222, v222, v254
    v_mul_f32 v223, v223, v254
    v_cvt_pk_bf16_f32 v210, v220, v221
    v_cvt_pk_bf16_f32 v211, v222, v223
    v_accvgpr_read_b32 v216, a88
    v_mfma_f32_16x16x32_bf16 v[76:79], a[204:207], v[120:123], v[76:79]
    v_accvgpr_read_b32 v217, a89
    v_accvgpr_read_b32 v218, a90
    v_accvgpr_read_b32 v219, a91
    v_mul_f32 v216, v216, v255
    v_mul_f32 v217, v217, v255
    s_waitcnt lgkmcnt(4)
    v_mfma_f32_16x16x32_bf16 v[16:19], a[208:211], v[132:135], v[16:19]
    ds_read_b64_tr_b16 a[200:201], v240 offset:14528
    v_mul_f32 v218, v218, v255
    v_mul_f32 v219, v219, v255
    v_cvt_pk_bf16_f32 v212, v216, v217
    v_cvt_pk_bf16_f32 v213, v218, v219
    v_accvgpr_read_b32 v220, a92
    v_mfma_f32_16x16x32_bf16 v[24:27], a[208:211], v[140:143], v[24:27]
    ds_read_b64_tr_b16 a[202:203], v240 offset:15040
    v_accvgpr_read_b32 v221, a93
    buffer_store_dwordx4 v[176:179], v243, s[16:19], s45 offen offset:128 nt
    v_accvgpr_read_b32 v222, a94
    v_accvgpr_read_b32 v223, a95
    v_mul_f32 v220, v220, v255
    v_mfma_f32_16x16x32_bf16 v[64:67], a[208:211], v[148:151], v[64:67]
    v_mul_f32 v221, v221, v255
    v_mul_f32 v222, v222, v255
    v_mul_f32 v223, v223, v255
    v_cvt_pk_bf16_f32 v214, v220, v221
    v_cvt_pk_bf16_f32 v215, v222, v223
    v_mfma_f32_16x16x32_bf16 v[72:75], a[208:211], v[156:159], v[72:75]
    v_mul_f32 v48, v48, v254
    v_mul_f32 v49, v49, v254
    v_mul_f32 v50, v50, v254
    v_mul_f32 v51, v51, v254
    v_cvt_pk_bf16_f32 v216, v48, v49
    v_mfma_f32_16x16x32_bf16 v[20:23], a[212:215], v[132:135], v[20:23]
    ds_read_b64_tr_b16 a[204:205], v240 offset:14536
    v_cvt_pk_bf16_f32 v217, v50, v51
    v_mul_f32 v52, v52, v254
    v_mul_f32 v53, v53, v254
    buffer_store_dwordx4 v[188:191], v243, s[16:19], s45 offen offset:512 nt
    v_mul_f32 v54, v54, v254
    v_mfma_f32_16x16x32_bf16 v[28:31], a[212:215], v[140:143], v[28:31]
    ds_read_b64_tr_b16 a[206:207], v240 offset:15048
    v_mul_f32 v55, v55, v254
    v_cvt_pk_bf16_f32 v218, v52, v53
    v_cvt_pk_bf16_f32 v219, v54, v55
    v_mul_f32 v56, v56, v255
    v_mul_f32 v57, v57, v255
    v_mfma_f32_16x16x32_bf16 v[68:71], a[212:215], v[148:151], v[68:71]
    v_mul_f32 v58, v58, v255
    v_mul_f32 v59, v59, v255
    v_cvt_pk_bf16_f32 v220, v56, v57
    v_cvt_pk_bf16_f32 v221, v58, v59
    v_mul_f32 v60, v60, v255
    v_mfma_f32_16x16x32_bf16 v[76:79], a[212:215], v[156:159], v[76:79]
    v_mul_f32 v61, v61, v255
    v_mul_f32 v62, v62, v255
    v_mul_f32 v63, v63, v255
    v_cvt_pk_bf16_f32 v222, v60, v61
    v_cvt_pk_bf16_f32 v223, v62, v63
    s_waitcnt lgkmcnt(4)
    v_mfma_f32_16x16x32_bf16 v[32:35], a[192:195], v[128:131], v[32:35]
    ds_read_b64_tr_b16 a[208:209], v240 offset:26944
    s_mov_b64 vcc, s[12:13]
    v_cndmask_b32_dpp v228, v216, v208, vcc quad_perm:[1,0,3,2] row_mask:0xf bank_mask:0xf
    v_cndmask_b32_dpp v229, v217, v209, vcc quad_perm:[1,0,3,2] row_mask:0xf bank_mask:0xf
    v_cndmask_b32_dpp v230, v218, v210, vcc quad_perm:[1,0,3,2] row_mask:0xf bank_mask:0xf
    v_cndmask_b32_dpp v231, v219, v211, vcc quad_perm:[1,0,3,2] row_mask:0xf bank_mask:0xf
    v_mfma_f32_16x16x32_bf16 v[40:43], a[192:195], v[136:139], v[40:43]
    ds_read_b64_tr_b16 a[210:211], v240 offset:27456
    s_mov_b64 vcc, s[14:15]
    v_cndmask_b32_dpp v216, v208, v216, vcc quad_perm:[1,0,3,2] row_mask:0xf bank_mask:0xf
    v_cndmask_b32_dpp v217, v209, v217, vcc quad_perm:[1,0,3,2] row_mask:0xf bank_mask:0xf
    v_cndmask_b32_dpp v218, v210, v218, vcc quad_perm:[1,0,3,2] row_mask:0xf bank_mask:0xf
    v_cndmask_b32_dpp v219, v211, v219, vcc quad_perm:[1,0,3,2] row_mask:0xf bank_mask:0xf
    v_mfma_f32_16x16x32_bf16 v[80:83], a[192:195], v[144:147], v[80:83]
    s_mov_b64 vcc, s[12:13]
    v_cndmask_b32_dpp v208, v220, v212, vcc quad_perm:[1,0,3,2] row_mask:0xf bank_mask:0xf
    v_cndmask_b32_dpp v209, v221, v213, vcc quad_perm:[1,0,3,2] row_mask:0xf bank_mask:0xf
    v_cndmask_b32_dpp v210, v222, v214, vcc quad_perm:[1,0,3,2] row_mask:0xf bank_mask:0xf
    v_cndmask_b32_dpp v211, v223, v215, vcc quad_perm:[1,0,3,2] row_mask:0xf bank_mask:0xf
    v_mfma_f32_16x16x32_bf16 v[88:91], a[192:195], v[152:155], v[88:91]
    s_mov_b64 vcc, s[14:15]
    v_cndmask_b32_dpp v220, v212, v220, vcc quad_perm:[1,0,3,2] row_mask:0xf bank_mask:0xf
    v_cndmask_b32_dpp v221, v213, v221, vcc quad_perm:[1,0,3,2] row_mask:0xf bank_mask:0xf
    v_cndmask_b32_dpp v222, v214, v222, vcc quad_perm:[1,0,3,2] row_mask:0xf bank_mask:0xf
    v_cndmask_b32_dpp v223, v215, v223, vcc quad_perm:[1,0,3,2] row_mask:0xf bank_mask:0xf
    v_mfma_f32_16x16x32_bf16 v[36:39], a[196:199], v[128:131], v[36:39]
    ds_read_b64_tr_b16 a[212:213], v240 offset:26952
    buffer_store_dwordx4 v[228:231], v243, s[16:19], s46 offen offset:128 nt
    v_mul_f32 v16, v16, v252
    v_mul_f32 v17, v17, v252
    v_mul_f32 v18, v18, v252
    v_mul_f32 v19, v19, v252
    v_mfma_f32_16x16x32_bf16 v[44:47], a[196:199], v[136:139], v[44:47]
    ds_read_b64_tr_b16 a[214:215], v240 offset:27464
    v_cvt_pk_bf16_f32 v16, v16, v17
    v_cvt_pk_bf16_f32 v17, v18, v19
    v_mul_f32 v20, v20, v252
    v_mul_f32 v21, v21, v252
    v_mul_f32 v22, v22, v252
    v_mfma_f32_16x16x32_bf16 v[84:87], a[196:199], v[144:147], v[84:87]
    v_mul_f32 v23, v23, v252
    v_cvt_pk_bf16_f32 v18, v20, v21
    v_cvt_pk_bf16_f32 v19, v22, v23
    v_mul_f32 v24, v24, v253
    v_mul_f32 v25, v25, v253
    v_mfma_f32_16x16x32_bf16 v[92:95], a[196:199], v[152:155], v[92:95]
    v_mul_f32 v26, v26, v253
    v_mul_f32 v27, v27, v253
    buffer_store_dwordx4 v[216:219], v243, s[16:19], s46 offen offset:512 nt
    v_cvt_pk_bf16_f32 v20, v24, v25
    v_cvt_pk_bf16_f32 v21, v26, v27
    s_waitcnt lgkmcnt(4)
    v_mfma_f32_16x16x32_bf16 v[32:35], a[200:203], v[96:99], v[32:35]
    v_mul_f32 v28, v28, v253
    v_mul_f32 v29, v29, v253
    v_mul_f32 v30, v30, v253
    v_mul_f32 v31, v31, v253
    v_cvt_pk_bf16_f32 v22, v28, v29
    v_mfma_f32_16x16x32_bf16 v[40:43], a[200:203], v[104:107], v[40:43]
    v_cvt_pk_bf16_f32 v23, v30, v31
    v_mul_f32 v64, v64, v254
    v_mul_f32 v65, v65, v254
    v_mul_f32 v66, v66, v254
    v_mul_f32 v67, v67, v254
    v_mfma_f32_16x16x32_bf16 v[80:83], a[200:203], v[112:115], v[80:83]
    v_cvt_pk_bf16_f32 v64, v64, v65
    v_cvt_pk_bf16_f32 v65, v66, v67
    v_mul_f32 v68, v68, v254
    v_mul_f32 v69, v69, v254
    buffer_store_dwordx4 v[208:211], v243, s[16:19], s47 offen offset:128 nt
    v_mfma_f32_16x16x32_bf16 v[88:91], a[200:203], v[120:123], v[88:91]
    v_mul_f32 v70, v70, v254
    v_mul_f32 v71, v71, v254
    v_cvt_pk_bf16_f32 v66, v68, v69
    v_cvt_pk_bf16_f32 v67, v70, v71
    v_mul_f32 v72, v72, v255
    v_mfma_f32_16x16x32_bf16 v[36:39], a[204:207], v[96:99], v[36:39]
    v_mul_f32 v73, v73, v255
    v_mul_f32 v74, v74, v255
    v_mul_f32 v75, v75, v255
    v_cvt_pk_bf16_f32 v68, v72, v73
    v_cvt_pk_bf16_f32 v69, v74, v75
    v_mfma_f32_16x16x32_bf16 v[44:47], a[204:207], v[104:107], v[44:47]
    v_mul_f32 v76, v76, v255
    v_mul_f32 v77, v77, v255
    v_mul_f32 v78, v78, v255
    v_mul_f32 v79, v79, v255
    v_cvt_pk_bf16_f32 v70, v76, v77
    v_mfma_f32_16x16x32_bf16 v[84:87], a[204:207], v[112:115], v[84:87]
    v_cvt_pk_bf16_f32 v71, v78, v79
    buffer_store_dwordx4 v[220:223], v243, s[16:19], s47 offen offset:512 nt
    v_mfma_f32_16x16x32_bf16 v[92:95], a[204:207], v[120:123], v[92:95]
    s_waitcnt lgkmcnt(0)
    v_mfma_f32_16x16x32_bf16 v[32:35], a[208:211], v[132:135], v[32:35]
    v_mfma_f32_16x16x32_bf16 v[40:43], a[208:211], v[140:143], v[40:43]
    v_mfma_f32_16x16x32_bf16 v[80:83], a[208:211], v[148:151], v[80:83]
    v_mfma_f32_16x16x32_bf16 v[88:91], a[208:211], v[156:159], v[88:91]
    v_mfma_f32_16x16x32_bf16 v[36:39], a[212:215], v[132:135], v[36:39]
    v_mfma_f32_16x16x32_bf16 v[44:47], a[212:215], v[140:143], v[44:47]
    v_mfma_f32_16x16x32_bf16 v[84:87], a[212:215], v[148:151], v[84:87]
    v_mfma_f32_16x16x32_bf16 v[92:95], a[212:215], v[156:159], v[92:95]
    s_nop 0
    v_mul_f32 v32, v32, v252
    v_mul_f32 v33, v33, v252
    v_mul_f32 v34, v34, v252
    v_mul_f32 v35, v35, v252
    v_cvt_pk_bf16_f32 v32, v32, v33
    v_cvt_pk_bf16_f32 v33, v34, v35
    v_mul_f32 v36, v36, v252
    v_mul_f32 v37, v37, v252
    v_mul_f32 v38, v38, v252
    v_mul_f32 v39, v39, v252
    v_cvt_pk_bf16_f32 v34, v36, v37
    v_cvt_pk_bf16_f32 v35, v38, v39
    v_mul_f32 v40, v40, v253
    v_mul_f32 v41, v41, v253
    v_mul_f32 v42, v42, v253
    v_mul_f32 v43, v43, v253
    v_cvt_pk_bf16_f32 v36, v40, v41
    v_cvt_pk_bf16_f32 v37, v42, v43
    v_mul_f32 v44, v44, v253
    v_mul_f32 v45, v45, v253
    v_mul_f32 v46, v46, v253
    v_mul_f32 v47, v47, v253
    v_cvt_pk_bf16_f32 v38, v44, v45
    v_cvt_pk_bf16_f32 v39, v46, v47
    s_mov_b64 vcc, s[12:13]
    v_cndmask_b32_dpp v24, v32, v16, vcc quad_perm:[1,0,3,2] row_mask:0xf bank_mask:0xf
    v_cndmask_b32_dpp v25, v33, v17, vcc quad_perm:[1,0,3,2] row_mask:0xf bank_mask:0xf
    v_cndmask_b32_dpp v26, v34, v18, vcc quad_perm:[1,0,3,2] row_mask:0xf bank_mask:0xf
    v_cndmask_b32_dpp v27, v35, v19, vcc quad_perm:[1,0,3,2] row_mask:0xf bank_mask:0xf
    s_mov_b64 vcc, s[14:15]
    v_cndmask_b32_dpp v32, v16, v32, vcc quad_perm:[1,0,3,2] row_mask:0xf bank_mask:0xf
    v_cndmask_b32_dpp v33, v17, v33, vcc quad_perm:[1,0,3,2] row_mask:0xf bank_mask:0xf
    v_cndmask_b32_dpp v34, v18, v34, vcc quad_perm:[1,0,3,2] row_mask:0xf bank_mask:0xf
    v_cndmask_b32_dpp v35, v19, v35, vcc quad_perm:[1,0,3,2] row_mask:0xf bank_mask:0xf
    buffer_store_dwordx4 v[24:27], v243, s[16:19], s44 offen offset:256 nt
    s_mov_b64 vcc, s[12:13]
    v_cndmask_b32_dpp v28, v36, v20, vcc quad_perm:[1,0,3,2] row_mask:0xf bank_mask:0xf
    v_cndmask_b32_dpp v29, v37, v21, vcc quad_perm:[1,0,3,2] row_mask:0xf bank_mask:0xf
    v_cndmask_b32_dpp v30, v38, v22, vcc quad_perm:[1,0,3,2] row_mask:0xf bank_mask:0xf
    v_cndmask_b32_dpp v31, v39, v23, vcc quad_perm:[1,0,3,2] row_mask:0xf bank_mask:0xf
    s_mov_b64 vcc, s[14:15]
    v_cndmask_b32_dpp v36, v20, v36, vcc quad_perm:[1,0,3,2] row_mask:0xf bank_mask:0xf
    v_cndmask_b32_dpp v37, v21, v37, vcc quad_perm:[1,0,3,2] row_mask:0xf bank_mask:0xf
    v_cndmask_b32_dpp v38, v22, v38, vcc quad_perm:[1,0,3,2] row_mask:0xf bank_mask:0xf
    v_cndmask_b32_dpp v39, v23, v39, vcc quad_perm:[1,0,3,2] row_mask:0xf bank_mask:0xf
    v_mul_f32 v80, v80, v254
    v_mul_f32 v81, v81, v254
    v_mul_f32 v82, v82, v254
    v_mul_f32 v83, v83, v254
    v_cvt_pk_bf16_f32 v80, v80, v81
    v_cvt_pk_bf16_f32 v81, v82, v83
    buffer_store_dwordx4 v[32:35], v243, s[16:19], s44 offen offset:640 nt
    v_mul_f32 v84, v84, v254
    v_mul_f32 v85, v85, v254
    v_mul_f32 v86, v86, v254
    v_mul_f32 v87, v87, v254
    v_cvt_pk_bf16_f32 v82, v84, v85
    v_cvt_pk_bf16_f32 v83, v86, v87
    v_mul_f32 v88, v88, v255
    v_mul_f32 v89, v89, v255
    v_mul_f32 v90, v90, v255
    v_mul_f32 v91, v91, v255
    v_cvt_pk_bf16_f32 v84, v88, v89
    v_cvt_pk_bf16_f32 v85, v90, v91
    v_mul_f32 v92, v92, v255
    v_mul_f32 v93, v93, v255
    v_mul_f32 v94, v94, v255
    v_mul_f32 v95, v95, v255
    buffer_store_dwordx4 v[28:31], v243, s[16:19], s45 offen offset:256 nt
    v_cvt_pk_bf16_f32 v86, v92, v93
    v_cvt_pk_bf16_f32 v87, v94, v95
    s_mov_b64 vcc, s[12:13]
    v_cndmask_b32_dpp v72, v80, v64, vcc quad_perm:[1,0,3,2] row_mask:0xf bank_mask:0xf
    v_cndmask_b32_dpp v73, v81, v65, vcc quad_perm:[1,0,3,2] row_mask:0xf bank_mask:0xf
    v_cndmask_b32_dpp v74, v82, v66, vcc quad_perm:[1,0,3,2] row_mask:0xf bank_mask:0xf
    v_cndmask_b32_dpp v75, v83, v67, vcc quad_perm:[1,0,3,2] row_mask:0xf bank_mask:0xf
    s_mov_b64 vcc, s[14:15]
    v_cndmask_b32_dpp v80, v64, v80, vcc quad_perm:[1,0,3,2] row_mask:0xf bank_mask:0xf
    v_cndmask_b32_dpp v81, v65, v81, vcc quad_perm:[1,0,3,2] row_mask:0xf bank_mask:0xf
    v_cndmask_b32_dpp v82, v66, v82, vcc quad_perm:[1,0,3,2] row_mask:0xf bank_mask:0xf
    v_cndmask_b32_dpp v83, v67, v83, vcc quad_perm:[1,0,3,2] row_mask:0xf bank_mask:0xf
    s_mov_b64 vcc, s[12:13]
    v_cndmask_b32_dpp v76, v84, v68, vcc quad_perm:[1,0,3,2] row_mask:0xf bank_mask:0xf
    v_cndmask_b32_dpp v77, v85, v69, vcc quad_perm:[1,0,3,2] row_mask:0xf bank_mask:0xf
    v_cndmask_b32_dpp v78, v86, v70, vcc quad_perm:[1,0,3,2] row_mask:0xf bank_mask:0xf
    buffer_store_dwordx4 v[36:39], v243, s[16:19], s45 offen offset:640 nt
    v_cndmask_b32_dpp v79, v87, v71, vcc quad_perm:[1,0,3,2] row_mask:0xf bank_mask:0xf
    s_mov_b64 vcc, s[14:15]
    v_cndmask_b32_dpp v84, v68, v84, vcc quad_perm:[1,0,3,2] row_mask:0xf bank_mask:0xf
    v_cndmask_b32_dpp v85, v69, v85, vcc quad_perm:[1,0,3,2] row_mask:0xf bank_mask:0xf
    v_cndmask_b32_dpp v86, v70, v86, vcc quad_perm:[1,0,3,2] row_mask:0xf bank_mask:0xf
    v_cndmask_b32_dpp v87, v71, v87, vcc quad_perm:[1,0,3,2] row_mask:0xf bank_mask:0xf
    buffer_store_dwordx4 v[72:75], v243, s[16:19], s46 offen offset:256 nt
    buffer_store_dwordx4 v[80:83], v243, s[16:19], s46 offen offset:640 nt
    buffer_store_dwordx4 v[76:79], v243, s[16:19], s47 offen offset:256 nt
    buffer_store_dwordx4 v[84:87], v243, s[16:19], s47 offen offset:640 nt
L_cend:
    s_cmp_eq_u32 s32, 0
    s_cbranch_scc1 L_end
    s_waitcnt vmcnt(0) lgkmcnt(0)
    s_nop 7
    s_nop 7
    v_mbcnt_lo_u32_b32 v136, -1, 0
    v_mbcnt_hi_u32_b32 v136, -1, v136
    v_lshrrev_b32 v137, 3, v136
    v_mul_u32_u24 v134, 1536, v137
    v_and_b32 v137, 7, v136
    v_lshl_add_u32 v134, v137, 4, v134
    v_bfe_u32 v137, v136, 2, 2
    v_lshlrev_b32 v135, 10, v137
    v_lshrrev_b32 v137, 4, v136
    v_lshl_add_u32 v135, v137, 7, v135
    v_and_b32 v137, 3, v136
    v_lshl_add_u32 v135, v137, 4, v135
    v_add_u32 v135, s38, v135
    L_fb_item:
    s_waitcnt vmcnt(0) lgkmcnt(0)
    s_nop 7
    s_nop 7
    s_ff1_i32_b32 s34, s32
    s_bitset0_b32 s32, s34
    s_and_b32 s35, s34, 1
    s_mul_i32 s35, s35, 12288
    s_lshr_b32 s34, s34, 1
    s_sub_u32 s34, s34, 1
    s_mul_i32 s34, s34, 25165824
    s_sub_u32 s44, s36, s34
    s_sub_u32 s25, s44, s23
    s_add_u32 s26, s25, 6144
    s_add_u32 s44, s44, s35
    s_add_u32 s45, s44, 6144
    s_mov_b32 s27, 16
    s_add_u32 m0, s38, 0
    s_nop 0
    buffer_load_dwordx4 v244, s[4:7], s44 offen lds
    s_add_u32 m0, s38, -2048
    s_nop 0
    buffer_load_dwordx4 v245, s[4:7], s44 offen offset:3072 lds
    s_add_u32 m0, s38, 2048
    s_nop 0
    buffer_load_dwordx4 v244, s[4:7], s45 offen lds
    s_add_u32 m0, s38, 0
    s_nop 0
    buffer_load_dwordx4 v245, s[4:7], s45 offen offset:3072 lds
    s_waitcnt vmcnt(2)
    ds_read_b128 v[160:163], v238
    ds_read_b128 v[164:167], v239
    s_waitcnt vmcnt(0)
    ds_read_b128 v[168:171], v238 offset:2048
    ds_read_b128 v[172:175], v239 offset:2048
    s_add_u32 m0, s38, -128
    s_waitcnt lgkmcnt(2)
    buffer_load_dwordx4 v244, s[4:7], s44 offen offset:128 lds
    s_add_u32 m0, s38, -2176
    s_nop 0
    buffer_load_dwordx4 v245, s[4:7], s44 offen offset:3200 lds
    s_add_u32 m0, s38, 1920
    s_waitcnt lgkmcnt(0)
    buffer_load_dwordx4 v244, s[4:7], s45 offen offset:128 lds
    s_add_u32 m0, s38, -128
    s_nop 0
    buffer_load_dwordx4 v245, s[4:7], s45 offen offset:3200 lds
    s_waitcnt vmcnt(2)
    ds_read_b128 v[176:179], v238
    ds_read_b128 v[180:183], v239
    s_waitcnt vmcnt(0)
    ds_read_b128 v[184:187], v238 offset:2048
    ds_read_b128 v[188:191], v239 offset:2048
    s_add_u32 m0, s38, -256
    s_waitcnt lgkmcnt(2)
    buffer_load_dwordx4 v244, s[4:7], s44 offen offset:256 lds
    s_add_u32 m0, s38, -2304
    s_nop 0
    buffer_load_dwordx4 v245, s[4:7], s44 offen offset:3328 lds
    s_add_u32 m0, s38, 1792
    s_waitcnt lgkmcnt(0)
    buffer_load_dwordx4 v244, s[4:7], s45 offen offset:256 lds
    s_add_u32 m0, s38, -256
    s_nop 0
    buffer_load_dwordx4 v245, s[4:7], s45 offen offset:3328 lds
    s_waitcnt vmcnt(2)
    ds_read_b128 v[192:195], v238
    ds_read_b128 v[196:199], v239
    s_waitcnt vmcnt(0)
    ds_read_b128 v[200:203], v238 offset:2048
    ds_read_b128 v[204:207], v239 offset:2048
    v_mov_b32 v0, 0
    v_mov_b32 v1, 0
    v_mov_b32 v2, 0
    v_mov_b32 v3, 0
    v_mov_b32 v4, 0
    v_mov_b32 v5, 0
    v_mov_b32 v6, 0
    v_mov_b32 v7, 0
    v_mov_b32 v8, 0
    v_mov_b32 v9, 0
    v_mov_b32 v10, 0
    v_mov_b32 v11, 0
    v_mov_b32 v12, 0
    v_mov_b32 v13, 0
    v_mov_b32 v14, 0
    v_mov_b32 v15, 0
    v_mov_b32 v16, 0
    v_mov_b32 v17, 0
    v_mov_b32 v18, 0
    v_mov_b32 v19, 0
    v_mov_b32 v20, 0
    v_mov_b32 v21, 0
    v_mov_b32 v22, 0
    v_mov_b32 v23, 0
    v_mov_b32 v24, 0
    v_mov_b32 v25, 0
    v_mov_b32 v26, 0
    v_mov_b32 v27, 0
    v_mov_b32 v28, 0
    v_mov_b32 v29, 0
    v_mov_b32 v30, 0
    v_mov_b32 v31, 0
    v_mov_b32 v32, 0
    v_mov_b32 v33, 0
    v_mov_b32 v34, 0
    v_mov_b32 v35, 0
    v_mov_b32 v36, 0
    v_mov_b32 v37, 0
    v_mov_b32 v38, 0
    v_mov_b32 v39, 0
    v_mov_b32 v40, 0
    v_mov_b32 v41, 0
    v_mov_b32 v42, 0
    v_mov_b32 v43, 0
    v_mov_b32 v44, 0
    v_mov_b32 v45, 0
    v_mov_b32 v46, 0
    v_mov_b32 v47, 0
    v_mov_b32 v48, 0
    v_mov_b32 v49, 0
    v_mov_b32 v50, 0
    v_mov_b32 v51, 0
    v_mov_b32 v52, 0
    v_mov_b32 v53, 0
    v_mov_b32 v54, 0
    v_mov_b32 v55, 0
    v_mov_b32 v56, 0
    v_mov_b32 v57, 0
    v_mov_b32 v58, 0
    v_mov_b32 v59, 0
    v_mov_b32 v60, 0
    v_mov_b32 v61, 0
    v_mov_b32 v62, 0
    v_mov_b32 v63, 0
    v_mov_b32 v64, 0
    v_mov_b32 v65, 0
    v_mov_b32 v66, 0
    v_mov_b32 v67, 0
    v_mov_b32 v68, 0
    v_mov_b32 v69, 0
    v_mov_b32 v70, 0
    v_mov_b32 v71, 0
    v_mov_b32 v72, 0
    v_mov_b32 v73, 0
    v_mov_b32 v74, 0
    v_mov_b32 v75, 0
    v_mov_b32 v76, 0
    v_mov_b32 v77, 0
    v_mov_b32 v78, 0
    v_mov_b32 v79, 0
    v_mov_b32 v80, 0
    v_mov_b32 v81, 0
    v_mov_b32 v82, 0
    v_mov_b32 v83, 0
    v_mov_b32 v84, 0
    v_mov_b32 v85, 0
    v_mov_b32 v86, 0
    v_mov_b32 v87, 0
    v_mov_b32 v88, 0
    v_mov_b32 v89, 0
    v_mov_b32 v90, 0
    v_mov_b32 v91, 0
    v_mov_b32 v92, 0
    v_mov_b32 v93, 0
    v_mov_b32 v94, 0
    v_mov_b32 v95, 0
    v_mov_b32 v128, 0xff800000
    v_mov_b32 v132, 0
    v_mov_b32 v129, 0xff800000
    v_mov_b32 v133, 0
    L_fb_unit:
    s_waitcnt vmcnt(0) lgkmcnt(0)
    s_nop 7
    s_nop 7
    s_add_u32 m0, s38, 0
    s_waitcnt lgkmcnt(2)
    buffer_load_dwordx4 v244, s[8:11], s25 offen lds
    s_add_u32 m0, s38, -2048
    s_nop 0
    buffer_load_dwordx4 v245, s[8:11], s25 offen offset:3072 lds
    s_add_u32 m0, s38, 2048
    s_waitcnt lgkmcnt(0)
    buffer_load_dwordx4 v244, s[8:11], s26 offen lds
    s_add_u32 m0, s38, 0
    s_nop 0
    buffer_load_dwordx4 v245, s[8:11], s26 offen offset:3072 lds
    s_waitcnt vmcnt(2)
    ds_read_b128 v[112:115], v238
    ds_read_b128 v[116:119], v239
    s_waitcnt vmcnt(0)
    ds_read_b128 v[120:123], v238 offset:2048
    ds_read_b128 v[124:127], v239 offset:2048
    s_waitcnt lgkmcnt(3)
    v_mfma_f32_16x16x32_bf16 v[96:99], v[112:115], v[160:163], 0
    v_mfma_f32_16x16x32_bf16 v[104:107], v[112:115], v[168:171], 0
    s_waitcnt lgkmcnt(2)
    v_mfma_f32_16x16x32_bf16 v[96:99], v[116:119], v[164:167], v[96:99]
    v_mfma_f32_16x16x32_bf16 v[104:107], v[116:119], v[172:175], v[104:107]
    s_waitcnt lgkmcnt(1)
    v_mfma_f32_16x16x32_bf16 v[100:103], v[120:123], v[160:163], 0
    v_mfma_f32_16x16x32_bf16 v[108:111], v[120:123], v[168:171], 0
    s_waitcnt lgkmcnt(0)
    v_mfma_f32_16x16x32_bf16 v[100:103], v[124:127], v[164:167], v[100:103]
    v_mfma_f32_16x16x32_bf16 v[108:111], v[124:127], v[172:175], v[108:111]
    s_add_u32 m0, s38, -128
    s_nop 0
    buffer_load_dwordx4 v244, s[8:11], s25 offen offset:128 lds
    s_add_u32 m0, s38, -2176
    s_nop 0
    buffer_load_dwordx4 v245, s[8:11], s25 offen offset:3200 lds
    s_add_u32 m0, s38, 1920
    s_nop 0
    buffer_load_dwordx4 v244, s[8:11], s26 offen offset:128 lds
    s_add_u32 m0, s38, -128
    s_nop 0
    buffer_load_dwordx4 v245, s[8:11], s26 offen offset:3200 lds
    s_waitcnt vmcnt(2)
    ds_read_b128 v[112:115], v238
    ds_read_b128 v[116:119], v239
    s_waitcnt vmcnt(0)
    ds_read_b128 v[120:123], v238 offset:2048
    ds_read_b128 v[124:127], v239 offset:2048
    s_waitcnt lgkmcnt(3)
    v_mfma_f32_16x16x32_bf16 v[96:99], v[112:115], v[176:179], v[96:99]
    v_mfma_f32_16x16x32_bf16 v[104:107], v[112:115], v[184:187], v[104:107]
    s_waitcnt lgkmcnt(2)
    v_mfma_f32_16x16x32_bf16 v[96:99], v[116:119], v[180:183], v[96:99]
    v_mfma_f32_16x16x32_bf16 v[104:107], v[116:119], v[188:191], v[104:107]
    s_waitcnt lgkmcnt(1)
    v_mfma_f32_16x16x32_bf16 v[100:103], v[120:123], v[176:179], v[100:103]
    v_mfma_f32_16x16x32_bf16 v[108:111], v[120:123], v[184:187], v[108:111]
    s_waitcnt lgkmcnt(0)
    v_mfma_f32_16x16x32_bf16 v[100:103], v[124:127], v[180:183], v[100:103]
    v_mfma_f32_16x16x32_bf16 v[108:111], v[124:127], v[188:191], v[108:111]
    s_add_u32 m0, s38, -256
    s_nop 0
    buffer_load_dwordx4 v244, s[8:11], s25 offen offset:256 lds
    s_add_u32 m0, s38, -2304
    s_nop 0
    buffer_load_dwordx4 v245, s[8:11], s25 offen offset:3328 lds
    s_add_u32 m0, s38, 1792
    s_nop 0
    buffer_load_dwordx4 v244, s[8:11], s26 offen offset:256 lds
    s_add_u32 m0, s38, -256
    s_nop 0
    buffer_load_dwordx4 v245, s[8:11], s26 offen offset:3328 lds
    s_waitcnt vmcnt(2)
    ds_read_b128 v[112:115], v238
    ds_read_b128 v[116:119], v239
    s_waitcnt vmcnt(0)
    ds_read_b128 v[120:123], v238 offset:2048
    ds_read_b128 v[124:127], v239 offset:2048
    s_waitcnt lgkmcnt(3)
    v_mfma_f32_16x16x32_bf16 v[96:99], v[112:115], v[192:195], v[96:99]
    v_mfma_f32_16x16x32_bf16 v[104:107], v[112:115], v[200:203], v[104:107]
    s_waitcnt lgkmcnt(2)
    v_mfma_f32_16x16x32_bf16 v[96:99], v[116:119], v[196:199], v[96:99]
    v_mfma_f32_16x16x32_bf16 v[104:107], v[116:119], v[204:207], v[104:107]
    s_waitcnt lgkmcnt(1)
    v_mfma_f32_16x16x32_bf16 v[100:103], v[120:123], v[192:195], v[100:103]
    v_mfma_f32_16x16x32_bf16 v[108:111], v[120:123], v[200:203], v[108:111]
    s_waitcnt lgkmcnt(0)
    v_mfma_f32_16x16x32_bf16 v[100:103], v[124:127], v[196:199], v[100:103]
    v_mfma_f32_16x16x32_bf16 v[108:111], v[124:127], v[204:207], v[108:111]
    s_nop 0
    v_max3_f32 v136, v96, v97, v98
    s_nop 4
    v_max3_f32 v136, v136, v99, v100
    v_max3_f32 v136, v136, v101, v102
    v_max_f32 v136, v136, v103
    v_max3_f32 v137, v104, v105, v106
    v_max3_f32 v137, v137, v107, v108
    v_max3_f32 v137, v137, v109, v110
    v_max_f32 v137, v137, v111
    s_nop 1
    v_permlane32_swap_b32 v136, v137
    v_max_f32 v136, v136, v137
    v_mov_b32 v137, v136
    s_nop 1
    v_permlane16_swap_b32 v136, v137
    v_max_f32 v136, v136, v137
    v_mov_b32 v137, v136
    s_nop 1
    v_permlane32_swap_b32 v136, v137
    v_max_f32 v136, v136, v128
    v_sub_f32 v130, v128, v136
    v_mov_b32 v128, v136
    v_mul_f32 v130, s20, v130
    v_exp_f32 v130, v130
    v_mul_f32 v248, s21, v136
    v_mul_f32 v132, v132, v130
    v_max_f32 v137, v137, v129
    v_sub_f32 v131, v129, v137
    v_mov_b32 v129, v137
    v_mul_f32 v131, s20, v131
    v_exp_f32 v131, v131
    v_mul_f32 v249, s21, v137
    v_mul_f32 v133, v133, v131
    v_fma_f32 v96, v96, s20, v248
    v_fma_f32 v97, v97, s20, v248
    v_fma_f32 v98, v98, s20, v248
    v_fma_f32 v99, v99, s20, v248
    v_fma_f32 v100, v100, s20, v248
    v_fma_f32 v101, v101, s20, v248
    v_fma_f32 v102, v102, s20, v248
    v_fma_f32 v103, v103, s20, v248
    v_fma_f32 v104, v104, s20, v249
    v_fma_f32 v105, v105, s20, v249
    v_fma_f32 v106, v106, s20, v249
    v_fma_f32 v107, v107, s20, v249
    v_fma_f32 v108, v108, s20, v249
    v_fma_f32 v109, v109, s20, v249
    v_fma_f32 v110, v110, s20, v249
    v_fma_f32 v111, v111, s20, v249
    v_exp_f32 v96, v96
    v_exp_f32 v97, v97
    v_exp_f32 v98, v98
    v_exp_f32 v99, v99
    v_exp_f32 v100, v100
    v_exp_f32 v101, v101
    v_exp_f32 v102, v102
    v_exp_f32 v103, v103
    v_exp_f32 v104, v104
    v_exp_f32 v105, v105
    v_exp_f32 v106, v106
    v_exp_f32 v107, v107
    v_exp_f32 v108, v108
    v_exp_f32 v109, v109
    v_exp_f32 v110, v110
    v_exp_f32 v111, v111
    v_add_f32 v132, v132, v96
    v_add_f32 v132, v132, v97
    v_add_f32 v132, v132, v98
    v_add_f32 v132, v132, v99
    v_add_f32 v132, v132, v100
    v_add_f32 v132, v132, v101
    v_add_f32 v132, v132, v102
    v_add_f32 v132, v132, v103
    v_add_f32 v133, v133, v104
    v_add_f32 v133, v133, v105
    v_add_f32 v133, v133, v106
    v_add_f32 v133, v133, v107
    v_add_f32 v133, v133, v108
    v_add_f32 v133, v133, v109
    v_add_f32 v133, v133, v110
    v_add_f32 v133, v133, v111
    v_cvt_pk_bf16_f32 v96, v96, v97
    v_cvt_pk_bf16_f32 v97, v98, v99
    v_cvt_pk_bf16_f32 v98, v100, v101
    v_cvt_pk_bf16_f32 v99, v102, v103
    v_cvt_pk_bf16_f32 v104, v104, v105
    v_cvt_pk_bf16_f32 v105, v106, v107
    v_cvt_pk_bf16_f32 v106, v108, v109
    v_cvt_pk_bf16_f32 v107, v110, v111
    v_mul_f32 v0, v0, v130
    v_mul_f32 v1, v1, v130
    v_mul_f32 v2, v2, v130
    v_mul_f32 v3, v3, v130
    v_mul_f32 v4, v4, v130
    v_mul_f32 v5, v5, v130
    v_mul_f32 v6, v6, v130
    v_mul_f32 v7, v7, v130
    v_mul_f32 v8, v8, v131
    v_mul_f32 v9, v9, v131
    v_mul_f32 v10, v10, v131
    v_mul_f32 v11, v11, v131
    v_mul_f32 v12, v12, v131
    v_mul_f32 v13, v13, v131
    v_mul_f32 v14, v14, v131
    v_mul_f32 v15, v15, v131
    v_mul_f32 v16, v16, v130
    v_mul_f32 v17, v17, v130
    v_mul_f32 v18, v18, v130
    v_mul_f32 v19, v19, v130
    v_mul_f32 v20, v20, v130
    v_mul_f32 v21, v21, v130
    v_mul_f32 v22, v22, v130
    v_mul_f32 v23, v23, v130
    v_mul_f32 v24, v24, v131
    v_mul_f32 v25, v25, v131
    v_mul_f32 v26, v26, v131
    v_mul_f32 v27, v27, v131
    v_mul_f32 v28, v28, v131
    v_mul_f32 v29, v29, v131
    v_mul_f32 v30, v30, v131
    v_mul_f32 v31, v31, v131
    v_mul_f32 v32, v32, v130
    v_mul_f32 v33, v33, v130
    v_mul_f32 v34, v34, v130
    v_mul_f32 v35, v35, v130
    v_mul_f32 v36, v36, v130
    v_mul_f32 v37, v37, v130
    v_mul_f32 v38, v38, v130
    v_mul_f32 v39, v39, v130
    v_mul_f32 v40, v40, v131
    v_mul_f32 v41, v41, v131
    v_mul_f32 v42, v42, v131
    v_mul_f32 v43, v43, v131
    v_mul_f32 v44, v44, v131
    v_mul_f32 v45, v45, v131
    v_mul_f32 v46, v46, v131
    v_mul_f32 v47, v47, v131
    v_mul_f32 v48, v48, v130
    v_mul_f32 v49, v49, v130
    v_mul_f32 v50, v50, v130
    v_mul_f32 v51, v51, v130
    v_mul_f32 v52, v52, v130
    v_mul_f32 v53, v53, v130
    v_mul_f32 v54, v54, v130
    v_mul_f32 v55, v55, v130
    v_mul_f32 v56, v56, v131
    v_mul_f32 v57, v57, v131
    v_mul_f32 v58, v58, v131
    v_mul_f32 v59, v59, v131
    v_mul_f32 v60, v60, v131
    v_mul_f32 v61, v61, v131
    v_mul_f32 v62, v62, v131
    v_mul_f32 v63, v63, v131
    v_mul_f32 v64, v64, v130
    v_mul_f32 v65, v65, v130
    v_mul_f32 v66, v66, v130
    v_mul_f32 v67, v67, v130
    v_mul_f32 v68, v68, v130
    v_mul_f32 v69, v69, v130
    v_mul_f32 v70, v70, v130
    v_mul_f32 v71, v71, v130
    v_mul_f32 v72, v72, v131
    v_mul_f32 v73, v73, v131
    v_mul_f32 v74, v74, v131
    v_mul_f32 v75, v75, v131
    v_mul_f32 v76, v76, v131
    v_mul_f32 v77, v77, v131
    v_mul_f32 v78, v78, v131
    v_mul_f32 v79, v79, v131
    v_mul_f32 v80, v80, v130
    v_mul_f32 v81, v81, v130
    v_mul_f32 v82, v82, v130
    v_mul_f32 v83, v83, v130
    v_mul_f32 v84, v84, v130
    v_mul_f32 v85, v85, v130
    v_mul_f32 v86, v86, v130
    v_mul_f32 v87, v87, v130
    v_mul_f32 v88, v88, v131
    v_mul_f32 v89, v89, v131
    v_mul_f32 v90, v90, v131
    v_mul_f32 v91, v91, v131
    v_mul_f32 v92, v92, v131
    v_mul_f32 v93, v93, v131
    v_mul_f32 v94, v94, v131
    v_mul_f32 v95, v95, v131
    s_add_u32 m0, s38, 0
    s_nop 0
    buffer_load_dwordx4 v134, s[48:51], s25 offen lds
    s_add_u32 m0, s38, 640
    s_nop 0
    buffer_load_dwordx4 v134, s[48:51], s25 offen offset:384 lds
    s_add_u32 m0, s38, 1280
    s_nop 0
    buffer_load_dwordx4 v134, s[48:51], s25 offen offset:768 lds
    s_add_u32 m0, s38, 1920
    s_nop 0
    buffer_load_dwordx4 v134, s[48:51], s25 offen offset:1152 lds
    s_waitcnt vmcnt(0)
    ds_read_b64_tr_b16 v[112:113], v135
    ds_read_b64_tr_b16 v[114:115], v135 offset:512
    ds_read_b64_tr_b16 v[116:117], v135 offset:8
    ds_read_b64_tr_b16 v[118:119], v135 offset:520
    ds_read_b64_tr_b16 v[120:121], v135 offset:64
    ds_read_b64_tr_b16 v[122:123], v135 offset:576
    ds_read_b64_tr_b16 v[124:125], v135 offset:72
    ds_read_b64_tr_b16 v[126:127], v135 offset:584
    s_waitcnt lgkmcnt(6)
    v_mfma_f32_16x16x32_bf16 v[0:3], v[112:115], v[96:99], v[0:3]
    v_mfma_f32_16x16x32_bf16 v[8:11], v[112:115], v[104:107], v[8:11]
    s_waitcnt lgkmcnt(4)
    v_mfma_f32_16x16x32_bf16 v[4:7], v[116:119], v[96:99], v[4:7]
    v_mfma_f32_16x16x32_bf16 v[12:15], v[116:119], v[104:107], v[12:15]
    s_waitcnt lgkmcnt(2)
    v_mfma_f32_16x16x32_bf16 v[16:19], v[120:123], v[96:99], v[16:19]
    v_mfma_f32_16x16x32_bf16 v[24:27], v[120:123], v[104:107], v[24:27]
    s_waitcnt lgkmcnt(0)
    v_mfma_f32_16x16x32_bf16 v[20:23], v[124:127], v[96:99], v[20:23]
    v_mfma_f32_16x16x32_bf16 v[28:31], v[124:127], v[104:107], v[28:31]
    s_add_u32 m0, s38, -128
    s_nop 0
    buffer_load_dwordx4 v134, s[48:51], s25 offen offset:128 lds
    s_add_u32 m0, s38, 512
    s_nop 0
    buffer_load_dwordx4 v134, s[48:51], s25 offen offset:512 lds
    s_add_u32 m0, s38, 1152
    s_nop 0
    buffer_load_dwordx4 v134, s[48:51], s25 offen offset:896 lds
    s_add_u32 m0, s38, 1792
    s_nop 0
    buffer_load_dwordx4 v134, s[48:51], s25 offen offset:1280 lds
    s_waitcnt vmcnt(0)
    ds_read_b64_tr_b16 v[112:113], v135
    ds_read_b64_tr_b16 v[114:115], v135 offset:512
    ds_read_b64_tr_b16 v[116:117], v135 offset:8
    ds_read_b64_tr_b16 v[118:119], v135 offset:520
    ds_read_b64_tr_b16 v[120:121], v135 offset:64
    ds_read_b64_tr_b16 v[122:123], v135 offset:576
    ds_read_b64_tr_b16 v[124:125], v135 offset:72
    ds_read_b64_tr_b16 v[126:127], v135 offset:584
    s_waitcnt lgkmcnt(6)
    v_mfma_f32_16x16x32_bf16 v[32:35], v[112:115], v[96:99], v[32:35]
    v_mfma_f32_16x16x32_bf16 v[40:43], v[112:115], v[104:107], v[40:43]
    s_waitcnt lgkmcnt(4)
    v_mfma_f32_16x16x32_bf16 v[36:39], v[116:119], v[96:99], v[36:39]
    v_mfma_f32_16x16x32_bf16 v[44:47], v[116:119], v[104:107], v[44:47]
    s_waitcnt lgkmcnt(2)
    v_mfma_f32_16x16x32_bf16 v[48:51], v[120:123], v[96:99], v[48:51]
    v_mfma_f32_16x16x32_bf16 v[56:59], v[120:123], v[104:107], v[56:59]
    s_waitcnt lgkmcnt(0)
    v_mfma_f32_16x16x32_bf16 v[52:55], v[124:127], v[96:99], v[52:55]
    v_mfma_f32_16x16x32_bf16 v[60:63], v[124:127], v[104:107], v[60:63]
    s_add_u32 m0, s38, -256
    s_nop 0
    buffer_load_dwordx4 v134, s[48:51], s25 offen offset:256 lds
    s_add_u32 m0, s38, 384
    s_nop 0
    buffer_load_dwordx4 v134, s[48:51], s25 offen offset:640 lds
    s_add_u32 m0, s38, 1024
    s_nop 0
    buffer_load_dwordx4 v134, s[48:51], s25 offen offset:1024 lds
    s_add_u32 m0, s38, 1664
    s_nop 0
    buffer_load_dwordx4 v134, s[48:51], s25 offen offset:1408 lds
    s_waitcnt vmcnt(0)
    ds_read_b64_tr_b16 v[112:113], v135
    ds_read_b64_tr_b16 v[114:115], v135 offset:512
    ds_read_b64_tr_b16 v[116:117], v135 offset:8
    ds_read_b64_tr_b16 v[118:119], v135 offset:520
    ds_read_b64_tr_b16 v[120:121], v135 offset:64
    ds_read_b64_tr_b16 v[122:123], v135 offset:576
    ds_read_b64_tr_b16 v[124:125], v135 offset:72
    ds_read_b64_tr_b16 v[126:127], v135 offset:584
    s_waitcnt lgkmcnt(6)
    v_mfma_f32_16x16x32_bf16 v[64:67], v[112:115], v[96:99], v[64:67]
    v_mfma_f32_16x16x32_bf16 v[72:75], v[112:115], v[104:107], v[72:75]
    s_waitcnt lgkmcnt(4)
    v_mfma_f32_16x16x32_bf16 v[68:71], v[116:119], v[96:99], v[68:71]
    v_mfma_f32_16x16x32_bf16 v[76:79], v[116:119], v[104:107], v[76:79]
    s_waitcnt lgkmcnt(2)
    v_mfma_f32_16x16x32_bf16 v[80:83], v[120:123], v[96:99], v[80:83]
    v_mfma_f32_16x16x32_bf16 v[88:91], v[120:123], v[104:107], v[88:91]
    s_waitcnt lgkmcnt(0)
    v_mfma_f32_16x16x32_bf16 v[84:87], v[124:127], v[96:99], v[84:87]
    v_mfma_f32_16x16x32_bf16 v[92:95], v[124:127], v[104:107], v[92:95]
    s_add_u32 s25, s25, 12288
    s_add_u32 s26, s26, 12288
    s_sub_u32 s27, s27, 1
    s_cmp_lg_u32 s27, 0
    s_cbranch_scc1 L_fb_unit
    s_waitcnt vmcnt(0) lgkmcnt(0)
    s_nop 7
    s_nop 7
    v_permlane32_swap_b32 v132, v133
    v_add_f32 v252, v132, v133
    v_mov_b32 v253, v252
    s_nop 1
    v_permlane16_swap_b32 v252, v253
    v_add_f32 v252, v252, v253
    v_rcp_f32 v252, v252
    s_nop 0
    v_mov_b32 v253, v252
    s_nop 1
    v_permlane32_swap_b32 v252, v253
    s_mov_b64 vcc, s[12:13]
    v_mul_f32 v0, v0, v252
    v_mul_f32 v1, v1, v252
    v_mul_f32 v2, v2, v252
    v_mul_f32 v3, v3, v252
    v_cvt_pk_bf16_f32 v0, v0, v1
    v_cvt_pk_bf16_f32 v1, v2, v3
    v_mul_f32 v4, v4, v252
    v_mul_f32 v5, v5, v252
    v_mul_f32 v6, v6, v252
    v_mul_f32 v7, v7, v252
    v_cvt_pk_bf16_f32 v2, v4, v5
    v_cvt_pk_bf16_f32 v3, v6, v7
    v_mul_f32 v8, v8, v253
    v_mul_f32 v9, v9, v253
    v_mul_f32 v10, v10, v253
    v_mul_f32 v11, v11, v253
    v_cvt_pk_bf16_f32 v4, v8, v9
    v_cvt_pk_bf16_f32 v5, v10, v11
    v_mul_f32 v12, v12, v253
    v_mul_f32 v13, v13, v253
    v_mul_f32 v14, v14, v253
    v_mul_f32 v15, v15, v253
    v_cvt_pk_bf16_f32 v6, v12, v13
    v_cvt_pk_bf16_f32 v7, v14, v15
    s_mov_b64 vcc, s[12:13]
    v_mul_f32 v16, v16, v252
    v_mul_f32 v17, v17, v252
    v_mul_f32 v18, v18, v252
    v_mul_f32 v19, v19, v252
    v_cvt_pk_bf16_f32 v16, v16, v17
    v_cvt_pk_bf16_f32 v17, v18, v19
    v_mul_f32 v20, v20, v252
    v_mul_f32 v21, v21, v252
    v_mul_f32 v22, v22, v252
    v_mul_f32 v23, v23, v252
    v_cvt_pk_bf16_f32 v18, v20, v21
    v_cvt_pk_bf16_f32 v19, v22, v23
    v_mul_f32 v24, v24, v253
    v_mul_f32 v25, v25, v253
    v_mul_f32 v26, v26, v253
    v_mul_f32 v27, v27, v253
    v_cvt_pk_bf16_f32 v20, v24, v25
    v_cvt_pk_bf16_f32 v21, v26, v27
    v_mul_f32 v28, v28, v253
    v_mul_f32 v29, v29, v253
    v_mul_f32 v30, v30, v253
    v_mul_f32 v31, v31, v253
    v_cvt_pk_bf16_f32 v22, v28, v29
    v_cvt_pk_bf16_f32 v23, v30, v31
    s_mov_b64 vcc, s[12:13]
    v_cndmask_b32_dpp v8, v16, v0, vcc quad_perm:[1,0,3,2] row_mask:0xf bank_mask:0xf
    v_cndmask_b32_dpp v9, v17, v1, vcc quad_perm:[1,0,3,2] row_mask:0xf bank_mask:0xf
    v_cndmask_b32_dpp v10, v18, v2, vcc quad_perm:[1,0,3,2] row_mask:0xf bank_mask:0xf
    v_cndmask_b32_dpp v11, v19, v3, vcc quad_perm:[1,0,3,2] row_mask:0xf bank_mask:0xf
    s_mov_b64 vcc, s[14:15]
    v_cndmask_b32_dpp v16, v0, v16, vcc quad_perm:[1,0,3,2] row_mask:0xf bank_mask:0xf
    v_cndmask_b32_dpp v17, v1, v17, vcc quad_perm:[1,0,3,2] row_mask:0xf bank_mask:0xf
    v_cndmask_b32_dpp v18, v2, v18, vcc quad_perm:[1,0,3,2] row_mask:0xf bank_mask:0xf
    v_cndmask_b32_dpp v19, v3, v19, vcc quad_perm:[1,0,3,2] row_mask:0xf bank_mask:0xf
    buffer_store_dwordx4 v[8:11], v243, s[16:19], s44 offen nt
    buffer_store_dwordx4 v[16:19], v243, s[16:19], s44 offen offset:384 nt
    s_mov_b64 vcc, s[12:13]
    v_cndmask_b32_dpp v12, v20, v4, vcc quad_perm:[1,0,3,2] row_mask:0xf bank_mask:0xf
    v_cndmask_b32_dpp v13, v21, v5, vcc quad_perm:[1,0,3,2] row_mask:0xf bank_mask:0xf
    v_cndmask_b32_dpp v14, v22, v6, vcc quad_perm:[1,0,3,2] row_mask:0xf bank_mask:0xf
    v_cndmask_b32_dpp v15, v23, v7, vcc quad_perm:[1,0,3,2] row_mask:0xf bank_mask:0xf
    s_mov_b64 vcc, s[14:15]
    v_cndmask_b32_dpp v20, v4, v20, vcc quad_perm:[1,0,3,2] row_mask:0xf bank_mask:0xf
    v_cndmask_b32_dpp v21, v5, v21, vcc quad_perm:[1,0,3,2] row_mask:0xf bank_mask:0xf
    v_cndmask_b32_dpp v22, v6, v22, vcc quad_perm:[1,0,3,2] row_mask:0xf bank_mask:0xf
    v_cndmask_b32_dpp v23, v7, v23, vcc quad_perm:[1,0,3,2] row_mask:0xf bank_mask:0xf
    buffer_store_dwordx4 v[12:15], v243, s[16:19], s45 offen nt
    buffer_store_dwordx4 v[20:23], v243, s[16:19], s45 offen offset:384 nt
    s_mov_b64 vcc, s[12:13]
    v_mul_f32 v32, v32, v252
    v_mul_f32 v33, v33, v252
    v_mul_f32 v34, v34, v252
    v_mul_f32 v35, v35, v252
    v_cvt_pk_bf16_f32 v32, v32, v33
    v_cvt_pk_bf16_f32 v33, v34, v35
    v_mul_f32 v36, v36, v252
    v_mul_f32 v37, v37, v252
    v_mul_f32 v38, v38, v252
    v_mul_f32 v39, v39, v252
    v_cvt_pk_bf16_f32 v34, v36, v37
    v_cvt_pk_bf16_f32 v35, v38, v39
    v_mul_f32 v40, v40, v253
    v_mul_f32 v41, v41, v253
    v_mul_f32 v42, v42, v253
    v_mul_f32 v43, v43, v253
    v_cvt_pk_bf16_f32 v36, v40, v41
    v_cvt_pk_bf16_f32 v37, v42, v43
    v_mul_f32 v44, v44, v253
    v_mul_f32 v45, v45, v253
    v_mul_f32 v46, v46, v253
    v_mul_f32 v47, v47, v253
    v_cvt_pk_bf16_f32 v38, v44, v45
    v_cvt_pk_bf16_f32 v39, v46, v47
    s_mov_b64 vcc, s[12:13]
    v_mul_f32 v48, v48, v252
    v_mul_f32 v49, v49, v252
    v_mul_f32 v50, v50, v252
    v_mul_f32 v51, v51, v252
    v_cvt_pk_bf16_f32 v48, v48, v49
    v_cvt_pk_bf16_f32 v49, v50, v51
    v_mul_f32 v52, v52, v252
    v_mul_f32 v53, v53, v252
    v_mul_f32 v54, v54, v252
    v_mul_f32 v55, v55, v252
    v_cvt_pk_bf16_f32 v50, v52, v53
    v_cvt_pk_bf16_f32 v51, v54, v55
    v_mul_f32 v56, v56, v253
    v_mul_f32 v57, v57, v253
    v_mul_f32 v58, v58, v253
    v_mul_f32 v59, v59, v253
    v_cvt_pk_bf16_f32 v52, v56, v57
    v_cvt_pk_bf16_f32 v53, v58, v59
    v_mul_f32 v60, v60, v253
    v_mul_f32 v61, v61, v253
    v_mul_f32 v62, v62, v253
    v_mul_f32 v63, v63, v253
    v_cvt_pk_bf16_f32 v54, v60, v61
    v_cvt_pk_bf16_f32 v55, v62, v63
    s_mov_b64 vcc, s[12:13]
    v_cndmask_b32_dpp v40, v48, v32, vcc quad_perm:[1,0,3,2] row_mask:0xf bank_mask:0xf
    v_cndmask_b32_dpp v41, v49, v33, vcc quad_perm:[1,0,3,2] row_mask:0xf bank_mask:0xf
    v_cndmask_b32_dpp v42, v50, v34, vcc quad_perm:[1,0,3,2] row_mask:0xf bank_mask:0xf
    v_cndmask_b32_dpp v43, v51, v35, vcc quad_perm:[1,0,3,2] row_mask:0xf bank_mask:0xf
    s_mov_b64 vcc, s[14:15]
    v_cndmask_b32_dpp v48, v32, v48, vcc quad_perm:[1,0,3,2] row_mask:0xf bank_mask:0xf
    v_cndmask_b32_dpp v49, v33, v49, vcc quad_perm:[1,0,3,2] row_mask:0xf bank_mask:0xf
    v_cndmask_b32_dpp v50, v34, v50, vcc quad_perm:[1,0,3,2] row_mask:0xf bank_mask:0xf
    v_cndmask_b32_dpp v51, v35, v51, vcc quad_perm:[1,0,3,2] row_mask:0xf bank_mask:0xf
    buffer_store_dwordx4 v[40:43], v243, s[16:19], s44 offen offset:128 nt
    buffer_store_dwordx4 v[48:51], v243, s[16:19], s44 offen offset:512 nt
    s_mov_b64 vcc, s[12:13]
    v_cndmask_b32_dpp v44, v52, v36, vcc quad_perm:[1,0,3,2] row_mask:0xf bank_mask:0xf
    v_cndmask_b32_dpp v45, v53, v37, vcc quad_perm:[1,0,3,2] row_mask:0xf bank_mask:0xf
    v_cndmask_b32_dpp v46, v54, v38, vcc quad_perm:[1,0,3,2] row_mask:0xf bank_mask:0xf
    v_cndmask_b32_dpp v47, v55, v39, vcc quad_perm:[1,0,3,2] row_mask:0xf bank_mask:0xf
    s_mov_b64 vcc, s[14:15]
    v_cndmask_b32_dpp v52, v36, v52, vcc quad_perm:[1,0,3,2] row_mask:0xf bank_mask:0xf
    v_cndmask_b32_dpp v53, v37, v53, vcc quad_perm:[1,0,3,2] row_mask:0xf bank_mask:0xf
    v_cndmask_b32_dpp v54, v38, v54, vcc quad_perm:[1,0,3,2] row_mask:0xf bank_mask:0xf
    v_cndmask_b32_dpp v55, v39, v55, vcc quad_perm:[1,0,3,2] row_mask:0xf bank_mask:0xf
    buffer_store_dwordx4 v[44:47], v243, s[16:19], s45 offen offset:128 nt
    buffer_store_dwordx4 v[52:55], v243, s[16:19], s45 offen offset:512 nt
    s_mov_b64 vcc, s[12:13]
    v_mul_f32 v64, v64, v252
    v_mul_f32 v65, v65, v252
    v_mul_f32 v66, v66, v252
    v_mul_f32 v67, v67, v252
    v_cvt_pk_bf16_f32 v64, v64, v65
    v_cvt_pk_bf16_f32 v65, v66, v67
    v_mul_f32 v68, v68, v252
    v_mul_f32 v69, v69, v252
    v_mul_f32 v70, v70, v252
    v_mul_f32 v71, v71, v252
    v_cvt_pk_bf16_f32 v66, v68, v69
    v_cvt_pk_bf16_f32 v67, v70, v71
    v_mul_f32 v72, v72, v253
    v_mul_f32 v73, v73, v253
    v_mul_f32 v74, v74, v253
    v_mul_f32 v75, v75, v253
    v_cvt_pk_bf16_f32 v68, v72, v73
    v_cvt_pk_bf16_f32 v69, v74, v75
    v_mul_f32 v76, v76, v253
    v_mul_f32 v77, v77, v253
    v_mul_f32 v78, v78, v253
    v_mul_f32 v79, v79, v253
    v_cvt_pk_bf16_f32 v70, v76, v77
    v_cvt_pk_bf16_f32 v71, v78, v79
    s_mov_b64 vcc, s[12:13]
    v_mul_f32 v80, v80, v252
    v_mul_f32 v81, v81, v252
    v_mul_f32 v82, v82, v252
    v_mul_f32 v83, v83, v252
    v_cvt_pk_bf16_f32 v80, v80, v81
    v_cvt_pk_bf16_f32 v81, v82, v83
    v_mul_f32 v84, v84, v252
    v_mul_f32 v85, v85, v252
    v_mul_f32 v86, v86, v252
    v_mul_f32 v87, v87, v252
    v_cvt_pk_bf16_f32 v82, v84, v85
    v_cvt_pk_bf16_f32 v83, v86, v87
    v_mul_f32 v88, v88, v253
    v_mul_f32 v89, v89, v253
    v_mul_f32 v90, v90, v253
    v_mul_f32 v91, v91, v253
    v_cvt_pk_bf16_f32 v84, v88, v89
    v_cvt_pk_bf16_f32 v85, v90, v91
    v_mul_f32 v92, v92, v253
    v_mul_f32 v93, v93, v253
    v_mul_f32 v94, v94, v253
    v_mul_f32 v95, v95, v253
    v_cvt_pk_bf16_f32 v86, v92, v93
    v_cvt_pk_bf16_f32 v87, v94, v95
    s_mov_b64 vcc, s[12:13]
    v_cndmask_b32_dpp v72, v80, v64, vcc quad_perm:[1,0,3,2] row_mask:0xf bank_mask:0xf
    v_cndmask_b32_dpp v73, v81, v65, vcc quad_perm:[1,0,3,2] row_mask:0xf bank_mask:0xf
    v_cndmask_b32_dpp v74, v82, v66, vcc quad_perm:[1,0,3,2] row_mask:0xf bank_mask:0xf
    v_cndmask_b32_dpp v75, v83, v67, vcc quad_perm:[1,0,3,2] row_mask:0xf bank_mask:0xf
    s_mov_b64 vcc, s[14:15]
    v_cndmask_b32_dpp v80, v64, v80, vcc quad_perm:[1,0,3,2] row_mask:0xf bank_mask:0xf
    v_cndmask_b32_dpp v81, v65, v81, vcc quad_perm:[1,0,3,2] row_mask:0xf bank_mask:0xf
    v_cndmask_b32_dpp v82, v66, v82, vcc quad_perm:[1,0,3,2] row_mask:0xf bank_mask:0xf
    v_cndmask_b32_dpp v83, v67, v83, vcc quad_perm:[1,0,3,2] row_mask:0xf bank_mask:0xf
    buffer_store_dwordx4 v[72:75], v243, s[16:19], s44 offen offset:256 nt
    buffer_store_dwordx4 v[80:83], v243, s[16:19], s44 offen offset:640 nt
    s_mov_b64 vcc, s[12:13]
    v_cndmask_b32_dpp v76, v84, v68, vcc quad_perm:[1,0,3,2] row_mask:0xf bank_mask:0xf
    v_cndmask_b32_dpp v77, v85, v69, vcc quad_perm:[1,0,3,2] row_mask:0xf bank_mask:0xf
    v_cndmask_b32_dpp v78, v86, v70, vcc quad_perm:[1,0,3,2] row_mask:0xf bank_mask:0xf
    v_cndmask_b32_dpp v79, v87, v71, vcc quad_perm:[1,0,3,2] row_mask:0xf bank_mask:0xf
    s_mov_b64 vcc, s[14:15]
    v_cndmask_b32_dpp v84, v68, v84, vcc quad_perm:[1,0,3,2] row_mask:0xf bank_mask:0xf
    v_cndmask_b32_dpp v85, v69, v85, vcc quad_perm:[1,0,3,2] row_mask:0xf bank_mask:0xf
    v_cndmask_b32_dpp v86, v70, v86, vcc quad_perm:[1,0,3,2] row_mask:0xf bank_mask:0xf
    v_cndmask_b32_dpp v87, v71, v87, vcc quad_perm:[1,0,3,2] row_mask:0xf bank_mask:0xf
    buffer_store_dwordx4 v[76:79], v243, s[16:19], s45 offen offset:256 nt
    buffer_store_dwordx4 v[84:87], v243, s[16:19], s45 offen offset:640 nt
    s_cmp_lg_u32 s32, 0
    s_cbranch_scc1 L_fb_item
L_end:
    s_endpgm
L_rare_1:
    s_lshl_b32 s33, s24, 1
    s_lshl_b32 s33, 3, s33
    s_or_b32 s32, s32, s33
    s_branch L_back_2

L_rare_3:
    s_lshl_b32 s33, s24, 1
    s_lshl_b32 s33, 3, s33
    s_or_b32 s32, s32, s33
    s_branch L_back_4
    s_endpgm
.section .rodata,"a"
.p2align 6
.amdhsa_kernel standalone__mha_softmax__near_ridge_kernel
  .amdhsa_next_free_vgpr 512
  .amdhsa_next_free_sgpr 102
  .amdhsa_accum_offset 256
  .amdhsa_group_segment_fixed_size 0
  .amdhsa_kernarg_size 48
  .amdhsa_user_sgpr_count 2
  .amdhsa_user_sgpr_kernarg_segment_ptr 1
  .amdhsa_system_sgpr_workgroup_id_x 1
.end_amdhsa_kernel
```
